```python
import torch

def _softmax(x, axis=-1):
    return torch.softmax(x, dim=axis)
def _gelu(x):
    return torch.nn.functional.gelu(x, approximate="tanh")
def _silu(x):
    return torch.nn.functional.silu(x)
def _sigmoid(x):
    return torch.sigmoid(x)
def _layernorm(x, axis=-1, eps=1e-5):
    m = x.mean(dim=axis, keepdim=True)
    v = x.var(dim=axis, keepdim=True, unbiased=False)
    return (x - m) / torch.sqrt(v + eps)
def _scatter_add(tgt, idx, src, axis=0):
    return tgt.clone().index_add_(axis, idx, src)
def _segment_sum(src, seg, n):
    out = torch.zeros((n,) + src.shape[1:], dtype=src.dtype)
    return out.index_add_(0, seg, src)
def _pad(x, pw):
    flat = tuple(v for pair in reversed(pw) for v in pair)
    return torch.nn.functional.pad(x, flat)

kernel_name = 'gated_mix__ssm_conv_s5__mixer_channel_mlp__prompt'

def setup_inputs():

    _w = (lambda a: (lambda t: t.to(torch.bfloat16) if t.is_floating_point() else t)(torch.as_tensor(a)))
    def _A_setup():
        B, S, D = 1, 2048, 1024
        P = D
        Lambda_re = -0.5 * (lambda _x: torch.exp(torch.as_tensor(_x)))((lambda *s: torch.randn(*s, dtype=torch.bfloat16) * 0.4)(P))
        Lambda_im = (lambda *s: torch.randn(*s, dtype=torch.bfloat16) * 0.8)(P) * 1.0
        B_re = (lambda *s: torch.randn(*s, dtype=torch.bfloat16) * 0.8)(P, D) * (D ** -0.5)
        B_im = (lambda *s: torch.randn(*s, dtype=torch.bfloat16) * 0.4)(P, D) * (D ** -0.5)
        C_re = (lambda *s: torch.randn(*s, dtype=torch.bfloat16) * 0.8)(D, P) * (P ** -0.5)
        C_im = (lambda *s: torch.randn(*s, dtype=torch.bfloat16) * 0.8)(D, P) * (P ** -0.5)
        log_dt = (lambda *s: torch.randn(*s, dtype=torch.bfloat16) * 0.4)(P) * 0.3 - 2.0
        Dskip = (lambda *s: torch.randn(*s, dtype=torch.bfloat16) * 0.1)(D)
        return {
            "x": _w((lambda *s: torch.randn(*s, dtype=torch.bfloat16) * 0.05)(B, S, D)),
            "Lambda_re": _w(Lambda_re),
            "Lambda_im": _w(Lambda_im),
            "B_re": _w(B_re),
            "B_im": _w(B_im),
            "C_re": _w(C_re),
            "C_im": _w(C_im),
            "log_dt": _w(log_dt),
            "Dskip": _w(Dskip),
        }
    _A_in = _A_setup()

    def _B_setup():
        B, S, D, F = 1, 2048, 1024, 3584
        return {
            "x": _w((lambda *s: torch.randn(*s, dtype=torch.bfloat16) * 0.05)(B, S, D)),
            "w1": _w((lambda *s: torch.randn(*s, dtype=torch.bfloat16) * 0.8)(D, F) * (D ** -0.5)),
            "b1": _w((lambda *s: torch.randn(*s, dtype=torch.bfloat16) * 0.2)(F)),
            "w2": _w((lambda *s: torch.randn(*s, dtype=torch.bfloat16) * 0.05)(F, D) * (F ** -0.5)),
            "b2": _w((lambda *s: torch.randn(*s, dtype=torch.bfloat16) * 0.05)(D)),
        }
    _B_in = _B_setup()

    return {
        "A_x": _A_in["x"],
        "A_Lambda_re": _A_in["Lambda_re"],
        "A_Lambda_im": _A_in["Lambda_im"],
        "A_B_re": _A_in["B_re"],
        "A_B_im": _A_in["B_im"],
        "A_C_re": _A_in["C_re"],
        "A_C_im": _A_in["C_im"],
        "A_log_dt": _A_in["log_dt"],
        "A_Dskip": _A_in["Dskip"],
        "B_x": _B_in["x"],
        "B_w1": _B_in["w1"],
        "B_b1": _B_in["b1"],
        "B_w2": _B_in["w2"],
        "B_b2": _B_in["b2"],
        "gate_w": _w((lambda *s: torch.randn(*s, dtype=torch.bfloat16) * 0.05)(1024) * 16.0),
    }

def reference(A_x, A_Lambda_re, A_Lambda_im, A_B_re, A_B_im, A_C_re, A_C_im, A_log_dt, A_Dskip, B_x, B_w1, B_b1, B_w2, B_b2, gate_w):
    def _A_ref(x, Lambda_re, Lambda_im, B_re, B_im, C_re, C_im, log_dt, Dskip):
        Bsz, L, H = x.shape
        Lam = Lambda_re + 1j * Lambda_im
        Bmat = B_re + 1j * B_im
        Cmat = C_re + 1j * C_im
        dt = torch.exp(log_dt)
        Lam_bar = torch.exp(dt * Lam)
        B_bar = ((Lam_bar - 1.0) / Lam)[:, None] * Bmat
        Bu = torch.einsum("bld,pd->blp", x + 0j, B_bar)
        h = torch.zeros_like(Bu[:, 0, :])
        hs = []
        for t in range(L):
            h = Lam_bar[None, :] * h + Bu[:, t, :]
            hs.append(h)
        hseq = torch.stack(hs, 1)
        y = 2.0 * torch.einsum("blp,dp->bld", hseq, Cmat).real + x * Dskip[None, None, :]
        return y

    def _B_ref(x, w1, b1, w2, b2):
        y = _layernorm(x, axis=-1)
        h = _gelu(torch.einsum("bsd,df->bsf", y, w1) + b1)
        return torch.einsum("bsf,fd->bsd", h, w2) + b2

    x = A_x
    g = _sigmoid((x * gate_w).sum(-1, keepdims=True))
    a = _A_ref(x, A_Lambda_re, A_Lambda_im, A_B_re, A_B_im, A_C_re, A_C_im, A_log_dt, A_Dskip)
    b = _B_ref(x, B_w1, B_b1, B_w2, B_b2)
    return g * a + (1 - g) * b
```

```asm
; @launch kernel=s1_kernel grid=(256,1,1) block=(512,1,1) lds=163840
.amdgcn_target "amdgcn-amd-amdhsa--gfx950"
.text
.globl s1_kernel
.p2align 8
.type s1_kernel,@function
s1_kernel:
    s_cmp_ge_u32 s2, 256
    s_cbranch_scc1 s1_done
    s_load_dwordx2 s[36:37], s[0:1], 0
    s_load_dwordx4 s[40:43], s[0:1], 8
    s_load_dwordx4 s[44:47], s[0:1], 24
    s_load_dwordx2 s[48:49], s[0:1], 56
    s_load_dwordx4 s[52:55], s[0:1], 80
    s_load_dwordx4 s[56:59], s[0:1], 128
    v_lshrrev_b32 v1, 6, v0
    v_and_b32 v2, 63, v0
    v_readfirstlane_b32 s32, v1
    s_and_b32 s3, s2, 7
    s_lshr_b32 s33, s2, 3
    s_and_b32 s34, s3, 1
    s_mov_b32 s87, s34
    s_lshl_b32 s34, s34, 2
    s_and_b32 s35, s33, 3
    s_add_u32 s34, s34, s35
    s_lshr_b32 s35, s3, 1
    s_lshl_b32 s35, s35, 2
    s_bfe_u32 s3, s33, 0x20002
    s_add_u32 s35, s35, s3
    s_lshr_b32 s33, s33, 4
    v_lshrrev_b32 v3, 3, v2
    v_and_b32 v4, 7, v2
    v_lshrrev_b32 v5, 1, v3
    v_xor_b32 v4, v4, v5
    v_lshlrev_b32 v4, 4, v4
    v_and_b32 v6, 15, v2
    v_lshrrev_b32 v7, 4, v2
    v_lshrrev_b32 v8, 1, v6
    v_xor_b32 v8, v8, v7
    v_lshlrev_b32 v8, 4, v8
    v_lshl_add_u32 v8, v6, 7, v8
    s_lshr_b32 s60, s32, 1
    s_and_b32 s61, s32, 1
    s_lshl_b32 s62, s60, 13
    v_add_u32 v104, s62, v8
    v_xor_b32 v105, 64, v104
    v_add_u32 v106, 61440, v104
    v_add_u32 v107, 61440, v105
    s_lshl_b32 s29, s32, 12
    s_waitcnt lgkmcnt(0)
    s_add_u32 s12, s58, 8388608
    s_addc_u32 s13, s59, 0
    s_mov_b32 s14, 23068672
    s_mov_b32 s15, 0x00020000
    s_cmp_eq_u32 s33, 0
    s_cbranch_scc1 s1_ssm
    s_mov_b32 s4, s36
    s_mov_b32 s5, s37
    s_mov_b32 s6, 4194304
    s_mov_b32 s7, 0x00020000
    s_mov_b32 s8, s52
    s_mov_b32 s9, s53
    s_mov_b32 s10, 7340032
    s_mov_b32 s11, 0x00020000
    s_mov_b32 s16, s54
    s_mov_b32 s17, s55
    s_mov_b32 s18, 7168
    s_mov_b32 s19, 0x00020000
    s_cmp_lg_u32 s32, 7
    s_cbranch_scc1 mlp_nb
    s_mul_i32 s63, s35, 448
    v_lshlrev_b32 v9, 2, v2
    s_mov_b32 m0, 135168
    s_nop 0
    buffer_load_dword v9, s[16:19], s63 offen lds
    s_mov_b32 m0, 135424
    s_add_u32 s63, s63, 256
    buffer_load_dword v9, s[16:19], s63 offen lds
mlp_nb:
    v_lshl_add_u32 v112, v3, 11, v4
    s_lshl_b32 s84, s87, 10
    v_add_u32 v112, s84, v112
    v_xor_b32 v113, 64, v112
    s_lshl_b32 s20, s34, 8
    s_lshl_b32 s63, s32, 5
    s_add_u32 s20, s20, s63
    s_lshl_b32 s20, s20, 11
    s_add_u32 s21, s20, 16384
    s_add_u32 s22, s20, 32768
    s_add_u32 s23, s20, 49152
    v_lshrrev_b32 v9, 2, v2
    v_and_b32 v10, 3, v2
    v_lshrrev_b32 v11, 5, v2
    v_lshlrev_b32 v11, 1, v11
    v_xor_b32 v10, v10, v11
    v_lshlrev_b32 v10, 4, v10
    s_movk_i32 s63, 7168
    v_mul_lo_u32 v9, v9, s63
    v_add_u32 v114, v9, v10
    s_mul_i32 s85, s87, 512*7168
    v_add_u32 v114, s85, v114
    s_lshl_b32 s84, s84, 1
    s_lshl_b32 s85, s85, 1
    s_mul_i32 s24, s60, 16*7168
    s_mul_i32 s64, s35, 448
    s_add_u32 s24, s24, s64
    s_lshl_b32 s63, s61, 8
    s_add_u32 s24, s24, s63
    s_add_u32 s25, s24, 64
    s_add_u32 s26, s24, 128
    s_add_u32 s27, s24, 192
    s_mul_i32 s30, s60, 7
    s_lshl_b32 s63, s61, 2
    s_add_u32 s30, s30, s63
    s_lshl_b32 s30, s30, 10
    s_add_u32 s30, s30, 32768
    s_mov_b32 s28, 64*7168
    s_add_u32 m0, s29, 0
    s_nop 0
    buffer_load_dwordx4 v112, s[4:7], s20 offen lds
    s_add_u32 m0, s29, 1024
    s_nop 0
    buffer_load_dwordx4 v113, s[4:7], s21 offen lds
    s_add_u32 m0, s29, 2048
    s_nop 0
    buffer_load_dwordx4 v112, s[4:7], s22 offen lds
    s_add_u32 m0, s29, 3072
    s_nop 0
    buffer_load_dwordx4 v113, s[4:7], s23 offen lds
    s_add_u32 m0, s30, 0
    s_nop 0
    buffer_load_dwordx4 v114, s[8:11], s24 offen lds
    s_add_u32 m0, s30, 1024
    s_nop 0
    buffer_load_dwordx4 v114, s[8:11], s25 offen lds
    s_add_u32 m0, s30, 2048
    s_nop 0
    buffer_load_dwordx4 v114, s[8:11], s26 offen lds
    s_cmp_lg_u32 s61, 0
    s_cbranch_scc1 mlp_skip_1
    s_add_u32 m0, s30, 3072
    s_nop 0
    buffer_load_dwordx4 v114, s[8:11], s27 offen lds
    mlp_skip_1:
    v_add_u32 v112, 128, v112
    v_add_u32 v113, 128, v113
    v_add_u32 v114, s28, v114
    s_add_u32 m0, s29, 61440
    s_nop 0
    buffer_load_dwordx4 v112, s[4:7], s20 offen lds
    s_add_u32 m0, s29, 62464
    s_nop 0
    buffer_load_dwordx4 v113, s[4:7], s21 offen lds
    s_add_u32 m0, s29, 63488
    s_nop 0
    buffer_load_dwordx4 v112, s[4:7], s22 offen lds
    s_add_u32 m0, s29, 64512
    s_nop 0
    buffer_load_dwordx4 v113, s[4:7], s23 offen lds
    s_add_u32 m0, s30, 61440
    s_nop 0
    buffer_load_dwordx4 v114, s[8:11], s24 offen lds
    s_add_u32 m0, s30, 62464
    s_nop 0
    buffer_load_dwordx4 v114, s[8:11], s25 offen lds
    s_add_u32 m0, s30, 63488
    s_nop 0
    buffer_load_dwordx4 v114, s[8:11], s26 offen lds
    s_cmp_lg_u32 s61, 0
    s_cbranch_scc1 mlp_skip_2
    s_add_u32 m0, s30, 64512
    s_nop 0
    buffer_load_dwordx4 v114, s[8:11], s27 offen lds
    mlp_skip_2:
    v_add_u32 v112, 128, v112
    v_add_u32 v113, 128, v113
    v_add_u32 v114, s28, v114
    v_lshrrev_b32 v9, 1, v7
    s_movk_i32 s63, 7168
    v_mul_lo_u32 v9, v9, s63
    v_and_b32 v10, 1, v7
    v_lshrrev_b32 v11, 2, v6
    v_lshl_add_u32 v11, v10, 3, v11
    v_lshl_add_u32 v9, v11, 6, v9
    v_and_b32 v11, 3, v6
    v_lshl_add_u32 v9, v11, 3, v9
    v_lshl_add_u32 v9, v10, 5, v9
    s_lshl_b32 s63, s61, 5
    v_xor_b32 v115, s63, v9
    v_add_u32 v115, 32768, v115
    v_add_u32 v5, 61440, v115
    s_lshl_b32 s63, s61, 12
    s_add_u32 s63, s63, 32768
    v_add_u32 v108, s63, v9
    v_xor_b32 v109, 32, v108
    v_add_u32 v110, 61440, v108
    v_add_u32 v111, 61440, v109
    s_lshl_b32 s63, s34, 4
    s_add_u32 s63, s63, s35
    s_cmp_ge_u32 s32, 3
    s_cselect_b32 s67, 2, 1
    s_add_u32 s67, s67, s32
    s_mul_i32 s67, s67, 128*7168
    s_lshl_b32 s66, s63, 13
    s_add_u32 s66, s66, s67
    s_cmp_lt_u32 s63, 112
    s_cselect_b32 s66, s66, 0
    s_cmp_lt_u32 s32, 6
    s_cselect_b32 s66, s66, 0
    v_lshlrev_b32 v9, 7, v2
    buffer_load_dword v10, v9, s[8:11], s66 offen
    s_mov_b32 s65, 0xffff0000
    v_mov_b32 v128, 0
    v_mov_b32 v129, 0
    v_mov_b32 v130, 0
    v_mov_b32 v131, 0
    v_mov_b32 v132, 0
    v_mov_b32 v133, 0
    v_mov_b32 v134, 0
    v_mov_b32 v135, 0
    v_mov_b32 v136, 0
    v_mov_b32 v137, 0
    v_mov_b32 v138, 0
    v_mov_b32 v139, 0
    v_mov_b32 v140, 0
    v_mov_b32 v141, 0
    v_mov_b32 v142, 0
    v_mov_b32 v143, 0
    v_mov_b32 v144, 0
    v_mov_b32 v145, 0
    v_mov_b32 v146, 0
    v_mov_b32 v147, 0
    v_mov_b32 v148, 0
    v_mov_b32 v149, 0
    v_mov_b32 v150, 0
    v_mov_b32 v151, 0
    v_mov_b32 v152, 0
    v_mov_b32 v153, 0
    v_mov_b32 v154, 0
    v_mov_b32 v155, 0
    v_mov_b32 v156, 0
    v_mov_b32 v157, 0
    v_mov_b32 v158, 0
    v_mov_b32 v159, 0
    v_mov_b32 v160, 0
    v_mov_b32 v161, 0
    v_mov_b32 v162, 0
    v_mov_b32 v163, 0
    v_mov_b32 v164, 0
    v_mov_b32 v165, 0
    v_mov_b32 v166, 0
    v_mov_b32 v167, 0
    v_mov_b32 v168, 0
    v_mov_b32 v169, 0
    v_mov_b32 v170, 0
    v_mov_b32 v171, 0
    v_mov_b32 v172, 0
    v_mov_b32 v173, 0
    v_mov_b32 v174, 0
    v_mov_b32 v175, 0
    v_mov_b32 v176, 0
    v_mov_b32 v177, 0
    v_mov_b32 v178, 0
    v_mov_b32 v179, 0
    v_mov_b32 v180, 0
    v_mov_b32 v181, 0
    v_mov_b32 v182, 0
    v_mov_b32 v183, 0
    v_mov_b32 v184, 0
    v_mov_b32 v185, 0
    v_mov_b32 v186, 0
    v_mov_b32 v187, 0
    v_mov_b32 v188, 0
    v_mov_b32 v189, 0
    v_mov_b32 v190, 0
    v_mov_b32 v191, 0
    v_mov_b32 v192, 0
    v_mov_b32 v193, 0
    v_mov_b32 v194, 0
    v_mov_b32 v195, 0
    v_mov_b32 v196, 0
    v_mov_b32 v197, 0
    v_mov_b32 v198, 0
    v_mov_b32 v199, 0
    v_mov_b32 v200, 0
    v_mov_b32 v201, 0
    v_mov_b32 v202, 0
    v_mov_b32 v203, 0
    v_mov_b32 v204, 0
    v_mov_b32 v205, 0
    v_mov_b32 v206, 0
    v_mov_b32 v207, 0
    v_mov_b32 v208, 0
    v_mov_b32 v209, 0
    v_mov_b32 v210, 0
    v_mov_b32 v211, 0
    v_mov_b32 v212, 0
    v_mov_b32 v213, 0
    v_mov_b32 v214, 0
    v_mov_b32 v215, 0
    v_mov_b32 v216, 0
    v_mov_b32 v217, 0
    v_mov_b32 v218, 0
    v_mov_b32 v219, 0
    v_mov_b32 v220, 0
    v_mov_b32 v221, 0
    v_mov_b32 v222, 0
    v_mov_b32 v223, 0
    v_mov_b32 v224, 0
    v_mov_b32 v225, 0
    v_mov_b32 v226, 0
    v_mov_b32 v227, 0
    v_mov_b32 v228, 0
    v_mov_b32 v229, 0
    v_mov_b32 v230, 0
    v_mov_b32 v231, 0
    v_mov_b32 v232, 0
    v_mov_b32 v233, 0
    v_mov_b32 v234, 0
    v_mov_b32 v235, 0
    v_mov_b32 v236, 0
    v_mov_b32 v237, 0
    v_mov_b32 v238, 0
    v_mov_b32 v239, 0
    v_mov_b32 v116, 0
    v_mov_b32 v117, 0
    v_mov_b32 v118, 0
    v_mov_b32 v119, 0
    v_mov_b32 v120, 0
    v_mov_b32 v121, 0
    v_mov_b32 v122, 0
    v_mov_b32 v123, 0
    v_mov_b32 v124, 0
    v_mov_b32 v125, 0
    v_mov_b32 v126, 0
    v_mov_b32 v127, 0
    v_mov_b32 v240, 0
    v_mov_b32 v241, 0
    v_mov_b32 v242, 0
    v_mov_b32 v243, 0
    v_mov_b32 v244, 0
    v_mov_b32 v245, 0
    v_mov_b32 v246, 0
    v_mov_b32 v247, 0
    v_mov_b32 v248, 0
    v_mov_b32 v249, 0
    v_mov_b32 v250, 0
    v_mov_b32 v251, 0
    v_mov_b32 v252, 0
    v_mov_b32 v253, 0
    v_mov_b32 v254, 0
    v_mov_b32 v255, 0
    v_mov_b32 v12, 0x3f803f80
    v_mov_b32 v13, 0x3f803f80
    v_mov_b32 v14, 0x3f803f80
    v_mov_b32 v15, 0x3f803f80
    s_add_u32 s68, s58, 4259840
    s_addc_u32 s69, s59, 0
    s_mov_b32 s70, 114688
    s_mov_b32 s71, 0x00020000
    s_mov_b32 s72, s56
    s_mov_b32 s73, s57
    s_mov_b32 s74, 256
    s_mov_b32 s75, 0x00020000
    s_add_u32 s76, s58, 4210688
    s_addc_u32 s77, s59, 0
    s_mov_b32 s78, 16384
    s_mov_b32 s79, 0x00020000
    s_and_b32 s86, s34, 3
    s_sub_u32 s86, 7, s86
    s_sub_u32 s88, s86, 1
    s_sub_u32 s89, s86, 2
    s_cmp_eq_u32 s60, 0
    s_cselect_b32 s86, s86, 99
    s_cselect_b32 s88, s88, 99
    s_cmp_eq_u32 s32, 0
    s_cselect_b32 s89, s89, 99
    s_cselect_b32 s83, 1, 99
    s_lshl_b32 s80, s61, 9
    s_lshl_b32 s81, s64, 1
    s_add_u32 s80, s80, s81
    s_mul_i32 s62, s61, 448
    s_waitcnt vmcnt(8)
    s_barrier
    ds_read_b64_tr_b16 v[32:33], v108 offset:0
    ds_read_b64_tr_b16 v[34:35], v108 offset:256
    ds_read_b128 v[16:19], v104 offset:0
    ds_read_b64_tr_b16 v[36:37], v109 offset:0
    ds_read_b64_tr_b16 v[38:39], v109 offset:256
    ds_read_b128 v[20:23], v104 offset:2048
    ds_read_b64_tr_b16 v[40:41], v108 offset:1024
    ds_read_b64_tr_b16 v[42:43], v108 offset:1280
    ds_read_b128 v[24:27], v104 offset:4096
    ds_read_b64_tr_b16 v[44:45], v109 offset:1024
    ds_read_b64_tr_b16 v[46:47], v109 offset:1280
    ds_read_b128 v[28:31], v104 offset:6144
    ds_read_b64_tr_b16 v[48:49], v108 offset:2048
    ds_read_b64_tr_b16 v[50:51], v108 offset:2304
    ds_read_b64_tr_b16 v[52:53], v109 offset:2048
    ds_read_b64_tr_b16 v[54:55], v109 offset:2304
    ds_read_b64_tr_b16 v[56:57], v115 offset:3072
    ds_read_b64_tr_b16 v[58:59], v115 offset:3328
    s_mov_b32 s31, 7
mlp_loop:
    s_cmp_lg_u32 s31, 4
    s_cbranch_scc1 mlp_h1
    v_subrev_u32 v112, s84, v112
    v_subrev_u32 v113, s84, v113
    v_subrev_u32 v114, s85, v114
mlp_h1:
    s_cmp_lg_u32 s31, s88
    s_cbranch_scc1 mlp_h2
    s_nop 7
    s_nop 7
    s_mul_i32 s63, s34, 3584*4
    s_add_u32 s63, s63, s80
    v_lshlrev_b32 v9, 4, v7
    s_mov_b32 exec_lo, 0x00010001
    s_mov_b32 exec_hi, 0x00010001
    buffer_store_dwordx4 v[116:119], v9, s[68:71], s63 offen offset:0 sc0 sc1
    buffer_store_dwordx4 v[120:123], v9, s[68:71], s63 offen offset:64 sc0 sc1
    buffer_store_dwordx4 v[124:127], v9, s[68:71], s63 offen offset:128 sc0 sc1
    buffer_store_dwordx4 v[240:243], v9, s[68:71], s63 offen offset:192 sc0 sc1
    buffer_store_dwordx4 v[244:247], v9, s[68:71], s63 offen offset:256 sc0 sc1
    buffer_store_dwordx4 v[248:251], v9, s[68:71], s63 offen offset:320 sc0 sc1
    s_sub_u32 s63, s63, s62
    buffer_store_dwordx4 v[252:255], v9, s[68:71], s63 offen offset:384 sc0 sc1
    s_mov_b64 exec, -1
mlp_h2:
    s_cmp_lg_u32 s31, s89
    s_cbranch_scc1 mlp_h3
    s_lshl_b32 s63, s35, 2
    v_mov_b32 v9, 1
    v_mov_b32 v10, 0
    s_mov_b64 exec, 1
    buffer_atomic_add v9, v10, s[72:75], s63 offen offset:128 sc1
    s_mov_b64 exec, -1
mlp_h3:
    s_cmp_lg_u32 s31, s83
    s_cbranch_scc1 mlp_h4
    v_mov_b32 v10, 0
    s_lshl_b32 s63, s35, 2
    v_and_b32 v11, 7, v2
    v_lshlrev_b32 v11, 2, v11
    buffer_load_dword v8, v10, s[72:75], s63 offen offset:128
    buffer_load_dword v9, v11, s[72:75], 0 offen
mlp_h4:
    s_waitcnt lgkmcnt(0)
    v_mfma_f32_16x16x32_bf16 v[128:131], v[32:35], v[16:19], v[128:131]
    ds_read_b64_tr_b16 v[76:77], v108 offset:14336
    v_mfma_f32_16x16x32_bf16 v[132:135], v[32:35], v[20:23], v[132:135]
    ds_read_b64_tr_b16 v[78:79], v108 offset:14592
    v_mfma_f32_16x16x32_bf16 v[136:139], v[32:35], v[24:27], v[136:139]
    ds_read_b128 v[60:63], v105 offset:0
    v_mfma_f32_16x16x32_bf16 v[140:143], v[32:35], v[28:31], v[140:143]
    ds_read_b64_tr_b16 v[80:81], v109 offset:14336
    v_mfma_f32_16x16x32_bf16 v[144:147], v[36:39], v[16:19], v[144:147]
    ds_read_b64_tr_b16 v[82:83], v109 offset:14592
    v_mfma_f32_16x16x32_bf16 v[148:151], v[36:39], v[20:23], v[148:151]
    ds_read_b128 v[64:67], v105 offset:2048
    v_mfma_f32_16x16x32_bf16 v[152:155], v[36:39], v[24:27], v[152:155]
    ds_read_b64_tr_b16 v[84:85], v108 offset:15360
    v_mfma_f32_16x16x32_bf16 v[156:159], v[36:39], v[28:31], v[156:159]
    ds_read_b64_tr_b16 v[86:87], v108 offset:15616
    v_mfma_f32_16x16x32_bf16 v[160:163], v[40:43], v[16:19], v[160:163]
    ds_read_b128 v[68:71], v105 offset:4096
    v_mfma_f32_16x16x32_bf16 v[164:167], v[40:43], v[20:23], v[164:167]
    ds_read_b64_tr_b16 v[88:89], v109 offset:15360
    v_mfma_f32_16x16x32_bf16 v[168:171], v[40:43], v[24:27], v[168:171]
    ds_read_b64_tr_b16 v[90:91], v109 offset:15616
    v_mfma_f32_16x16x32_bf16 v[172:175], v[40:43], v[28:31], v[172:175]
    ds_read_b128 v[72:75], v105 offset:6144
    v_mfma_f32_16x16x32_bf16 v[176:179], v[44:47], v[16:19], v[176:179]
    ds_read_b64_tr_b16 v[92:93], v108 offset:16384
    v_mfma_f32_16x16x32_bf16 v[180:183], v[44:47], v[20:23], v[180:183]
    ds_read_b64_tr_b16 v[94:95], v108 offset:16640
    v_mfma_f32_16x16x32_bf16 v[184:187], v[44:47], v[24:27], v[184:187]
    ds_read_b64_tr_b16 v[96:97], v109 offset:16384
    v_mfma_f32_16x16x32_bf16 v[188:191], v[44:47], v[28:31], v[188:191]
    ds_read_b64_tr_b16 v[98:99], v109 offset:16640
    v_mfma_f32_16x16x32_bf16 v[192:195], v[48:51], v[16:19], v[192:195]
    ds_read_b64_tr_b16 v[100:101], v115 offset:17408
    v_mfma_f32_16x16x32_bf16 v[196:199], v[48:51], v[20:23], v[196:199]
    ds_read_b64_tr_b16 v[102:103], v115 offset:17664
    v_mfma_f32_16x16x32_bf16 v[200:203], v[48:51], v[24:27], v[200:203]
    v_mfma_f32_16x16x32_bf16 v[204:207], v[48:51], v[28:31], v[204:207]
    v_mfma_f32_16x16x32_bf16 v[208:211], v[52:55], v[16:19], v[208:211]
    v_mfma_f32_16x16x32_bf16 v[212:215], v[52:55], v[20:23], v[212:215]
    v_mfma_f32_16x16x32_bf16 v[216:219], v[52:55], v[24:27], v[216:219]
    v_mfma_f32_16x16x32_bf16 v[220:223], v[52:55], v[28:31], v[220:223]
    v_mfma_f32_16x16x32_bf16 v[224:227], v[56:59], v[16:19], v[224:227]
    v_mfma_f32_16x16x32_bf16 v[228:231], v[56:59], v[20:23], v[228:231]
    v_mfma_f32_16x16x32_bf16 v[232:235], v[56:59], v[24:27], v[232:235]
    v_mfma_f32_16x16x32_bf16 v[236:239], v[56:59], v[28:31], v[236:239]
    s_cmp_lg_u32 s31, s86
    s_cbranch_scc1 mlp_cs_3
    v_mfma_f32_16x16x32_bf16 v[116:119], v[32:35], v[12:15], v[116:119]
    v_mfma_f32_16x16x32_bf16 v[120:123], v[36:39], v[12:15], v[120:123]
    v_mfma_f32_16x16x32_bf16 v[124:127], v[40:43], v[12:15], v[124:127]
    v_mfma_f32_16x16x32_bf16 v[240:243], v[44:47], v[12:15], v[240:243]
    v_mfma_f32_16x16x32_bf16 v[244:247], v[48:51], v[12:15], v[244:247]
    v_mfma_f32_16x16x32_bf16 v[248:251], v[52:55], v[12:15], v[248:251]
    v_mfma_f32_16x16x32_bf16 v[252:255], v[56:59], v[12:15], v[252:255]
mlp_cs_3:
    s_cmp_eq_u32 s31, s88
    s_cbranch_scc1 mlp_w1
    s_waitcnt vmcnt(2)
    s_cmp_eq_u32 s31, s83
    s_cbranch_scc1 mlp_w1
    s_waitcnt vmcnt(1)
    s_cmp_eq_u32 s31, s89
    s_cbranch_scc1 mlp_w1
    s_cmp_eq_u32 s31, 7
    s_cbranch_scc1 mlp_w1
    s_waitcnt vmcnt(0)
mlp_w1:
    s_waitcnt vmcnt(7) lgkmcnt(0)
    s_barrier
    v_mfma_f32_16x16x32_bf16 v[128:131], v[76:79], v[60:63], v[128:131]
    ds_read_b64_tr_b16 v[32:33], v110 offset:0
    v_mfma_f32_16x16x32_bf16 v[132:135], v[76:79], v[64:67], v[132:135]
    ds_read_b64_tr_b16 v[34:35], v110 offset:256
    v_mfma_f32_16x16x32_bf16 v[136:139], v[76:79], v[68:71], v[136:139]
    s_add_u32 m0, s29, 0
    s_nop 0
    buffer_load_dwordx4 v112, s[4:7], s20 offen lds
    v_mfma_f32_16x16x32_bf16 v[140:143], v[76:79], v[72:75], v[140:143]
    ds_read_b128 v[16:19], v106 offset:0
    v_mfma_f32_16x16x32_bf16 v[144:147], v[80:83], v[60:63], v[144:147]
    ds_read_b64_tr_b16 v[36:37], v111 offset:0
    v_mfma_f32_16x16x32_bf16 v[148:151], v[80:83], v[64:67], v[148:151]
    s_add_u32 m0, s29, 1024
    s_nop 0
    buffer_load_dwordx4 v113, s[4:7], s21 offen lds
    v_mfma_f32_16x16x32_bf16 v[152:155], v[80:83], v[68:71], v[152:155]
    ds_read_b64_tr_b16 v[38:39], v111 offset:256
    v_mfma_f32_16x16x32_bf16 v[156:159], v[80:83], v[72:75], v[156:159]
    ds_read_b128 v[20:23], v106 offset:2048
    v_mfma_f32_16x16x32_bf16 v[160:163], v[84:87], v[60:63], v[160:163]
    s_add_u32 m0, s29, 2048
    s_nop 0
    buffer_load_dwordx4 v112, s[4:7], s22 offen lds
    v_mfma_f32_16x16x32_bf16 v[164:167], v[84:87], v[64:67], v[164:167]
    ds_read_b64_tr_b16 v[40:41], v110 offset:1024
    v_mfma_f32_16x16x32_bf16 v[168:171], v[84:87], v[68:71], v[168:171]
    ds_read_b64_tr_b16 v[42:43], v110 offset:1280
    v_mfma_f32_16x16x32_bf16 v[172:175], v[84:87], v[72:75], v[172:175]
    s_add_u32 m0, s29, 3072
    s_nop 0
    buffer_load_dwordx4 v113, s[4:7], s23 offen lds
    v_mfma_f32_16x16x32_bf16 v[176:179], v[88:91], v[60:63], v[176:179]
    ds_read_b128 v[24:27], v106 offset:4096
    v_mfma_f32_16x16x32_bf16 v[180:183], v[88:91], v[64:67], v[180:183]
    ds_read_b64_tr_b16 v[44:45], v111 offset:1024
    v_mfma_f32_16x16x32_bf16 v[184:187], v[88:91], v[68:71], v[184:187]
    s_add_u32 m0, s30, 0
    s_nop 0
    buffer_load_dwordx4 v114, s[8:11], s24 offen lds
    v_mfma_f32_16x16x32_bf16 v[188:191], v[88:91], v[72:75], v[188:191]
    ds_read_b64_tr_b16 v[46:47], v111 offset:1280
    v_mfma_f32_16x16x32_bf16 v[192:195], v[92:95], v[60:63], v[192:195]
    ds_read_b128 v[28:31], v106 offset:6144
    v_mfma_f32_16x16x32_bf16 v[196:199], v[92:95], v[64:67], v[196:199]
    s_add_u32 m0, s30, 1024
    s_nop 0
    buffer_load_dwordx4 v114, s[8:11], s25 offen lds
    v_mfma_f32_16x16x32_bf16 v[200:203], v[92:95], v[68:71], v[200:203]
    ds_read_b64_tr_b16 v[48:49], v110 offset:2048
    v_mfma_f32_16x16x32_bf16 v[204:207], v[92:95], v[72:75], v[204:207]
    ds_read_b64_tr_b16 v[50:51], v110 offset:2304
    v_mfma_f32_16x16x32_bf16 v[208:211], v[96:99], v[60:63], v[208:211]
    s_add_u32 m0, s30, 2048
    s_nop 0
    buffer_load_dwordx4 v114, s[8:11], s26 offen lds
    v_mfma_f32_16x16x32_bf16 v[212:215], v[96:99], v[64:67], v[212:215]
    ds_read_b64_tr_b16 v[52:53], v111 offset:2048
    v_mfma_f32_16x16x32_bf16 v[216:219], v[96:99], v[68:71], v[216:219]
    ds_read_b64_tr_b16 v[54:55], v111 offset:2304
    v_mfma_f32_16x16x32_bf16 v[220:223], v[96:99], v[72:75], v[220:223]
    s_cmp_lg_u32 s61, 0
    s_cbranch_scc1 mlp_skip_4
    s_add_u32 m0, s30, 3072
    s_nop 0
    buffer_load_dwordx4 v114, s[8:11], s27 offen lds
    mlp_skip_4:
    v_mfma_f32_16x16x32_bf16 v[224:227], v[100:103], v[60:63], v[224:227]
    ds_read_b64_tr_b16 v[56:57], v5 offset:3072
    v_mfma_f32_16x16x32_bf16 v[228:231], v[100:103], v[64:67], v[228:231]
    ds_read_b64_tr_b16 v[58:59], v5 offset:3328
    v_mfma_f32_16x16x32_bf16 v[232:235], v[100:103], v[68:71], v[232:235]
    v_add_u32 v112, 128, v112
    v_add_u32 v113, 128, v113
    v_add_u32 v114, s28, v114
    v_mfma_f32_16x16x32_bf16 v[236:239], v[100:103], v[72:75], v[236:239]
    s_cmp_lg_u32 s31, s86
    s_cbranch_scc1 mlp_cs_5
    v_mfma_f32_16x16x32_bf16 v[116:119], v[76:79], v[12:15], v[116:119]
    v_mfma_f32_16x16x32_bf16 v[120:123], v[80:83], v[12:15], v[120:123]
    v_mfma_f32_16x16x32_bf16 v[124:127], v[84:87], v[12:15], v[124:127]
    v_mfma_f32_16x16x32_bf16 v[240:243], v[88:91], v[12:15], v[240:243]
    v_mfma_f32_16x16x32_bf16 v[244:247], v[92:95], v[12:15], v[244:247]
    v_mfma_f32_16x16x32_bf16 v[248:251], v[96:99], v[12:15], v[248:251]
    v_mfma_f32_16x16x32_bf16 v[252:255], v[100:103], v[12:15], v[252:255]
mlp_cs_5:
    s_waitcnt lgkmcnt(0)
    v_mfma_f32_16x16x32_bf16 v[128:131], v[32:35], v[16:19], v[128:131]
    ds_read_b64_tr_b16 v[76:77], v110 offset:14336
    v_mfma_f32_16x16x32_bf16 v[132:135], v[32:35], v[20:23], v[132:135]
    ds_read_b64_tr_b16 v[78:79], v110 offset:14592
    v_mfma_f32_16x16x32_bf16 v[136:139], v[32:35], v[24:27], v[136:139]
    ds_read_b128 v[60:63], v107 offset:0
    v_mfma_f32_16x16x32_bf16 v[140:143], v[32:35], v[28:31], v[140:143]
    ds_read_b64_tr_b16 v[80:81], v111 offset:14336
    v_mfma_f32_16x16x32_bf16 v[144:147], v[36:39], v[16:19], v[144:147]
    ds_read_b64_tr_b16 v[82:83], v111 offset:14592
    v_mfma_f32_16x16x32_bf16 v[148:151], v[36:39], v[20:23], v[148:151]
    ds_read_b128 v[64:67], v107 offset:2048
    v_mfma_f32_16x16x32_bf16 v[152:155], v[36:39], v[24:27], v[152:155]
    ds_read_b64_tr_b16 v[84:85], v110 offset:15360
    v_mfma_f32_16x16x32_bf16 v[156:159], v[36:39], v[28:31], v[156:159]
    ds_read_b64_tr_b16 v[86:87], v110 offset:15616
    v_mfma_f32_16x16x32_bf16 v[160:163], v[40:43], v[16:19], v[160:163]
    ds_read_b128 v[68:71], v107 offset:4096
    v_mfma_f32_16x16x32_bf16 v[164:167], v[40:43], v[20:23], v[164:167]
    ds_read_b64_tr_b16 v[88:89], v111 offset:15360
    v_mfma_f32_16x16x32_bf16 v[168:171], v[40:43], v[24:27], v[168:171]
    ds_read_b64_tr_b16 v[90:91], v111 offset:15616
    v_mfma_f32_16x16x32_bf16 v[172:175], v[40:43], v[28:31], v[172:175]
    ds_read_b128 v[72:75], v107 offset:6144
    v_mfma_f32_16x16x32_bf16 v[176:179], v[44:47], v[16:19], v[176:179]
    ds_read_b64_tr_b16 v[92:93], v110 offset:16384
    v_mfma_f32_16x16x32_bf16 v[180:183], v[44:47], v[20:23], v[180:183]
    ds_read_b64_tr_b16 v[94:95], v110 offset:16640
    v_mfma_f32_16x16x32_bf16 v[184:187], v[44:47], v[24:27], v[184:187]
    ds_read_b64_tr_b16 v[96:97], v111 offset:16384
    v_mfma_f32_16x16x32_bf16 v[188:191], v[44:47], v[28:31], v[188:191]
    ds_read_b64_tr_b16 v[98:99], v111 offset:16640
    v_mfma_f32_16x16x32_bf16 v[192:195], v[48:51], v[16:19], v[192:195]
    ds_read_b64_tr_b16 v[100:101], v5 offset:17408
    v_mfma_f32_16x16x32_bf16 v[196:199], v[48:51], v[20:23], v[196:199]
    ds_read_b64_tr_b16 v[102:103], v5 offset:17664
    v_mfma_f32_16x16x32_bf16 v[200:203], v[48:51], v[24:27], v[200:203]
    v_mfma_f32_16x16x32_bf16 v[204:207], v[48:51], v[28:31], v[204:207]
    v_mfma_f32_16x16x32_bf16 v[208:211], v[52:55], v[16:19], v[208:211]
    v_mfma_f32_16x16x32_bf16 v[212:215], v[52:55], v[20:23], v[212:215]
    v_mfma_f32_16x16x32_bf16 v[216:219], v[52:55], v[24:27], v[216:219]
    v_mfma_f32_16x16x32_bf16 v[220:223], v[52:55], v[28:31], v[220:223]
    v_mfma_f32_16x16x32_bf16 v[224:227], v[56:59], v[16:19], v[224:227]
    v_mfma_f32_16x16x32_bf16 v[228:231], v[56:59], v[20:23], v[228:231]
    v_mfma_f32_16x16x32_bf16 v[232:235], v[56:59], v[24:27], v[232:235]
    v_mfma_f32_16x16x32_bf16 v[236:239], v[56:59], v[28:31], v[236:239]
    s_cmp_lg_u32 s31, s86
    s_cbranch_scc1 mlp_cs_6
    v_mfma_f32_16x16x32_bf16 v[116:119], v[32:35], v[12:15], v[116:119]
    v_mfma_f32_16x16x32_bf16 v[120:123], v[36:39], v[12:15], v[120:123]
    v_mfma_f32_16x16x32_bf16 v[124:127], v[40:43], v[12:15], v[124:127]
    v_mfma_f32_16x16x32_bf16 v[240:243], v[44:47], v[12:15], v[240:243]
    v_mfma_f32_16x16x32_bf16 v[244:247], v[48:51], v[12:15], v[244:247]
    v_mfma_f32_16x16x32_bf16 v[248:251], v[52:55], v[12:15], v[248:251]
    v_mfma_f32_16x16x32_bf16 v[252:255], v[56:59], v[12:15], v[252:255]
mlp_cs_6:
    s_waitcnt vmcnt(0) lgkmcnt(0)
    s_barrier
    v_mfma_f32_16x16x32_bf16 v[128:131], v[76:79], v[60:63], v[128:131]
    ds_read_b64_tr_b16 v[32:33], v108 offset:0
    v_mfma_f32_16x16x32_bf16 v[132:135], v[76:79], v[64:67], v[132:135]
    ds_read_b64_tr_b16 v[34:35], v108 offset:256
    v_mfma_f32_16x16x32_bf16 v[136:139], v[76:79], v[68:71], v[136:139]
    s_add_u32 m0, s29, 61440
    s_nop 0
    buffer_load_dwordx4 v112, s[4:7], s20 offen lds
    v_mfma_f32_16x16x32_bf16 v[140:143], v[76:79], v[72:75], v[140:143]
    ds_read_b128 v[16:19], v104 offset:0
    v_mfma_f32_16x16x32_bf16 v[144:147], v[80:83], v[60:63], v[144:147]
    ds_read_b64_tr_b16 v[36:37], v109 offset:0
    v_mfma_f32_16x16x32_bf16 v[148:151], v[80:83], v[64:67], v[148:151]
    s_add_u32 m0, s29, 62464
    s_nop 0
    buffer_load_dwordx4 v113, s[4:7], s21 offen lds
    v_mfma_f32_16x16x32_bf16 v[152:155], v[80:83], v[68:71], v[152:155]
    ds_read_b64_tr_b16 v[38:39], v109 offset:256
    v_mfma_f32_16x16x32_bf16 v[156:159], v[80:83], v[72:75], v[156:159]
    ds_read_b128 v[20:23], v104 offset:2048
    v_mfma_f32_16x16x32_bf16 v[160:163], v[84:87], v[60:63], v[160:163]
    s_add_u32 m0, s29, 63488
    s_nop 0
    buffer_load_dwordx4 v112, s[4:7], s22 offen lds
    v_mfma_f32_16x16x32_bf16 v[164:167], v[84:87], v[64:67], v[164:167]
    ds_read_b64_tr_b16 v[40:41], v108 offset:1024
    v_mfma_f32_16x16x32_bf16 v[168:171], v[84:87], v[68:71], v[168:171]
    ds_read_b64_tr_b16 v[42:43], v108 offset:1280
    v_mfma_f32_16x16x32_bf16 v[172:175], v[84:87], v[72:75], v[172:175]
    s_add_u32 m0, s29, 64512
    s_nop 0
    buffer_load_dwordx4 v113, s[4:7], s23 offen lds
    v_mfma_f32_16x16x32_bf16 v[176:179], v[88:91], v[60:63], v[176:179]
    ds_read_b128 v[24:27], v104 offset:4096
    v_mfma_f32_16x16x32_bf16 v[180:183], v[88:91], v[64:67], v[180:183]
    ds_read_b64_tr_b16 v[44:45], v109 offset:1024
    v_mfma_f32_16x16x32_bf16 v[184:187], v[88:91], v[68:71], v[184:187]
    s_add_u32 m0, s30, 61440
    s_nop 0
    buffer_load_dwordx4 v114, s[8:11], s24 offen lds
    v_mfma_f32_16x16x32_bf16 v[188:191], v[88:91], v[72:75], v[188:191]
    ds_read_b64_tr_b16 v[46:47], v109 offset:1280
    v_mfma_f32_16x16x32_bf16 v[192:195], v[92:95], v[60:63], v[192:195]
    ds_read_b128 v[28:31], v104 offset:6144
    v_mfma_f32_16x16x32_bf16 v[196:199], v[92:95], v[64:67], v[196:199]
    s_add_u32 m0, s30, 62464
    s_nop 0
    buffer_load_dwordx4 v114, s[8:11], s25 offen lds
    v_mfma_f32_16x16x32_bf16 v[200:203], v[92:95], v[68:71], v[200:203]
    ds_read_b64_tr_b16 v[48:49], v108 offset:2048
    v_mfma_f32_16x16x32_bf16 v[204:207], v[92:95], v[72:75], v[204:207]
    ds_read_b64_tr_b16 v[50:51], v108 offset:2304
    v_mfma_f32_16x16x32_bf16 v[208:211], v[96:99], v[60:63], v[208:211]
    s_add_u32 m0, s30, 63488
    s_nop 0
    buffer_load_dwordx4 v114, s[8:11], s26 offen lds
    v_mfma_f32_16x16x32_bf16 v[212:215], v[96:99], v[64:67], v[212:215]
    ds_read_b64_tr_b16 v[52:53], v109 offset:2048
    v_mfma_f32_16x16x32_bf16 v[216:219], v[96:99], v[68:71], v[216:219]
    ds_read_b64_tr_b16 v[54:55], v109 offset:2304
    v_mfma_f32_16x16x32_bf16 v[220:223], v[96:99], v[72:75], v[220:223]
    s_cmp_lg_u32 s61, 0
    s_cbranch_scc1 mlp_skip_7
    s_add_u32 m0, s30, 64512
    s_nop 0
    buffer_load_dwordx4 v114, s[8:11], s27 offen lds
    mlp_skip_7:
    v_mfma_f32_16x16x32_bf16 v[224:227], v[100:103], v[60:63], v[224:227]
    ds_read_b64_tr_b16 v[56:57], v115 offset:3072
    v_mfma_f32_16x16x32_bf16 v[228:231], v[100:103], v[64:67], v[228:231]
    ds_read_b64_tr_b16 v[58:59], v115 offset:3328
    v_mfma_f32_16x16x32_bf16 v[232:235], v[100:103], v[68:71], v[232:235]
    v_add_u32 v112, 128, v112
    v_add_u32 v113, 128, v113
    v_add_u32 v114, s28, v114
    v_mfma_f32_16x16x32_bf16 v[236:239], v[100:103], v[72:75], v[236:239]
    s_cmp_lg_u32 s31, s86
    s_cbranch_scc1 mlp_cs_8
    v_mfma_f32_16x16x32_bf16 v[116:119], v[76:79], v[12:15], v[116:119]
    v_mfma_f32_16x16x32_bf16 v[120:123], v[80:83], v[12:15], v[120:123]
    v_mfma_f32_16x16x32_bf16 v[124:127], v[84:87], v[12:15], v[124:127]
    v_mfma_f32_16x16x32_bf16 v[240:243], v[88:91], v[12:15], v[240:243]
    v_mfma_f32_16x16x32_bf16 v[244:247], v[92:95], v[12:15], v[244:247]
    v_mfma_f32_16x16x32_bf16 v[248:251], v[96:99], v[12:15], v[248:251]
    v_mfma_f32_16x16x32_bf16 v[252:255], v[100:103], v[12:15], v[252:255]
mlp_cs_8:
    s_sub_u32 s31, s31, 1
    s_cmp_lg_u32 s31, 0
    s_cbranch_scc1 mlp_loop
    s_cmp_lg_u32 s32, 0
    s_cbranch_scc1 mlp_ready
    s_mov_b32 s81, 0x100000
mlp_poll:
    v_lshl_add_u32 v9, v8, 8, v9
    v_cmp_eq_u32 vcc, 0x810, v9
    s_cmp_eq_u32 vcc_lo, -1
    s_cbranch_scc1 mlp_ready
    s_sleep 16
    v_mov_b32 v10, 0
    s_lshl_b32 s63, s35, 2
    v_and_b32 v11, 7, v2
    v_lshlrev_b32 v11, 2, v11
    buffer_load_dword v8, v10, s[72:75], s63 offen offset:128 sc0 sc1
    buffer_load_dword v9, v11, s[72:75], 0 offen sc0 sc1
    s_waitcnt vmcnt(0)
    s_sub_u32 s81, s81, 1
    s_cmp_lg_u32 s81, 0
    s_cbranch_scc1 mlp_poll
mlp_ready:
    s_waitcnt lgkmcnt(0)
    v_mfma_f32_16x16x32_bf16 v[128:131], v[32:35], v[16:19], v[128:131]
    ds_read_b64_tr_b16 v[76:77], v108 offset:14336
    v_mfma_f32_16x16x32_bf16 v[132:135], v[32:35], v[20:23], v[132:135]
    ds_read_b64_tr_b16 v[78:79], v108 offset:14592
    v_mfma_f32_16x16x32_bf16 v[136:139], v[32:35], v[24:27], v[136:139]
    ds_read_b128 v[60:63], v105 offset:0
    v_mfma_f32_16x16x32_bf16 v[140:143], v[32:35], v[28:31], v[140:143]
    ds_read_b64_tr_b16 v[80:81], v109 offset:14336
    v_mfma_f32_16x16x32_bf16 v[144:147], v[36:39], v[16:19], v[144:147]
    ds_read_b64_tr_b16 v[82:83], v109 offset:14592
    v_mfma_f32_16x16x32_bf16 v[148:151], v[36:39], v[20:23], v[148:151]
    ds_read_b128 v[64:67], v105 offset:2048
    v_mfma_f32_16x16x32_bf16 v[152:155], v[36:39], v[24:27], v[152:155]
    ds_read_b64_tr_b16 v[84:85], v108 offset:15360
    v_mfma_f32_16x16x32_bf16 v[156:159], v[36:39], v[28:31], v[156:159]
    ds_read_b64_tr_b16 v[86:87], v108 offset:15616
    v_mfma_f32_16x16x32_bf16 v[160:163], v[40:43], v[16:19], v[160:163]
    ds_read_b128 v[68:71], v105 offset:4096
    v_mfma_f32_16x16x32_bf16 v[164:167], v[40:43], v[20:23], v[164:167]
    ds_read_b64_tr_b16 v[88:89], v109 offset:15360
    v_mfma_f32_16x16x32_bf16 v[168:171], v[40:43], v[24:27], v[168:171]
    ds_read_b64_tr_b16 v[90:91], v109 offset:15616
    v_mfma_f32_16x16x32_bf16 v[172:175], v[40:43], v[28:31], v[172:175]
    ds_read_b128 v[72:75], v105 offset:6144
    v_mfma_f32_16x16x32_bf16 v[176:179], v[44:47], v[16:19], v[176:179]
    ds_read_b64_tr_b16 v[92:93], v108 offset:16384
    v_mfma_f32_16x16x32_bf16 v[180:183], v[44:47], v[20:23], v[180:183]
    ds_read_b64_tr_b16 v[94:95], v108 offset:16640
    v_mfma_f32_16x16x32_bf16 v[184:187], v[44:47], v[24:27], v[184:187]
    ds_read_b64_tr_b16 v[96:97], v109 offset:16384
    v_mfma_f32_16x16x32_bf16 v[188:191], v[44:47], v[28:31], v[188:191]
    ds_read_b64_tr_b16 v[98:99], v109 offset:16640
    v_mfma_f32_16x16x32_bf16 v[192:195], v[48:51], v[16:19], v[192:195]
    ds_read_b64_tr_b16 v[100:101], v115 offset:17408
    v_mfma_f32_16x16x32_bf16 v[196:199], v[48:51], v[20:23], v[196:199]
    ds_read_b64_tr_b16 v[102:103], v115 offset:17664
    v_mfma_f32_16x16x32_bf16 v[200:203], v[48:51], v[24:27], v[200:203]
    v_mfma_f32_16x16x32_bf16 v[204:207], v[48:51], v[28:31], v[204:207]
    v_mfma_f32_16x16x32_bf16 v[208:211], v[52:55], v[16:19], v[208:211]
    v_mfma_f32_16x16x32_bf16 v[212:215], v[52:55], v[20:23], v[212:215]
    v_mfma_f32_16x16x32_bf16 v[216:219], v[52:55], v[24:27], v[216:219]
    v_mfma_f32_16x16x32_bf16 v[220:223], v[52:55], v[28:31], v[220:223]
    v_mfma_f32_16x16x32_bf16 v[224:227], v[56:59], v[16:19], v[224:227]
    v_mfma_f32_16x16x32_bf16 v[228:231], v[56:59], v[20:23], v[228:231]
    v_mfma_f32_16x16x32_bf16 v[232:235], v[56:59], v[24:27], v[232:235]
    v_mfma_f32_16x16x32_bf16 v[236:239], v[56:59], v[28:31], v[236:239]
    s_waitcnt vmcnt(0) lgkmcnt(0)
    s_barrier
    v_lshlrev_b32 v112, 4, v2
    s_mul_i32 s63, s32, 3584*4
    s_lshl_b32 s66, s64, 1
    s_add_u32 s63, s63, s66
    v_lshlrev_b32 v113, 2, v2
    s_lshl_b32 s66, s34, 11
    s_lshl_b32 s67, s32, 8
    s_add_u32 s66, s66, s67
    v_lshlrev_b32 v114, 3, v7
    s_add_u32 s40, s58, 4194304
    s_addc_u32 s41, s59, 0
    s_mov_b32 s42, 16384
    s_mov_b32 s43, 0x00020000
    v_lshlrev_b32 v14, 7, v7
    v_lshl_add_u32 v14, v6, 2, v14
    s_and_b32 s44, s32, 3
    s_lshl_b32 s45, s44, 9
    s_lshl_b32 s46, s34, 11
    s_add_u32 s45, s45, s46
    v_mfma_f32_16x16x32_bf16 v[128:131], v[76:79], v[60:63], v[128:131]
    ds_read_b64_tr_b16 v[32:33], v110 offset:0
    v_mfma_f32_16x16x32_bf16 v[132:135], v[76:79], v[64:67], v[132:135]
    ds_read_b64_tr_b16 v[34:35], v110 offset:256
    v_mfma_f32_16x16x32_bf16 v[136:139], v[76:79], v[68:71], v[136:139]
    buffer_load_dword v13, v14, s[40:43], s45 offen
    v_mfma_f32_16x16x32_bf16 v[140:143], v[76:79], v[72:75], v[140:143]
    ds_read_b128 v[16:19], v106 offset:0
    v_mfma_f32_16x16x32_bf16 v[144:147], v[80:83], v[60:63], v[144:147]
    ds_read_b64_tr_b16 v[36:37], v111 offset:0
    v_mfma_f32_16x16x32_bf16 v[148:151], v[80:83], v[64:67], v[148:151]
    buffer_load_dwordx4 v[8:11], v112, s[68:71], s63 offen
    v_mfma_f32_16x16x32_bf16 v[152:155], v[80:83], v[68:71], v[152:155]
    ds_read_b64_tr_b16 v[38:39], v111 offset:256
    v_mfma_f32_16x16x32_bf16 v[156:159], v[80:83], v[72:75], v[156:159]
    ds_read_b128 v[20:23], v106 offset:2048
    v_mfma_f32_16x16x32_bf16 v[160:163], v[84:87], v[60:63], v[160:163]
    buffer_load_dword v12, v113, s[76:79], s66 offen
    v_mfma_f32_16x16x32_bf16 v[164:167], v[84:87], v[64:67], v[164:167]
    ds_read_b64_tr_b16 v[40:41], v110 offset:1024
    v_mfma_f32_16x16x32_bf16 v[168:171], v[84:87], v[68:71], v[168:171]
    ds_read_b64_tr_b16 v[42:43], v110 offset:1280
    v_mfma_f32_16x16x32_bf16 v[172:175], v[84:87], v[72:75], v[172:175]
    ds_read_b128 v[24:27], v106 offset:4096
    v_mfma_f32_16x16x32_bf16 v[176:179], v[88:91], v[60:63], v[176:179]
    ds_read_b64_tr_b16 v[44:45], v111 offset:1024
    v_mfma_f32_16x16x32_bf16 v[180:183], v[88:91], v[64:67], v[180:183]
    ds_read_b64_tr_b16 v[46:47], v111 offset:1280
    v_mfma_f32_16x16x32_bf16 v[184:187], v[88:91], v[68:71], v[184:187]
    ds_read_b128 v[28:31], v106 offset:6144
    v_mfma_f32_16x16x32_bf16 v[188:191], v[88:91], v[72:75], v[188:191]
    ds_read_b64_tr_b16 v[48:49], v110 offset:2048
    v_mfma_f32_16x16x32_bf16 v[192:195], v[92:95], v[60:63], v[192:195]
    ds_read_b64_tr_b16 v[50:51], v110 offset:2304
    v_mfma_f32_16x16x32_bf16 v[196:199], v[92:95], v[64:67], v[196:199]
    ds_read_b64_tr_b16 v[52:53], v111 offset:2048
    v_mfma_f32_16x16x32_bf16 v[200:203], v[92:95], v[68:71], v[200:203]
    ds_read_b64_tr_b16 v[54:55], v111 offset:2304
    v_mfma_f32_16x16x32_bf16 v[204:207], v[92:95], v[72:75], v[204:207]
    ds_read_b64_tr_b16 v[56:57], v5 offset:3072
    v_mfma_f32_16x16x32_bf16 v[208:211], v[96:99], v[60:63], v[208:211]
    ds_read_b64_tr_b16 v[58:59], v5 offset:3328
    v_mfma_f32_16x16x32_bf16 v[212:215], v[96:99], v[64:67], v[212:215]
    v_mfma_f32_16x16x32_bf16 v[216:219], v[96:99], v[68:71], v[216:219]
    v_mfma_f32_16x16x32_bf16 v[220:223], v[96:99], v[72:75], v[220:223]
    v_mfma_f32_16x16x32_bf16 v[224:227], v[100:103], v[60:63], v[224:227]
    v_mfma_f32_16x16x32_bf16 v[228:231], v[100:103], v[64:67], v[228:231]
    v_mfma_f32_16x16x32_bf16 v[232:235], v[100:103], v[68:71], v[232:235]
    v_mfma_f32_16x16x32_bf16 v[236:239], v[100:103], v[72:75], v[236:239]
    s_waitcnt lgkmcnt(0)
    v_mfma_f32_16x16x32_bf16 v[128:131], v[32:35], v[16:19], v[128:131]
    ds_read_b64_tr_b16 v[76:77], v110 offset:14336
    v_mfma_f32_16x16x32_bf16 v[132:135], v[32:35], v[20:23], v[132:135]
    ds_read_b64_tr_b16 v[78:79], v110 offset:14592
    v_mfma_f32_16x16x32_bf16 v[136:139], v[32:35], v[24:27], v[136:139]
    ds_read_b128 v[60:63], v107 offset:0
    v_mfma_f32_16x16x32_bf16 v[140:143], v[32:35], v[28:31], v[140:143]
    ds_read_b64_tr_b16 v[80:81], v111 offset:14336
    v_mfma_f32_16x16x32_bf16 v[144:147], v[36:39], v[16:19], v[144:147]
    ds_read_b64_tr_b16 v[82:83], v111 offset:14592
    v_mfma_f32_16x16x32_bf16 v[148:151], v[36:39], v[20:23], v[148:151]
    ds_read_b128 v[64:67], v107 offset:2048
    v_mfma_f32_16x16x32_bf16 v[152:155], v[36:39], v[24:27], v[152:155]
    ds_read_b64_tr_b16 v[84:85], v110 offset:15360
    v_mfma_f32_16x16x32_bf16 v[156:159], v[36:39], v[28:31], v[156:159]
    ds_read_b64_tr_b16 v[86:87], v110 offset:15616
    v_mfma_f32_16x16x32_bf16 v[160:163], v[40:43], v[16:19], v[160:163]
    ds_read_b128 v[68:71], v107 offset:4096
    v_mfma_f32_16x16x32_bf16 v[164:167], v[40:43], v[20:23], v[164:167]
    ds_read_b64_tr_b16 v[88:89], v111 offset:15360
    v_mfma_f32_16x16x32_bf16 v[168:171], v[40:43], v[24:27], v[168:171]
    ds_read_b64_tr_b16 v[90:91], v111 offset:15616
    v_mfma_f32_16x16x32_bf16 v[172:175], v[40:43], v[28:31], v[172:175]
    ds_read_b128 v[72:75], v107 offset:6144
    v_mfma_f32_16x16x32_bf16 v[176:179], v[44:47], v[16:19], v[176:179]
    ds_read_b64_tr_b16 v[92:93], v110 offset:16384
    v_mfma_f32_16x16x32_bf16 v[180:183], v[44:47], v[20:23], v[180:183]
    ds_read_b64_tr_b16 v[94:95], v110 offset:16640
    v_mfma_f32_16x16x32_bf16 v[184:187], v[44:47], v[24:27], v[184:187]
    ds_read_b64_tr_b16 v[96:97], v111 offset:16384
    v_mfma_f32_16x16x32_bf16 v[188:191], v[44:47], v[28:31], v[188:191]
    ds_read_b64_tr_b16 v[98:99], v111 offset:16640
    v_mfma_f32_16x16x32_bf16 v[192:195], v[48:51], v[16:19], v[192:195]
    ds_read_b64_tr_b16 v[100:101], v5 offset:17408
    v_mfma_f32_16x16x32_bf16 v[196:199], v[48:51], v[20:23], v[196:199]
    ds_read_b64_tr_b16 v[102:103], v5 offset:17664
    v_mfma_f32_16x16x32_bf16 v[200:203], v[48:51], v[24:27], v[200:203]
    v_mfma_f32_16x16x32_bf16 v[204:207], v[48:51], v[28:31], v[204:207]
    v_mfma_f32_16x16x32_bf16 v[208:211], v[52:55], v[16:19], v[208:211]
    v_mfma_f32_16x16x32_bf16 v[212:215], v[52:55], v[20:23], v[212:215]
    v_mfma_f32_16x16x32_bf16 v[216:219], v[52:55], v[24:27], v[216:219]
    v_mfma_f32_16x16x32_bf16 v[220:223], v[52:55], v[28:31], v[220:223]
    v_mfma_f32_16x16x32_bf16 v[224:227], v[56:59], v[16:19], v[224:227]
    v_mfma_f32_16x16x32_bf16 v[228:231], v[56:59], v[20:23], v[228:231]
    v_mfma_f32_16x16x32_bf16 v[232:235], v[56:59], v[24:27], v[232:235]
    v_mfma_f32_16x16x32_bf16 v[236:239], v[56:59], v[28:31], v[236:239]
    s_mul_i32 s63, s32, 1040
    s_add_u32 s63, s63, 122880
    v_add_u32 v112, s63, v112
    s_add_u32 s67, s67, 131328
    v_add_u32 v113, s67, v113
    s_waitcnt vmcnt(0)
    ds_write_b128 v112, v[8:11]
    ds_write_b32 v113, v12
    s_lshl_b32 s44, s44, 8
    s_add_u32 s44, s44, 136192
    v_lshlrev_b32 v14, 2, v2
    v_add_u32 v14, s44, v14
    ds_write_b32 v14, v13
    s_lshl_b32 s44, s60, 8
    s_add_u32 s44, s44, 136192
    v_lshlrev_b32 v15, 2, v6
    v_add_u32 v15, s44, v15
    v_and_b32 v112, 7, v6
    s_movk_i32 s63, 1040
    v_mul_lo_u32 v112, v112, s63
    v_lshl_add_u32 v112, v7, 4, v112
    s_lshl_b32 s63, s61, 9
    s_add_u32 s63, s63, 122880
    v_add_u32 v112, s63, v112
    v_subrev_u32 v12, s62, v112
    s_lshr_b32 s62, s62, 1
    s_lshl_b32 s63, s60, 9
    s_add_u32 s63, s63, 131328
    v_lshlrev_b32 v113, 3, v6
    v_add_u32 v113, s63, v113
    s_lshl_b32 s66, s61, 8
    s_add_u32 s66, s66, 135168
    v_add_u32 v114, s66, v114
    v_subrev_u32 v13, s62, v114
    s_waitcnt lgkmcnt(0)
    s_barrier
    v_mfma_f32_16x16x32_bf16 v[128:131], v[76:79], v[60:63], v[128:131]
    ds_read_b64 v[16:17], v114 offset:0
    ds_read_b128 v[116:119], v112 offset:0
    v_mfma_f32_16x16x32_bf16 v[132:135], v[76:79], v[64:67], v[132:135]
    ds_read_b64 v[18:19], v114 offset:32
    ds_read_b128 v[120:123], v112 offset:64
    v_mfma_f32_16x16x32_bf16 v[136:139], v[76:79], v[68:71], v[136:139]
    ds_read_b64 v[20:21], v114 offset:64
    ds_read_b128 v[124:127], v112 offset:128
    v_mfma_f32_16x16x32_bf16 v[140:143], v[76:79], v[72:75], v[140:143]
    ds_read_b64 v[22:23], v114 offset:96
    ds_read_b128 v[240:243], v112 offset:192
    v_mfma_f32_16x16x32_bf16 v[144:147], v[80:83], v[60:63], v[144:147]
    ds_read_b64 v[24:25], v114 offset:128
    ds_read_b128 v[244:247], v112 offset:256
    v_mfma_f32_16x16x32_bf16 v[148:151], v[80:83], v[64:67], v[148:151]
    ds_read_b64 v[26:27], v114 offset:160
    ds_read_b128 v[248:251], v112 offset:320
    v_mfma_f32_16x16x32_bf16 v[152:155], v[80:83], v[68:71], v[152:155]
    ds_read_b64 v[28:29], v13 offset:192
    ds_read_b128 v[252:255], v12 offset:384
    v_mfma_f32_16x16x32_bf16 v[156:159], v[80:83], v[72:75], v[156:159]
    ds_read_b32 v56, v15 offset:0
    ds_read_b32 v57, v15 offset:64
    ds_read_b32 v58, v15 offset:128
    ds_read_b32 v59, v15 offset:192
    v_mfma_f32_16x16x32_bf16 v[160:163], v[84:87], v[60:63], v[160:163]
    ds_read_b64 v[8:9], v113 offset:0
    ds_read_b64 v[10:11], v113 offset:128
    ds_read_b64 v[12:13], v113 offset:256
    ds_read_b64 v[14:15], v113 offset:384
    v_mfma_f32_16x16x32_bf16 v[164:167], v[84:87], v[64:67], v[164:167]
    v_mfma_f32_16x16x32_bf16 v[168:171], v[84:87], v[68:71], v[168:171]
    s_waitcnt lgkmcnt(0)
    v_mfma_f32_16x16x32_bf16 v[172:175], v[84:87], v[72:75], v[172:175]
    v_add_f32_dpp v116, v116, v116 quad_perm:[1,0,3,2] row_mask:0xf bank_mask:0xf
    v_add_f32_dpp v117, v117, v117 quad_perm:[1,0,3,2] row_mask:0xf bank_mask:0xf
    v_add_f32_dpp v118, v118, v118 quad_perm:[1,0,3,2] row_mask:0xf bank_mask:0xf
    v_add_f32_dpp v119, v119, v119 quad_perm:[1,0,3,2] row_mask:0xf bank_mask:0xf
    v_add_f32_dpp v120, v120, v120 quad_perm:[1,0,3,2] row_mask:0xf bank_mask:0xf
    v_mfma_f32_16x16x32_bf16 v[176:179], v[88:91], v[60:63], v[176:179]
    v_add_f32_dpp v121, v121, v121 quad_perm:[1,0,3,2] row_mask:0xf bank_mask:0xf
    v_add_f32_dpp v122, v122, v122 quad_perm:[1,0,3,2] row_mask:0xf bank_mask:0xf
    v_add_f32_dpp v123, v123, v123 quad_perm:[1,0,3,2] row_mask:0xf bank_mask:0xf
    v_add_f32_dpp v124, v124, v124 quad_perm:[1,0,3,2] row_mask:0xf bank_mask:0xf
    v_add_f32_dpp v125, v125, v125 quad_perm:[1,0,3,2] row_mask:0xf bank_mask:0xf
    v_mfma_f32_16x16x32_bf16 v[180:183], v[88:91], v[64:67], v[180:183]
    v_add_f32_dpp v126, v126, v126 quad_perm:[1,0,3,2] row_mask:0xf bank_mask:0xf
    v_add_f32_dpp v127, v127, v127 quad_perm:[1,0,3,2] row_mask:0xf bank_mask:0xf
    v_add_f32_dpp v240, v240, v240 quad_perm:[1,0,3,2] row_mask:0xf bank_mask:0xf
    v_add_f32_dpp v241, v241, v241 quad_perm:[1,0,3,2] row_mask:0xf bank_mask:0xf
    v_add_f32_dpp v242, v242, v242 quad_perm:[1,0,3,2] row_mask:0xf bank_mask:0xf
    v_mfma_f32_16x16x32_bf16 v[184:187], v[88:91], v[68:71], v[184:187]
    v_add_f32_dpp v243, v243, v243 quad_perm:[1,0,3,2] row_mask:0xf bank_mask:0xf
    v_add_f32_dpp v244, v244, v244 quad_perm:[1,0,3,2] row_mask:0xf bank_mask:0xf
    v_add_f32_dpp v245, v245, v245 quad_perm:[1,0,3,2] row_mask:0xf bank_mask:0xf
    v_add_f32_dpp v246, v246, v246 quad_perm:[1,0,3,2] row_mask:0xf bank_mask:0xf
    v_add_f32_dpp v247, v247, v247 quad_perm:[1,0,3,2] row_mask:0xf bank_mask:0xf
    v_mfma_f32_16x16x32_bf16 v[188:191], v[88:91], v[72:75], v[188:191]
    v_add_f32_dpp v248, v248, v248 quad_perm:[1,0,3,2] row_mask:0xf bank_mask:0xf
    v_add_f32_dpp v249, v249, v249 quad_perm:[1,0,3,2] row_mask:0xf bank_mask:0xf
    v_add_f32_dpp v250, v250, v250 quad_perm:[1,0,3,2] row_mask:0xf bank_mask:0xf
    v_add_f32_dpp v251, v251, v251 quad_perm:[1,0,3,2] row_mask:0xf bank_mask:0xf
    v_add_f32_dpp v252, v252, v252 quad_perm:[1,0,3,2] row_mask:0xf bank_mask:0xf
    v_mfma_f32_16x16x32_bf16 v[192:195], v[92:95], v[60:63], v[192:195]
    v_add_f32_dpp v253, v253, v253 quad_perm:[1,0,3,2] row_mask:0xf bank_mask:0xf
    v_add_f32_dpp v254, v254, v254 quad_perm:[1,0,3,2] row_mask:0xf bank_mask:0xf
    v_add_f32_dpp v255, v255, v255 quad_perm:[1,0,3,2] row_mask:0xf bank_mask:0xf
    v_add_f32_dpp v116, v116, v116 quad_perm:[2,3,0,1] row_mask:0xf bank_mask:0xf
    v_add_f32_dpp v117, v117, v117 quad_perm:[2,3,0,1] row_mask:0xf bank_mask:0xf
    v_mfma_f32_16x16x32_bf16 v[196:199], v[92:95], v[64:67], v[196:199]
    v_add_f32_dpp v118, v118, v118 quad_perm:[2,3,0,1] row_mask:0xf bank_mask:0xf
    v_add_f32_dpp v119, v119, v119 quad_perm:[2,3,0,1] row_mask:0xf bank_mask:0xf
    v_add_f32_dpp v120, v120, v120 quad_perm:[2,3,0,1] row_mask:0xf bank_mask:0xf
    v_add_f32_dpp v121, v121, v121 quad_perm:[2,3,0,1] row_mask:0xf bank_mask:0xf
    v_add_f32_dpp v122, v122, v122 quad_perm:[2,3,0,1] row_mask:0xf bank_mask:0xf
    v_mfma_f32_16x16x32_bf16 v[200:203], v[92:95], v[68:71], v[200:203]
    v_add_f32_dpp v123, v123, v123 quad_perm:[2,3,0,1] row_mask:0xf bank_mask:0xf
    v_add_f32_dpp v124, v124, v124 quad_perm:[2,3,0,1] row_mask:0xf bank_mask:0xf
    v_add_f32_dpp v125, v125, v125 quad_perm:[2,3,0,1] row_mask:0xf bank_mask:0xf
    v_add_f32_dpp v126, v126, v126 quad_perm:[2,3,0,1] row_mask:0xf bank_mask:0xf
    v_add_f32_dpp v127, v127, v127 quad_perm:[2,3,0,1] row_mask:0xf bank_mask:0xf
    v_mfma_f32_16x16x32_bf16 v[204:207], v[92:95], v[72:75], v[204:207]
    v_add_f32_dpp v240, v240, v240 quad_perm:[2,3,0,1] row_mask:0xf bank_mask:0xf
    v_add_f32_dpp v241, v241, v241 quad_perm:[2,3,0,1] row_mask:0xf bank_mask:0xf
    v_add_f32_dpp v242, v242, v242 quad_perm:[2,3,0,1] row_mask:0xf bank_mask:0xf
    v_add_f32_dpp v243, v243, v243 quad_perm:[2,3,0,1] row_mask:0xf bank_mask:0xf
    v_add_f32_dpp v244, v244, v244 quad_perm:[2,3,0,1] row_mask:0xf bank_mask:0xf
    v_mfma_f32_16x16x32_bf16 v[208:211], v[96:99], v[60:63], v[208:211]
    v_add_f32_dpp v245, v245, v245 quad_perm:[2,3,0,1] row_mask:0xf bank_mask:0xf
    v_add_f32_dpp v246, v246, v246 quad_perm:[2,3,0,1] row_mask:0xf bank_mask:0xf
    v_add_f32_dpp v247, v247, v247 quad_perm:[2,3,0,1] row_mask:0xf bank_mask:0xf
    v_add_f32_dpp v248, v248, v248 quad_perm:[2,3,0,1] row_mask:0xf bank_mask:0xf
    v_add_f32_dpp v249, v249, v249 quad_perm:[2,3,0,1] row_mask:0xf bank_mask:0xf
    v_mfma_f32_16x16x32_bf16 v[212:215], v[96:99], v[64:67], v[212:215]
    v_add_f32_dpp v250, v250, v250 quad_perm:[2,3,0,1] row_mask:0xf bank_mask:0xf
    v_add_f32_dpp v251, v251, v251 quad_perm:[2,3,0,1] row_mask:0xf bank_mask:0xf
    v_add_f32_dpp v252, v252, v252 quad_perm:[2,3,0,1] row_mask:0xf bank_mask:0xf
    v_add_f32_dpp v253, v253, v253 quad_perm:[2,3,0,1] row_mask:0xf bank_mask:0xf
    v_add_f32_dpp v254, v254, v254 quad_perm:[2,3,0,1] row_mask:0xf bank_mask:0xf
    v_mfma_f32_16x16x32_bf16 v[216:219], v[96:99], v[68:71], v[216:219]
    v_add_f32_dpp v255, v255, v255 quad_perm:[2,3,0,1] row_mask:0xf bank_mask:0xf
    v_add_f32_dpp v116, v116, v116 row_half_mirror row_mask:0xf bank_mask:0xf
    v_add_f32_dpp v117, v117, v117 row_half_mirror row_mask:0xf bank_mask:0xf
    v_add_f32_dpp v118, v118, v118 row_half_mirror row_mask:0xf bank_mask:0xf
    v_add_f32_dpp v119, v119, v119 row_half_mirror row_mask:0xf bank_mask:0xf
    v_mfma_f32_16x16x32_bf16 v[220:223], v[96:99], v[72:75], v[220:223]
    v_add_f32_dpp v120, v120, v120 row_half_mirror row_mask:0xf bank_mask:0xf
    v_add_f32_dpp v121, v121, v121 row_half_mirror row_mask:0xf bank_mask:0xf
    v_add_f32_dpp v122, v122, v122 row_half_mirror row_mask:0xf bank_mask:0xf
    v_add_f32_dpp v123, v123, v123 row_half_mirror row_mask:0xf bank_mask:0xf
    v_add_f32_dpp v124, v124, v124 row_half_mirror row_mask:0xf bank_mask:0xf
    v_mfma_f32_16x16x32_bf16 v[224:227], v[100:103], v[60:63], v[224:227]
    v_add_f32_dpp v125, v125, v125 row_half_mirror row_mask:0xf bank_mask:0xf
    v_add_f32_dpp v126, v126, v126 row_half_mirror row_mask:0xf bank_mask:0xf
    v_add_f32_dpp v127, v127, v127 row_half_mirror row_mask:0xf bank_mask:0xf
    v_add_f32_dpp v240, v240, v240 row_half_mirror row_mask:0xf bank_mask:0xf
    v_add_f32_dpp v241, v241, v241 row_half_mirror row_mask:0xf bank_mask:0xf
    v_mfma_f32_16x16x32_bf16 v[228:231], v[100:103], v[64:67], v[228:231]
    v_add_f32_dpp v242, v242, v242 row_half_mirror row_mask:0xf bank_mask:0xf
    v_add_f32_dpp v243, v243, v243 row_half_mirror row_mask:0xf bank_mask:0xf
    v_add_f32_dpp v244, v244, v244 row_half_mirror row_mask:0xf bank_mask:0xf
    v_add_f32_dpp v245, v245, v245 row_half_mirror row_mask:0xf bank_mask:0xf
    v_add_f32_dpp v246, v246, v246 row_half_mirror row_mask:0xf bank_mask:0xf
    v_mfma_f32_16x16x32_bf16 v[232:235], v[100:103], v[68:71], v[232:235]
    v_add_f32_dpp v247, v247, v247 row_half_mirror row_mask:0xf bank_mask:0xf
    v_add_f32_dpp v248, v248, v248 row_half_mirror row_mask:0xf bank_mask:0xf
    v_add_f32_dpp v249, v249, v249 row_half_mirror row_mask:0xf bank_mask:0xf
    v_add_f32_dpp v250, v250, v250 row_half_mirror row_mask:0xf bank_mask:0xf
    v_add_f32_dpp v251, v251, v251 row_half_mirror row_mask:0xf bank_mask:0xf
    v_mfma_f32_16x16x32_bf16 v[236:239], v[100:103], v[72:75], v[236:239]
    v_add_f32_dpp v252, v252, v252 row_half_mirror row_mask:0xf bank_mask:0xf
    v_add_f32_dpp v253, v253, v253 row_half_mirror row_mask:0xf bank_mask:0xf
    v_add_f32_dpp v254, v254, v254 row_half_mirror row_mask:0xf bank_mask:0xf
    v_add_f32_dpp v255, v255, v255 row_half_mirror row_mask:0xf bank_mask:0xf
    v_mul_f32 v105, 0x3e800000, v9
    v_mul_f32 v112, -v8, v105
    v_sub_f32 v56, 1.0, v56
    v_cvt_pk_bf16_f32 v56, v56, v56
    v_lshlrev_b32 v56, 16, v56
    v_mul_f32 v104, 4.0, v56
    v_mul_f32 v107, 0x3e800000, v11
    v_mul_f32 v113, -v10, v107
    v_sub_f32 v57, 1.0, v57
    v_cvt_pk_bf16_f32 v57, v57, v57
    v_lshlrev_b32 v57, 16, v57
    v_mul_f32 v106, 4.0, v57
    v_mul_f32 v109, 0x3e800000, v13
    v_mul_f32 v114, -v12, v109
    v_sub_f32 v58, 1.0, v58
    v_cvt_pk_bf16_f32 v58, v58, v58
    v_lshlrev_b32 v58, 16, v58
    v_mul_f32 v108, 4.0, v58
    v_mul_f32 v111, 0x3e800000, v15
    v_mul_f32 v115, -v14, v111
    v_sub_f32 v59, 1.0, v59
    v_cvt_pk_bf16_f32 v59, v59, v59
    v_lshlrev_b32 v59, 16, v59
    v_mul_f32 v110, 4.0, v59
    v_lshlrev_b32 v64, 16, v16
    v_and_b32 v65, s65, v16
    v_lshlrev_b32 v66, 16, v17
    v_and_b32 v67, s65, v17
    v_lshlrev_b32 v68, 16, v18
    v_and_b32 v69, s65, v18
    v_lshlrev_b32 v70, 16, v19
    v_and_b32 v71, s65, v19
    v_lshlrev_b32 v72, 16, v20
    v_and_b32 v73, s65, v20
    v_lshlrev_b32 v74, 16, v21
    v_and_b32 v75, s65, v21
    v_lshlrev_b32 v76, 16, v22
    v_and_b32 v77, s65, v22
    v_lshlrev_b32 v78, 16, v23
    v_and_b32 v79, s65, v23
    v_lshlrev_b32 v80, 16, v24
    v_and_b32 v81, s65, v24
    v_lshlrev_b32 v82, 16, v25
    v_and_b32 v83, s65, v25
    v_lshlrev_b32 v84, 16, v26
    v_and_b32 v85, s65, v26
    v_lshlrev_b32 v86, 16, v27
    v_and_b32 v87, s65, v27
    v_lshlrev_b32 v88, 16, v28
    v_and_b32 v89, s65, v28
    v_lshlrev_b32 v90, 16, v29
    v_and_b32 v91, s65, v29
    s_mov_b32 s68, 0x3e800000
    v_pk_mul_f32 v[64:65], v[64:65], s[68:69] op_sel_hi:[1,0]
    v_pk_mul_f32 v[66:67], v[66:67], s[68:69] op_sel_hi:[1,0]
    v_pk_mul_f32 v[68:69], v[68:69], s[68:69] op_sel_hi:[1,0]
    v_pk_mul_f32 v[70:71], v[70:71], s[68:69] op_sel_hi:[1,0]
    v_pk_mul_f32 v[72:73], v[72:73], s[68:69] op_sel_hi:[1,0]
    v_pk_mul_f32 v[74:75], v[74:75], s[68:69] op_sel_hi:[1,0]
    v_pk_mul_f32 v[76:77], v[76:77], s[68:69] op_sel_hi:[1,0]
    v_pk_mul_f32 v[78:79], v[78:79], s[68:69] op_sel_hi:[1,0]
    v_pk_mul_f32 v[80:81], v[80:81], s[68:69] op_sel_hi:[1,0]
    v_pk_mul_f32 v[82:83], v[82:83], s[68:69] op_sel_hi:[1,0]
    v_pk_mul_f32 v[84:85], v[84:85], s[68:69] op_sel_hi:[1,0]
    v_pk_mul_f32 v[86:87], v[86:87], s[68:69] op_sel_hi:[1,0]
    v_pk_mul_f32 v[88:89], v[88:89], s[68:69] op_sel_hi:[1,0]
    v_pk_mul_f32 v[90:91], v[90:91], s[68:69] op_sel_hi:[1,0]
    s_movk_i32 s63, 11264
    v_mul_lo_u32 v9, v6, s63
    v_lshl_add_u32 v9, v7, 3, v9
    s_lshl_b32 s66, s34, 8
    s_lshl_b32 s67, s60, 6
    s_add_u32 s66, s66, s67
    s_mul_i32 s66, s66, 11264
    s_add_u32 s66, s66, s64
    s_mul_i32 s67, s61, 360448
    s_add_u32 s67, s67, s66
    s_lshl_b32 s63, s61, 8
    s_add_u32 s66, s66, s63
    s_mov_b32 s68, 0x3fcc1b70
    s_mov_b32 s69, 0xc0877208
    s_mov_b32 s70, 0x411e747d
    s_mov_b32 s71, 0xc1894247
    s_mov_b32 s72, 0x41a79704
    s_mov_b32 s73, 0xc1863ae0
    s_mov_b32 s74, 0x40f9e1bd
    s_mov_b32 s75, 0.5
    v_mov_b32 v10, 0xbfcb1cfa
    s_movk_i32 s63, 11264
    v_mul_lo_u32 v11, v6, s63
    v_lshrrev_b32 v12, 1, v7
    v_lshl_add_u32 v11, v12, 4, v11
    v_and_b32 v12, 1, v7
    v_lshl_add_u32 v9, v12, 5, v11
    s_lshl_b32 s63, s32, 10
    v_lshlrev_b32 v11, 4, v2
    v_add_u32 v11, s63, v11
    v_xor_b32 v12, 1024, v11
    s_cmp_lg_u32 s61, 0
    s_cbranch_scc1 mlp_x1
    v_pk_fma_f32 v[32:33], v[114:115], v[252:253], v[88:89] op_sel:[0,0,0] op_sel_hi:[0,1,1]
    v_pk_fma_f32 v[36:37], v[114:115], v[254:255], v[90:91] op_sel:[0,0,0] op_sel_hi:[0,1,1]
    v_pk_fma_f32 v[40:41], v[114:115], v[252:253], v[88:89] op_sel:[1,0,0] op_sel_hi:[1,1,1]
    v_pk_fma_f32 v[44:45], v[114:115], v[254:255], v[90:91] op_sel:[1,0,0] op_sel_hi:[1,1,1]
    v_pk_fma_f32 v[232:233], v[108:109], v[232:233], v[32:33] op_sel:[1,0,0] op_sel_hi:[1,1,1]
    v_pk_fma_f32 v[234:235], v[108:109], v[234:235], v[36:37] op_sel:[1,0,0] op_sel_hi:[1,1,1]
    v_pk_fma_f32 v[236:237], v[110:111], v[236:237], v[40:41] op_sel:[1,0,0] op_sel_hi:[1,1,1]
    v_pk_fma_f32 v[238:239], v[110:111], v[238:239], v[44:45] op_sel:[1,0,0] op_sel_hi:[1,1,1]
    v_pk_mul_f32 v[34:35], v[232:233], v[232:233] clamp
    v_pk_mul_f32 v[38:39], v[234:235], v[234:235] clamp
    v_pk_mul_f32 v[42:43], v[236:237], v[236:237] clamp
    v_pk_mul_f32 v[46:47], v[238:239], v[238:239] clamp
    v_pk_fma_f32 v[32:33], v[34:35], v[10:11], s[74:75] op_sel:[0,0,0] op_sel_hi:[1,0,0]
    v_pk_fma_f32 v[36:37], v[38:39], v[10:11], s[74:75] op_sel:[0,0,0] op_sel_hi:[1,0,0]
    v_pk_fma_f32 v[40:41], v[42:43], v[10:11], s[74:75] op_sel:[0,0,0] op_sel_hi:[1,0,0]
    v_pk_fma_f32 v[44:45], v[46:47], v[10:11], s[74:75] op_sel:[0,0,0] op_sel_hi:[1,0,0]
    v_pk_fma_f32 v[32:33], v[32:33], v[34:35], s[72:73] op_sel:[0,0,1] op_sel_hi:[1,1,1]
    v_pk_fma_f32 v[36:37], v[36:37], v[38:39], s[72:73] op_sel:[0,0,1] op_sel_hi:[1,1,1]
    v_pk_fma_f32 v[40:41], v[40:41], v[42:43], s[72:73] op_sel:[0,0,1] op_sel_hi:[1,1,1]
    v_pk_fma_f32 v[44:45], v[44:45], v[46:47], s[72:73] op_sel:[0,0,1] op_sel_hi:[1,1,1]
    v_pk_fma_f32 v[32:33], v[32:33], v[34:35], s[72:73] op_sel:[0,0,0] op_sel_hi:[1,1,0]
    v_pk_fma_f32 v[36:37], v[36:37], v[38:39], s[72:73] op_sel:[0,0,0] op_sel_hi:[1,1,0]
    v_pk_fma_f32 v[40:41], v[40:41], v[42:43], s[72:73] op_sel:[0,0,0] op_sel_hi:[1,1,0]
    v_pk_fma_f32 v[44:45], v[44:45], v[46:47], s[72:73] op_sel:[0,0,0] op_sel_hi:[1,1,0]
    v_pk_fma_f32 v[32:33], v[32:33], v[34:35], s[70:71] op_sel:[0,0,1] op_sel_hi:[1,1,1]
    v_pk_fma_f32 v[36:37], v[36:37], v[38:39], s[70:71] op_sel:[0,0,1] op_sel_hi:[1,1,1]
    v_pk_fma_f32 v[40:41], v[40:41], v[42:43], s[70:71] op_sel:[0,0,1] op_sel_hi:[1,1,1]
    v_pk_fma_f32 v[44:45], v[44:45], v[46:47], s[70:71] op_sel:[0,0,1] op_sel_hi:[1,1,1]
    v_pk_fma_f32 v[32:33], v[32:33], v[34:35], s[70:71] op_sel:[0,0,0] op_sel_hi:[1,1,0]
    v_pk_fma_f32 v[36:37], v[36:37], v[38:39], s[70:71] op_sel:[0,0,0] op_sel_hi:[1,1,0]
    v_pk_fma_f32 v[40:41], v[40:41], v[42:43], s[70:71] op_sel:[0,0,0] op_sel_hi:[1,1,0]
    v_pk_fma_f32 v[44:45], v[44:45], v[46:47], s[70:71] op_sel:[0,0,0] op_sel_hi:[1,1,0]
    v_pk_fma_f32 v[32:33], v[32:33], v[34:35], s[68:69] op_sel:[0,0,1] op_sel_hi:[1,1,1]
    v_pk_fma_f32 v[36:37], v[36:37], v[38:39], s[68:69] op_sel:[0,0,1] op_sel_hi:[1,1,1]
    v_pk_fma_f32 v[40:41], v[40:41], v[42:43], s[68:69] op_sel:[0,0,1] op_sel_hi:[1,1,1]
    v_pk_fma_f32 v[44:45], v[44:45], v[46:47], s[68:69] op_sel:[0,0,1] op_sel_hi:[1,1,1]
    v_pk_fma_f32 v[32:33], v[32:33], v[34:35], s[68:69] op_sel:[0,0,0] op_sel_hi:[1,1,0]
    v_pk_fma_f32 v[36:37], v[36:37], v[38:39], s[68:69] op_sel:[0,0,0] op_sel_hi:[1,1,0]
    v_pk_fma_f32 v[40:41], v[40:41], v[42:43], s[68:69] op_sel:[0,0,0] op_sel_hi:[1,1,0]
    v_pk_fma_f32 v[44:45], v[44:45], v[46:47], s[68:69] op_sel:[0,0,0] op_sel_hi:[1,1,0]
    v_pk_fma_f32 v[32:33], v[32:33], v[232:233], s[74:75] op_sel:[0,0,1] op_sel_hi:[1,1,1] clamp
    v_pk_fma_f32 v[36:37], v[36:37], v[234:235], s[74:75] op_sel:[0,0,1] op_sel_hi:[1,1,1] clamp
    v_pk_fma_f32 v[40:41], v[40:41], v[236:237], s[74:75] op_sel:[0,0,1] op_sel_hi:[1,1,1] clamp
    v_pk_fma_f32 v[44:45], v[44:45], v[238:239], s[74:75] op_sel:[0,0,1] op_sel_hi:[1,1,1] clamp
    v_pk_mul_f32 v[232:233], v[232:233], v[108:109] op_sel:[0,0] op_sel_hi:[1,0]
    v_pk_mul_f32 v[234:235], v[234:235], v[108:109] op_sel:[0,0] op_sel_hi:[1,0]
    v_pk_mul_f32 v[236:237], v[236:237], v[110:111] op_sel:[0,0] op_sel_hi:[1,0]
    v_pk_mul_f32 v[238:239], v[238:239], v[110:111] op_sel:[0,0] op_sel_hi:[1,0]
    v_pk_mul_f32 v[32:33], v[32:33], v[232:233]
    v_pk_mul_f32 v[36:37], v[36:37], v[234:235]
    v_pk_mul_f32 v[40:41], v[40:41], v[236:237]
    v_pk_mul_f32 v[44:45], v[44:45], v[238:239]
    v_cvt_pk_bf16_f32 v100, v32, v33
    v_cvt_pk_bf16_f32 v101, v36, v37
    v_cvt_pk_bf16_f32 v102, v40, v41
    v_cvt_pk_bf16_f32 v103, v44, v45
    ds_write_b128 v11, v[100:103]
    v_pk_fma_f32 v[48:49], v[112:113], v[252:253], v[88:89] op_sel:[0,0,0] op_sel_hi:[0,1,1]
    v_pk_fma_f32 v[52:53], v[112:113], v[254:255], v[90:91] op_sel:[0,0,0] op_sel_hi:[0,1,1]
    v_pk_fma_f32 v[56:57], v[112:113], v[252:253], v[88:89] op_sel:[1,0,0] op_sel_hi:[1,1,1]
    v_pk_fma_f32 v[60:61], v[112:113], v[254:255], v[90:91] op_sel:[1,0,0] op_sel_hi:[1,1,1]
    v_pk_fma_f32 v[224:225], v[104:105], v[224:225], v[48:49] op_sel:[1,0,0] op_sel_hi:[1,1,1]
    v_pk_fma_f32 v[226:227], v[104:105], v[226:227], v[52:53] op_sel:[1,0,0] op_sel_hi:[1,1,1]
    v_pk_fma_f32 v[228:229], v[106:107], v[228:229], v[56:57] op_sel:[1,0,0] op_sel_hi:[1,1,1]
    v_pk_fma_f32 v[230:231], v[106:107], v[230:231], v[60:61] op_sel:[1,0,0] op_sel_hi:[1,1,1]
    v_pk_mul_f32 v[50:51], v[224:225], v[224:225] clamp
    v_pk_mul_f32 v[54:55], v[226:227], v[226:227] clamp
    v_pk_mul_f32 v[58:59], v[228:229], v[228:229] clamp
    v_pk_mul_f32 v[62:63], v[230:231], v[230:231] clamp
    v_pk_fma_f32 v[48:49], v[50:51], v[10:11], s[74:75] op_sel:[0,0,0] op_sel_hi:[1,0,0]
    v_pk_fma_f32 v[52:53], v[54:55], v[10:11], s[74:75] op_sel:[0,0,0] op_sel_hi:[1,0,0]
    v_pk_fma_f32 v[56:57], v[58:59], v[10:11], s[74:75] op_sel:[0,0,0] op_sel_hi:[1,0,0]
    v_pk_fma_f32 v[60:61], v[62:63], v[10:11], s[74:75] op_sel:[0,0,0] op_sel_hi:[1,0,0]
    v_pk_fma_f32 v[48:49], v[48:49], v[50:51], s[72:73] op_sel:[0,0,1] op_sel_hi:[1,1,1]
    v_pk_fma_f32 v[52:53], v[52:53], v[54:55], s[72:73] op_sel:[0,0,1] op_sel_hi:[1,1,1]
    v_pk_fma_f32 v[56:57], v[56:57], v[58:59], s[72:73] op_sel:[0,0,1] op_sel_hi:[1,1,1]
    v_pk_fma_f32 v[60:61], v[60:61], v[62:63], s[72:73] op_sel:[0,0,1] op_sel_hi:[1,1,1]
    v_pk_fma_f32 v[48:49], v[48:49], v[50:51], s[72:73] op_sel:[0,0,0] op_sel_hi:[1,1,0]
    v_pk_fma_f32 v[52:53], v[52:53], v[54:55], s[72:73] op_sel:[0,0,0] op_sel_hi:[1,1,0]
    v_pk_fma_f32 v[56:57], v[56:57], v[58:59], s[72:73] op_sel:[0,0,0] op_sel_hi:[1,1,0]
    v_pk_fma_f32 v[60:61], v[60:61], v[62:63], s[72:73] op_sel:[0,0,0] op_sel_hi:[1,1,0]
    v_pk_fma_f32 v[48:49], v[48:49], v[50:51], s[70:71] op_sel:[0,0,1] op_sel_hi:[1,1,1]
    v_pk_fma_f32 v[52:53], v[52:53], v[54:55], s[70:71] op_sel:[0,0,1] op_sel_hi:[1,1,1]
    v_pk_fma_f32 v[56:57], v[56:57], v[58:59], s[70:71] op_sel:[0,0,1] op_sel_hi:[1,1,1]
    v_pk_fma_f32 v[60:61], v[60:61], v[62:63], s[70:71] op_sel:[0,0,1] op_sel_hi:[1,1,1]
    v_pk_fma_f32 v[48:49], v[48:49], v[50:51], s[70:71] op_sel:[0,0,0] op_sel_hi:[1,1,0]
    v_pk_fma_f32 v[52:53], v[52:53], v[54:55], s[70:71] op_sel:[0,0,0] op_sel_hi:[1,1,0]
    v_pk_fma_f32 v[56:57], v[56:57], v[58:59], s[70:71] op_sel:[0,0,0] op_sel_hi:[1,1,0]
    v_pk_fma_f32 v[60:61], v[60:61], v[62:63], s[70:71] op_sel:[0,0,0] op_sel_hi:[1,1,0]
    v_pk_fma_f32 v[48:49], v[48:49], v[50:51], s[68:69] op_sel:[0,0,1] op_sel_hi:[1,1,1]
    v_pk_fma_f32 v[52:53], v[52:53], v[54:55], s[68:69] op_sel:[0,0,1] op_sel_hi:[1,1,1]
    v_pk_fma_f32 v[56:57], v[56:57], v[58:59], s[68:69] op_sel:[0,0,1] op_sel_hi:[1,1,1]
    v_pk_fma_f32 v[60:61], v[60:61], v[62:63], s[68:69] op_sel:[0,0,1] op_sel_hi:[1,1,1]
    v_pk_fma_f32 v[48:49], v[48:49], v[50:51], s[68:69] op_sel:[0,0,0] op_sel_hi:[1,1,0]
    v_pk_fma_f32 v[52:53], v[52:53], v[54:55], s[68:69] op_sel:[0,0,0] op_sel_hi:[1,1,0]
    v_pk_fma_f32 v[56:57], v[56:57], v[58:59], s[68:69] op_sel:[0,0,0] op_sel_hi:[1,1,0]
    v_pk_fma_f32 v[60:61], v[60:61], v[62:63], s[68:69] op_sel:[0,0,0] op_sel_hi:[1,1,0]
    v_pk_fma_f32 v[48:49], v[48:49], v[224:225], s[74:75] op_sel:[0,0,1] op_sel_hi:[1,1,1] clamp
    v_pk_fma_f32 v[52:53], v[52:53], v[226:227], s[74:75] op_sel:[0,0,1] op_sel_hi:[1,1,1] clamp
    v_pk_fma_f32 v[56:57], v[56:57], v[228:229], s[74:75] op_sel:[0,0,1] op_sel_hi:[1,1,1] clamp
    v_pk_fma_f32 v[60:61], v[60:61], v[230:231], s[74:75] op_sel:[0,0,1] op_sel_hi:[1,1,1] clamp
    v_pk_mul_f32 v[224:225], v[224:225], v[104:105] op_sel:[0,0] op_sel_hi:[1,0]
    v_pk_mul_f32 v[226:227], v[226:227], v[104:105] op_sel:[0,0] op_sel_hi:[1,0]
    v_pk_mul_f32 v[228:229], v[228:229], v[106:107] op_sel:[0,0] op_sel_hi:[1,0]
    v_pk_mul_f32 v[230:231], v[230:231], v[106:107] op_sel:[0,0] op_sel_hi:[1,0]
    v_pk_mul_f32 v[48:49], v[48:49], v[224:225]
    v_pk_mul_f32 v[52:53], v[52:53], v[226:227]
    v_pk_mul_f32 v[56:57], v[56:57], v[228:229]
    v_pk_mul_f32 v[60:61], v[60:61], v[230:231]
    v_cvt_pk_bf16_f32 v92, v48, v49
    v_cvt_pk_bf16_f32 v93, v52, v53
    v_cvt_pk_bf16_f32 v96, v56, v57
    v_cvt_pk_bf16_f32 v97, v60, v61
    s_branch mlp_x2
mlp_x1:
    v_pk_fma_f32 v[32:33], v[112:113], v[252:253], v[88:89] op_sel:[0,0,0] op_sel_hi:[0,1,1]
    v_pk_fma_f32 v[36:37], v[112:113], v[254:255], v[90:91] op_sel:[0,0,0] op_sel_hi:[0,1,1]
    v_pk_fma_f32 v[40:41], v[112:113], v[252:253], v[88:89] op_sel:[1,0,0] op_sel_hi:[1,1,1]
    v_pk_fma_f32 v[44:45], v[112:113], v[254:255], v[90:91] op_sel:[1,0,0] op_sel_hi:[1,1,1]
    v_pk_fma_f32 v[224:225], v[104:105], v[224:225], v[32:33] op_sel:[1,0,0] op_sel_hi:[1,1,1]
    v_pk_fma_f32 v[226:227], v[104:105], v[226:227], v[36:37] op_sel:[1,0,0] op_sel_hi:[1,1,1]
    v_pk_fma_f32 v[228:229], v[106:107], v[228:229], v[40:41] op_sel:[1,0,0] op_sel_hi:[1,1,1]
    v_pk_fma_f32 v[230:231], v[106:107], v[230:231], v[44:45] op_sel:[1,0,0] op_sel_hi:[1,1,1]
    v_pk_mul_f32 v[34:35], v[224:225], v[224:225] clamp
    v_pk_mul_f32 v[38:39], v[226:227], v[226:227] clamp
    v_pk_mul_f32 v[42:43], v[228:229], v[228:229] clamp
    v_pk_mul_f32 v[46:47], v[230:231], v[230:231] clamp
    v_pk_fma_f32 v[32:33], v[34:35], v[10:11], s[74:75] op_sel:[0,0,0] op_sel_hi:[1,0,0]
    v_pk_fma_f32 v[36:37], v[38:39], v[10:11], s[74:75] op_sel:[0,0,0] op_sel_hi:[1,0,0]
    v_pk_fma_f32 v[40:41], v[42:43], v[10:11], s[74:75] op_sel:[0,0,0] op_sel_hi:[1,0,0]
    v_pk_fma_f32 v[44:45], v[46:47], v[10:11], s[74:75] op_sel:[0,0,0] op_sel_hi:[1,0,0]
    v_pk_fma_f32 v[32:33], v[32:33], v[34:35], s[72:73] op_sel:[0,0,1] op_sel_hi:[1,1,1]
    v_pk_fma_f32 v[36:37], v[36:37], v[38:39], s[72:73] op_sel:[0,0,1] op_sel_hi:[1,1,1]
    v_pk_fma_f32 v[40:41], v[40:41], v[42:43], s[72:73] op_sel:[0,0,1] op_sel_hi:[1,1,1]
    v_pk_fma_f32 v[44:45], v[44:45], v[46:47], s[72:73] op_sel:[0,0,1] op_sel_hi:[1,1,1]
    v_pk_fma_f32 v[32:33], v[32:33], v[34:35], s[72:73] op_sel:[0,0,0] op_sel_hi:[1,1,0]
    v_pk_fma_f32 v[36:37], v[36:37], v[38:39], s[72:73] op_sel:[0,0,0] op_sel_hi:[1,1,0]
    v_pk_fma_f32 v[40:41], v[40:41], v[42:43], s[72:73] op_sel:[0,0,0] op_sel_hi:[1,1,0]
    v_pk_fma_f32 v[44:45], v[44:45], v[46:47], s[72:73] op_sel:[0,0,0] op_sel_hi:[1,1,0]
    v_pk_fma_f32 v[32:33], v[32:33], v[34:35], s[70:71] op_sel:[0,0,1] op_sel_hi:[1,1,1]
    v_pk_fma_f32 v[36:37], v[36:37], v[38:39], s[70:71] op_sel:[0,0,1] op_sel_hi:[1,1,1]
    v_pk_fma_f32 v[40:41], v[40:41], v[42:43], s[70:71] op_sel:[0,0,1] op_sel_hi:[1,1,1]
    v_pk_fma_f32 v[44:45], v[44:45], v[46:47], s[70:71] op_sel:[0,0,1] op_sel_hi:[1,1,1]
    v_pk_fma_f32 v[32:33], v[32:33], v[34:35], s[70:71] op_sel:[0,0,0] op_sel_hi:[1,1,0]
    v_pk_fma_f32 v[36:37], v[36:37], v[38:39], s[70:71] op_sel:[0,0,0] op_sel_hi:[1,1,0]
    v_pk_fma_f32 v[40:41], v[40:41], v[42:43], s[70:71] op_sel:[0,0,0] op_sel_hi:[1,1,0]
    v_pk_fma_f32 v[44:45], v[44:45], v[46:47], s[70:71] op_sel:[0,0,0] op_sel_hi:[1,1,0]
    v_pk_fma_f32 v[32:33], v[32:33], v[34:35], s[68:69] op_sel:[0,0,1] op_sel_hi:[1,1,1]
    v_pk_fma_f32 v[36:37], v[36:37], v[38:39], s[68:69] op_sel:[0,0,1] op_sel_hi:[1,1,1]
    v_pk_fma_f32 v[40:41], v[40:41], v[42:43], s[68:69] op_sel:[0,0,1] op_sel_hi:[1,1,1]
    v_pk_fma_f32 v[44:45], v[44:45], v[46:47], s[68:69] op_sel:[0,0,1] op_sel_hi:[1,1,1]
    v_pk_fma_f32 v[32:33], v[32:33], v[34:35], s[68:69] op_sel:[0,0,0] op_sel_hi:[1,1,0]
    v_pk_fma_f32 v[36:37], v[36:37], v[38:39], s[68:69] op_sel:[0,0,0] op_sel_hi:[1,1,0]
    v_pk_fma_f32 v[40:41], v[40:41], v[42:43], s[68:69] op_sel:[0,0,0] op_sel_hi:[1,1,0]
    v_pk_fma_f32 v[44:45], v[44:45], v[46:47], s[68:69] op_sel:[0,0,0] op_sel_hi:[1,1,0]
    v_pk_fma_f32 v[32:33], v[32:33], v[224:225], s[74:75] op_sel:[0,0,1] op_sel_hi:[1,1,1] clamp
    v_pk_fma_f32 v[36:37], v[36:37], v[226:227], s[74:75] op_sel:[0,0,1] op_sel_hi:[1,1,1] clamp
    v_pk_fma_f32 v[40:41], v[40:41], v[228:229], s[74:75] op_sel:[0,0,1] op_sel_hi:[1,1,1] clamp
    v_pk_fma_f32 v[44:45], v[44:45], v[230:231], s[74:75] op_sel:[0,0,1] op_sel_hi:[1,1,1] clamp
    v_pk_mul_f32 v[224:225], v[224:225], v[104:105] op_sel:[0,0] op_sel_hi:[1,0]
    v_pk_mul_f32 v[226:227], v[226:227], v[104:105] op_sel:[0,0] op_sel_hi:[1,0]
    v_pk_mul_f32 v[228:229], v[228:229], v[106:107] op_sel:[0,0] op_sel_hi:[1,0]
    v_pk_mul_f32 v[230:231], v[230:231], v[106:107] op_sel:[0,0] op_sel_hi:[1,0]
    v_pk_mul_f32 v[32:33], v[32:33], v[224:225]
    v_pk_mul_f32 v[36:37], v[36:37], v[226:227]
    v_pk_mul_f32 v[40:41], v[40:41], v[228:229]
    v_pk_mul_f32 v[44:45], v[44:45], v[230:231]
    v_cvt_pk_bf16_f32 v100, v32, v33
    v_cvt_pk_bf16_f32 v101, v36, v37
    v_cvt_pk_bf16_f32 v102, v40, v41
    v_cvt_pk_bf16_f32 v103, v44, v45
    ds_write_b128 v11, v[100:103]
    v_pk_fma_f32 v[48:49], v[114:115], v[252:253], v[88:89] op_sel:[0,0,0] op_sel_hi:[0,1,1]
    v_pk_fma_f32 v[52:53], v[114:115], v[254:255], v[90:91] op_sel:[0,0,0] op_sel_hi:[0,1,1]
    v_pk_fma_f32 v[56:57], v[114:115], v[252:253], v[88:89] op_sel:[1,0,0] op_sel_hi:[1,1,1]
    v_pk_fma_f32 v[60:61], v[114:115], v[254:255], v[90:91] op_sel:[1,0,0] op_sel_hi:[1,1,1]
    v_pk_fma_f32 v[232:233], v[108:109], v[232:233], v[48:49] op_sel:[1,0,0] op_sel_hi:[1,1,1]
    v_pk_fma_f32 v[234:235], v[108:109], v[234:235], v[52:53] op_sel:[1,0,0] op_sel_hi:[1,1,1]
    v_pk_fma_f32 v[236:237], v[110:111], v[236:237], v[56:57] op_sel:[1,0,0] op_sel_hi:[1,1,1]
    v_pk_fma_f32 v[238:239], v[110:111], v[238:239], v[60:61] op_sel:[1,0,0] op_sel_hi:[1,1,1]
    v_pk_mul_f32 v[50:51], v[232:233], v[232:233] clamp
    v_pk_mul_f32 v[54:55], v[234:235], v[234:235] clamp
    v_pk_mul_f32 v[58:59], v[236:237], v[236:237] clamp
    v_pk_mul_f32 v[62:63], v[238:239], v[238:239] clamp
    v_pk_fma_f32 v[48:49], v[50:51], v[10:11], s[74:75] op_sel:[0,0,0] op_sel_hi:[1,0,0]
    v_pk_fma_f32 v[52:53], v[54:55], v[10:11], s[74:75] op_sel:[0,0,0] op_sel_hi:[1,0,0]
    v_pk_fma_f32 v[56:57], v[58:59], v[10:11], s[74:75] op_sel:[0,0,0] op_sel_hi:[1,0,0]
    v_pk_fma_f32 v[60:61], v[62:63], v[10:11], s[74:75] op_sel:[0,0,0] op_sel_hi:[1,0,0]
    v_pk_fma_f32 v[48:49], v[48:49], v[50:51], s[72:73] op_sel:[0,0,1] op_sel_hi:[1,1,1]
    v_pk_fma_f32 v[52:53], v[52:53], v[54:55], s[72:73] op_sel:[0,0,1] op_sel_hi:[1,1,1]
    v_pk_fma_f32 v[56:57], v[56:57], v[58:59], s[72:73] op_sel:[0,0,1] op_sel_hi:[1,1,1]
    v_pk_fma_f32 v[60:61], v[60:61], v[62:63], s[72:73] op_sel:[0,0,1] op_sel_hi:[1,1,1]
    v_pk_fma_f32 v[48:49], v[48:49], v[50:51], s[72:73] op_sel:[0,0,0] op_sel_hi:[1,1,0]
    v_pk_fma_f32 v[52:53], v[52:53], v[54:55], s[72:73] op_sel:[0,0,0] op_sel_hi:[1,1,0]
    v_pk_fma_f32 v[56:57], v[56:57], v[58:59], s[72:73] op_sel:[0,0,0] op_sel_hi:[1,1,0]
    v_pk_fma_f32 v[60:61], v[60:61], v[62:63], s[72:73] op_sel:[0,0,0] op_sel_hi:[1,1,0]
    v_pk_fma_f32 v[48:49], v[48:49], v[50:51], s[70:71] op_sel:[0,0,1] op_sel_hi:[1,1,1]
    v_pk_fma_f32 v[52:53], v[52:53], v[54:55], s[70:71] op_sel:[0,0,1] op_sel_hi:[1,1,1]
    v_pk_fma_f32 v[56:57], v[56:57], v[58:59], s[70:71] op_sel:[0,0,1] op_sel_hi:[1,1,1]
    v_pk_fma_f32 v[60:61], v[60:61], v[62:63], s[70:71] op_sel:[0,0,1] op_sel_hi:[1,1,1]
    v_pk_fma_f32 v[48:49], v[48:49], v[50:51], s[70:71] op_sel:[0,0,0] op_sel_hi:[1,1,0]
    v_pk_fma_f32 v[52:53], v[52:53], v[54:55], s[70:71] op_sel:[0,0,0] op_sel_hi:[1,1,0]
    v_pk_fma_f32 v[56:57], v[56:57], v[58:59], s[70:71] op_sel:[0,0,0] op_sel_hi:[1,1,0]
    v_pk_fma_f32 v[60:61], v[60:61], v[62:63], s[70:71] op_sel:[0,0,0] op_sel_hi:[1,1,0]
    v_pk_fma_f32 v[48:49], v[48:49], v[50:51], s[68:69] op_sel:[0,0,1] op_sel_hi:[1,1,1]
    v_pk_fma_f32 v[52:53], v[52:53], v[54:55], s[68:69] op_sel:[0,0,1] op_sel_hi:[1,1,1]
    v_pk_fma_f32 v[56:57], v[56:57], v[58:59], s[68:69] op_sel:[0,0,1] op_sel_hi:[1,1,1]
    v_pk_fma_f32 v[60:61], v[60:61], v[62:63], s[68:69] op_sel:[0,0,1] op_sel_hi:[1,1,1]
    v_pk_fma_f32 v[48:49], v[48:49], v[50:51], s[68:69] op_sel:[0,0,0] op_sel_hi:[1,1,0]
    v_pk_fma_f32 v[52:53], v[52:53], v[54:55], s[68:69] op_sel:[0,0,0] op_sel_hi:[1,1,0]
    v_pk_fma_f32 v[56:57], v[56:57], v[58:59], s[68:69] op_sel:[0,0,0] op_sel_hi:[1,1,0]
    v_pk_fma_f32 v[60:61], v[60:61], v[62:63], s[68:69] op_sel:[0,0,0] op_sel_hi:[1,1,0]
    v_pk_fma_f32 v[48:49], v[48:49], v[232:233], s[74:75] op_sel:[0,0,1] op_sel_hi:[1,1,1] clamp
    v_pk_fma_f32 v[52:53], v[52:53], v[234:235], s[74:75] op_sel:[0,0,1] op_sel_hi:[1,1,1] clamp
    v_pk_fma_f32 v[56:57], v[56:57], v[236:237], s[74:75] op_sel:[0,0,1] op_sel_hi:[1,1,1] clamp
    v_pk_fma_f32 v[60:61], v[60:61], v[238:239], s[74:75] op_sel:[0,0,1] op_sel_hi:[1,1,1] clamp
    v_pk_mul_f32 v[232:233], v[232:233], v[108:109] op_sel:[0,0] op_sel_hi:[1,0]
    v_pk_mul_f32 v[234:235], v[234:235], v[108:109] op_sel:[0,0] op_sel_hi:[1,0]
    v_pk_mul_f32 v[236:237], v[236:237], v[110:111] op_sel:[0,0] op_sel_hi:[1,0]
    v_pk_mul_f32 v[238:239], v[238:239], v[110:111] op_sel:[0,0] op_sel_hi:[1,0]
    v_pk_mul_f32 v[48:49], v[48:49], v[232:233]
    v_pk_mul_f32 v[52:53], v[52:53], v[234:235]
    v_pk_mul_f32 v[56:57], v[56:57], v[236:237]
    v_pk_mul_f32 v[60:61], v[60:61], v[238:239]
    v_cvt_pk_bf16_f32 v94, v48, v49
    v_cvt_pk_bf16_f32 v95, v52, v53
    v_cvt_pk_bf16_f32 v98, v56, v57
    v_cvt_pk_bf16_f32 v99, v60, v61
mlp_x2:
    v_pk_fma_f32 v[32:33], v[112:113], v[116:117], v[64:65] op_sel:[0,0,0] op_sel_hi:[0,1,1]
    v_pk_fma_f32 v[36:37], v[112:113], v[118:119], v[66:67] op_sel:[0,0,0] op_sel_hi:[0,1,1]
    v_pk_fma_f32 v[40:41], v[112:113], v[120:121], v[68:69] op_sel:[0,0,0] op_sel_hi:[0,1,1]
    v_pk_fma_f32 v[44:45], v[112:113], v[122:123], v[70:71] op_sel:[0,0,0] op_sel_hi:[0,1,1]
    v_pk_fma_f32 v[128:129], v[104:105], v[128:129], v[32:33] op_sel:[1,0,0] op_sel_hi:[1,1,1]
    v_pk_fma_f32 v[130:131], v[104:105], v[130:131], v[36:37] op_sel:[1,0,0] op_sel_hi:[1,1,1]
    v_pk_fma_f32 v[144:145], v[104:105], v[144:145], v[40:41] op_sel:[1,0,0] op_sel_hi:[1,1,1]
    v_pk_fma_f32 v[146:147], v[104:105], v[146:147], v[44:45] op_sel:[1,0,0] op_sel_hi:[1,1,1]
    v_pk_mul_f32 v[34:35], v[128:129], v[128:129] clamp
    v_pk_mul_f32 v[38:39], v[130:131], v[130:131] clamp
    v_pk_mul_f32 v[42:43], v[144:145], v[144:145] clamp
    v_pk_mul_f32 v[46:47], v[146:147], v[146:147] clamp
    v_pk_fma_f32 v[32:33], v[34:35], v[10:11], s[74:75] op_sel:[0,0,0] op_sel_hi:[1,0,0]
    v_pk_fma_f32 v[36:37], v[38:39], v[10:11], s[74:75] op_sel:[0,0,0] op_sel_hi:[1,0,0]
    v_pk_fma_f32 v[40:41], v[42:43], v[10:11], s[74:75] op_sel:[0,0,0] op_sel_hi:[1,0,0]
    v_pk_fma_f32 v[44:45], v[46:47], v[10:11], s[74:75] op_sel:[0,0,0] op_sel_hi:[1,0,0]
    v_pk_fma_f32 v[32:33], v[32:33], v[34:35], s[72:73] op_sel:[0,0,1] op_sel_hi:[1,1,1]
    v_pk_fma_f32 v[36:37], v[36:37], v[38:39], s[72:73] op_sel:[0,0,1] op_sel_hi:[1,1,1]
    v_pk_fma_f32 v[40:41], v[40:41], v[42:43], s[72:73] op_sel:[0,0,1] op_sel_hi:[1,1,1]
    v_pk_fma_f32 v[44:45], v[44:45], v[46:47], s[72:73] op_sel:[0,0,1] op_sel_hi:[1,1,1]
    v_pk_fma_f32 v[32:33], v[32:33], v[34:35], s[72:73] op_sel:[0,0,0] op_sel_hi:[1,1,0]
    v_pk_fma_f32 v[36:37], v[36:37], v[38:39], s[72:73] op_sel:[0,0,0] op_sel_hi:[1,1,0]
    v_pk_fma_f32 v[40:41], v[40:41], v[42:43], s[72:73] op_sel:[0,0,0] op_sel_hi:[1,1,0]
    v_pk_fma_f32 v[44:45], v[44:45], v[46:47], s[72:73] op_sel:[0,0,0] op_sel_hi:[1,1,0]
    v_pk_fma_f32 v[32:33], v[32:33], v[34:35], s[70:71] op_sel:[0,0,1] op_sel_hi:[1,1,1]
    v_pk_fma_f32 v[36:37], v[36:37], v[38:39], s[70:71] op_sel:[0,0,1] op_sel_hi:[1,1,1]
    v_pk_fma_f32 v[40:41], v[40:41], v[42:43], s[70:71] op_sel:[0,0,1] op_sel_hi:[1,1,1]
    v_pk_fma_f32 v[44:45], v[44:45], v[46:47], s[70:71] op_sel:[0,0,1] op_sel_hi:[1,1,1]
    v_pk_fma_f32 v[32:33], v[32:33], v[34:35], s[70:71] op_sel:[0,0,0] op_sel_hi:[1,1,0]
    v_pk_fma_f32 v[36:37], v[36:37], v[38:39], s[70:71] op_sel:[0,0,0] op_sel_hi:[1,1,0]
    v_pk_fma_f32 v[40:41], v[40:41], v[42:43], s[70:71] op_sel:[0,0,0] op_sel_hi:[1,1,0]
    v_pk_fma_f32 v[44:45], v[44:45], v[46:47], s[70:71] op_sel:[0,0,0] op_sel_hi:[1,1,0]
    v_pk_fma_f32 v[32:33], v[32:33], v[34:35], s[68:69] op_sel:[0,0,1] op_sel_hi:[1,1,1]
    v_pk_fma_f32 v[36:37], v[36:37], v[38:39], s[68:69] op_sel:[0,0,1] op_sel_hi:[1,1,1]
    v_pk_fma_f32 v[40:41], v[40:41], v[42:43], s[68:69] op_sel:[0,0,1] op_sel_hi:[1,1,1]
    v_pk_fma_f32 v[44:45], v[44:45], v[46:47], s[68:69] op_sel:[0,0,1] op_sel_hi:[1,1,1]
    v_pk_fma_f32 v[32:33], v[32:33], v[34:35], s[68:69] op_sel:[0,0,0] op_sel_hi:[1,1,0]
    v_pk_fma_f32 v[36:37], v[36:37], v[38:39], s[68:69] op_sel:[0,0,0] op_sel_hi:[1,1,0]
    v_pk_fma_f32 v[40:41], v[40:41], v[42:43], s[68:69] op_sel:[0,0,0] op_sel_hi:[1,1,0]
    v_pk_fma_f32 v[44:45], v[44:45], v[46:47], s[68:69] op_sel:[0,0,0] op_sel_hi:[1,1,0]
    v_pk_fma_f32 v[32:33], v[32:33], v[128:129], s[74:75] op_sel:[0,0,1] op_sel_hi:[1,1,1] clamp
    v_pk_fma_f32 v[36:37], v[36:37], v[130:131], s[74:75] op_sel:[0,0,1] op_sel_hi:[1,1,1] clamp
    v_pk_fma_f32 v[40:41], v[40:41], v[144:145], s[74:75] op_sel:[0,0,1] op_sel_hi:[1,1,1] clamp
    v_pk_fma_f32 v[44:45], v[44:45], v[146:147], s[74:75] op_sel:[0,0,1] op_sel_hi:[1,1,1] clamp
    v_pk_mul_f32 v[128:129], v[128:129], v[104:105] op_sel:[0,0] op_sel_hi:[1,0]
    v_pk_mul_f32 v[130:131], v[130:131], v[104:105] op_sel:[0,0] op_sel_hi:[1,0]
    v_pk_mul_f32 v[144:145], v[144:145], v[104:105] op_sel:[0,0] op_sel_hi:[1,0]
    v_pk_mul_f32 v[146:147], v[146:147], v[104:105] op_sel:[0,0] op_sel_hi:[1,0]
    v_pk_mul_f32 v[32:33], v[32:33], v[128:129]
    v_pk_mul_f32 v[36:37], v[36:37], v[130:131]
    v_pk_mul_f32 v[40:41], v[40:41], v[144:145]
    v_pk_mul_f32 v[44:45], v[44:45], v[146:147]
    v_cvt_pk_bf16_f32 v16, v32, v33
    v_cvt_pk_bf16_f32 v17, v36, v37
    v_cvt_pk_bf16_f32 v18, v40, v41
    v_cvt_pk_bf16_f32 v19, v44, v45
    s_nop 1
    v_permlane16_swap_b32 v16, v18
    v_permlane16_swap_b32 v17, v19
    buffer_store_dwordx4 v[16:19], v9, s[12:15], s66 offen offset:0 sc1
    v_pk_fma_f32 v[48:49], v[112:113], v[124:125], v[72:73] op_sel:[0,0,0] op_sel_hi:[0,1,1]
    v_pk_fma_f32 v[52:53], v[112:113], v[126:127], v[74:75] op_sel:[0,0,0] op_sel_hi:[0,1,1]
    v_pk_fma_f32 v[56:57], v[112:113], v[240:241], v[76:77] op_sel:[0,0,0] op_sel_hi:[0,1,1]
    v_pk_fma_f32 v[60:61], v[112:113], v[242:243], v[78:79] op_sel:[0,0,0] op_sel_hi:[0,1,1]
    v_pk_fma_f32 v[160:161], v[104:105], v[160:161], v[48:49] op_sel:[1,0,0] op_sel_hi:[1,1,1]
    v_pk_fma_f32 v[162:163], v[104:105], v[162:163], v[52:53] op_sel:[1,0,0] op_sel_hi:[1,1,1]
    v_pk_fma_f32 v[176:177], v[104:105], v[176:177], v[56:57] op_sel:[1,0,0] op_sel_hi:[1,1,1]
    v_pk_fma_f32 v[178:179], v[104:105], v[178:179], v[60:61] op_sel:[1,0,0] op_sel_hi:[1,1,1]
    v_pk_mul_f32 v[50:51], v[160:161], v[160:161] clamp
    v_pk_mul_f32 v[54:55], v[162:163], v[162:163] clamp
    v_pk_mul_f32 v[58:59], v[176:177], v[176:177] clamp
    v_pk_mul_f32 v[62:63], v[178:179], v[178:179] clamp
    v_pk_fma_f32 v[48:49], v[50:51], v[10:11], s[74:75] op_sel:[0,0,0] op_sel_hi:[1,0,0]
    v_pk_fma_f32 v[52:53], v[54:55], v[10:11], s[74:75] op_sel:[0,0,0] op_sel_hi:[1,0,0]
    v_pk_fma_f32 v[56:57], v[58:59], v[10:11], s[74:75] op_sel:[0,0,0] op_sel_hi:[1,0,0]
    v_pk_fma_f32 v[60:61], v[62:63], v[10:11], s[74:75] op_sel:[0,0,0] op_sel_hi:[1,0,0]
    v_pk_fma_f32 v[48:49], v[48:49], v[50:51], s[72:73] op_sel:[0,0,1] op_sel_hi:[1,1,1]
    v_pk_fma_f32 v[52:53], v[52:53], v[54:55], s[72:73] op_sel:[0,0,1] op_sel_hi:[1,1,1]
    v_pk_fma_f32 v[56:57], v[56:57], v[58:59], s[72:73] op_sel:[0,0,1] op_sel_hi:[1,1,1]
    v_pk_fma_f32 v[60:61], v[60:61], v[62:63], s[72:73] op_sel:[0,0,1] op_sel_hi:[1,1,1]
    v_pk_fma_f32 v[48:49], v[48:49], v[50:51], s[72:73] op_sel:[0,0,0] op_sel_hi:[1,1,0]
    v_pk_fma_f32 v[52:53], v[52:53], v[54:55], s[72:73] op_sel:[0,0,0] op_sel_hi:[1,1,0]
    v_pk_fma_f32 v[56:57], v[56:57], v[58:59], s[72:73] op_sel:[0,0,0] op_sel_hi:[1,1,0]
    v_pk_fma_f32 v[60:61], v[60:61], v[62:63], s[72:73] op_sel:[0,0,0] op_sel_hi:[1,1,0]
    v_pk_fma_f32 v[48:49], v[48:49], v[50:51], s[70:71] op_sel:[0,0,1] op_sel_hi:[1,1,1]
    v_pk_fma_f32 v[52:53], v[52:53], v[54:55], s[70:71] op_sel:[0,0,1] op_sel_hi:[1,1,1]
    v_pk_fma_f32 v[56:57], v[56:57], v[58:59], s[70:71] op_sel:[0,0,1] op_sel_hi:[1,1,1]
    v_pk_fma_f32 v[60:61], v[60:61], v[62:63], s[70:71] op_sel:[0,0,1] op_sel_hi:[1,1,1]
    v_pk_fma_f32 v[48:49], v[48:49], v[50:51], s[70:71] op_sel:[0,0,0] op_sel_hi:[1,1,0]
    v_pk_fma_f32 v[52:53], v[52:53], v[54:55], s[70:71] op_sel:[0,0,0] op_sel_hi:[1,1,0]
    v_pk_fma_f32 v[56:57], v[56:57], v[58:59], s[70:71] op_sel:[0,0,0] op_sel_hi:[1,1,0]
    v_pk_fma_f32 v[60:61], v[60:61], v[62:63], s[70:71] op_sel:[0,0,0] op_sel_hi:[1,1,0]
    v_pk_fma_f32 v[48:49], v[48:49], v[50:51], s[68:69] op_sel:[0,0,1] op_sel_hi:[1,1,1]
    v_pk_fma_f32 v[52:53], v[52:53], v[54:55], s[68:69] op_sel:[0,0,1] op_sel_hi:[1,1,1]
    v_pk_fma_f32 v[56:57], v[56:57], v[58:59], s[68:69] op_sel:[0,0,1] op_sel_hi:[1,1,1]
    v_pk_fma_f32 v[60:61], v[60:61], v[62:63], s[68:69] op_sel:[0,0,1] op_sel_hi:[1,1,1]
    v_pk_fma_f32 v[48:49], v[48:49], v[50:51], s[68:69] op_sel:[0,0,0] op_sel_hi:[1,1,0]
    v_pk_fma_f32 v[52:53], v[52:53], v[54:55], s[68:69] op_sel:[0,0,0] op_sel_hi:[1,1,0]
    v_pk_fma_f32 v[56:57], v[56:57], v[58:59], s[68:69] op_sel:[0,0,0] op_sel_hi:[1,1,0]
    v_pk_fma_f32 v[60:61], v[60:61], v[62:63], s[68:69] op_sel:[0,0,0] op_sel_hi:[1,1,0]
    v_pk_fma_f32 v[48:49], v[48:49], v[160:161], s[74:75] op_sel:[0,0,1] op_sel_hi:[1,1,1] clamp
    v_pk_fma_f32 v[52:53], v[52:53], v[162:163], s[74:75] op_sel:[0,0,1] op_sel_hi:[1,1,1] clamp
    v_pk_fma_f32 v[56:57], v[56:57], v[176:177], s[74:75] op_sel:[0,0,1] op_sel_hi:[1,1,1] clamp
    v_pk_fma_f32 v[60:61], v[60:61], v[178:179], s[74:75] op_sel:[0,0,1] op_sel_hi:[1,1,1] clamp
    v_pk_mul_f32 v[160:161], v[160:161], v[104:105] op_sel:[0,0] op_sel_hi:[1,0]
    v_pk_mul_f32 v[162:163], v[162:163], v[104:105] op_sel:[0,0] op_sel_hi:[1,0]
    v_pk_mul_f32 v[176:177], v[176:177], v[104:105] op_sel:[0,0] op_sel_hi:[1,0]
    v_pk_mul_f32 v[178:179], v[178:179], v[104:105] op_sel:[0,0] op_sel_hi:[1,0]
    v_pk_mul_f32 v[48:49], v[48:49], v[160:161]
    v_pk_mul_f32 v[52:53], v[52:53], v[162:163]
    v_pk_mul_f32 v[56:57], v[56:57], v[176:177]
    v_pk_mul_f32 v[60:61], v[60:61], v[178:179]
    v_cvt_pk_bf16_f32 v20, v48, v49
    v_cvt_pk_bf16_f32 v21, v52, v53
    v_cvt_pk_bf16_f32 v22, v56, v57
    v_cvt_pk_bf16_f32 v23, v60, v61
    s_nop 1
    v_permlane16_swap_b32 v20, v22
    v_permlane16_swap_b32 v21, v23
    buffer_store_dwordx4 v[20:23], v9, s[12:15], s66 offen offset:64 sc1
    v_pk_fma_f32 v[32:33], v[112:113], v[244:245], v[80:81] op_sel:[0,0,0] op_sel_hi:[0,1,1]
    v_pk_fma_f32 v[36:37], v[112:113], v[246:247], v[82:83] op_sel:[0,0,0] op_sel_hi:[0,1,1]
    v_pk_fma_f32 v[40:41], v[112:113], v[248:249], v[84:85] op_sel:[0,0,0] op_sel_hi:[0,1,1]
    v_pk_fma_f32 v[44:45], v[112:113], v[250:251], v[86:87] op_sel:[0,0,0] op_sel_hi:[0,1,1]
    v_pk_fma_f32 v[192:193], v[104:105], v[192:193], v[32:33] op_sel:[1,0,0] op_sel_hi:[1,1,1]
    v_pk_fma_f32 v[194:195], v[104:105], v[194:195], v[36:37] op_sel:[1,0,0] op_sel_hi:[1,1,1]
    v_pk_fma_f32 v[208:209], v[104:105], v[208:209], v[40:41] op_sel:[1,0,0] op_sel_hi:[1,1,1]
    v_pk_fma_f32 v[210:211], v[104:105], v[210:211], v[44:45] op_sel:[1,0,0] op_sel_hi:[1,1,1]
    v_pk_mul_f32 v[34:35], v[192:193], v[192:193] clamp
    v_pk_mul_f32 v[38:39], v[194:195], v[194:195] clamp
    v_pk_mul_f32 v[42:43], v[208:209], v[208:209] clamp
    v_pk_mul_f32 v[46:47], v[210:211], v[210:211] clamp
    v_pk_fma_f32 v[32:33], v[34:35], v[10:11], s[74:75] op_sel:[0,0,0] op_sel_hi:[1,0,0]
    v_pk_fma_f32 v[36:37], v[38:39], v[10:11], s[74:75] op_sel:[0,0,0] op_sel_hi:[1,0,0]
    v_pk_fma_f32 v[40:41], v[42:43], v[10:11], s[74:75] op_sel:[0,0,0] op_sel_hi:[1,0,0]
    v_pk_fma_f32 v[44:45], v[46:47], v[10:11], s[74:75] op_sel:[0,0,0] op_sel_hi:[1,0,0]
    v_pk_fma_f32 v[32:33], v[32:33], v[34:35], s[72:73] op_sel:[0,0,1] op_sel_hi:[1,1,1]
    v_pk_fma_f32 v[36:37], v[36:37], v[38:39], s[72:73] op_sel:[0,0,1] op_sel_hi:[1,1,1]
    v_pk_fma_f32 v[40:41], v[40:41], v[42:43], s[72:73] op_sel:[0,0,1] op_sel_hi:[1,1,1]
    v_pk_fma_f32 v[44:45], v[44:45], v[46:47], s[72:73] op_sel:[0,0,1] op_sel_hi:[1,1,1]
    v_pk_fma_f32 v[32:33], v[32:33], v[34:35], s[72:73] op_sel:[0,0,0] op_sel_hi:[1,1,0]
    v_pk_fma_f32 v[36:37], v[36:37], v[38:39], s[72:73] op_sel:[0,0,0] op_sel_hi:[1,1,0]
    v_pk_fma_f32 v[40:41], v[40:41], v[42:43], s[72:73] op_sel:[0,0,0] op_sel_hi:[1,1,0]
    v_pk_fma_f32 v[44:45], v[44:45], v[46:47], s[72:73] op_sel:[0,0,0] op_sel_hi:[1,1,0]
    v_pk_fma_f32 v[32:33], v[32:33], v[34:35], s[70:71] op_sel:[0,0,1] op_sel_hi:[1,1,1]
    v_pk_fma_f32 v[36:37], v[36:37], v[38:39], s[70:71] op_sel:[0,0,1] op_sel_hi:[1,1,1]
    v_pk_fma_f32 v[40:41], v[40:41], v[42:43], s[70:71] op_sel:[0,0,1] op_sel_hi:[1,1,1]
    v_pk_fma_f32 v[44:45], v[44:45], v[46:47], s[70:71] op_sel:[0,0,1] op_sel_hi:[1,1,1]
    v_pk_fma_f32 v[32:33], v[32:33], v[34:35], s[70:71] op_sel:[0,0,0] op_sel_hi:[1,1,0]
    v_pk_fma_f32 v[36:37], v[36:37], v[38:39], s[70:71] op_sel:[0,0,0] op_sel_hi:[1,1,0]
    v_pk_fma_f32 v[40:41], v[40:41], v[42:43], s[70:71] op_sel:[0,0,0] op_sel_hi:[1,1,0]
    v_pk_fma_f32 v[44:45], v[44:45], v[46:47], s[70:71] op_sel:[0,0,0] op_sel_hi:[1,1,0]
    v_pk_fma_f32 v[32:33], v[32:33], v[34:35], s[68:69] op_sel:[0,0,1] op_sel_hi:[1,1,1]
    v_pk_fma_f32 v[36:37], v[36:37], v[38:39], s[68:69] op_sel:[0,0,1] op_sel_hi:[1,1,1]
    v_pk_fma_f32 v[40:41], v[40:41], v[42:43], s[68:69] op_sel:[0,0,1] op_sel_hi:[1,1,1]
    v_pk_fma_f32 v[44:45], v[44:45], v[46:47], s[68:69] op_sel:[0,0,1] op_sel_hi:[1,1,1]
    v_pk_fma_f32 v[32:33], v[32:33], v[34:35], s[68:69] op_sel:[0,0,0] op_sel_hi:[1,1,0]
    v_pk_fma_f32 v[36:37], v[36:37], v[38:39], s[68:69] op_sel:[0,0,0] op_sel_hi:[1,1,0]
    v_pk_fma_f32 v[40:41], v[40:41], v[42:43], s[68:69] op_sel:[0,0,0] op_sel_hi:[1,1,0]
    v_pk_fma_f32 v[44:45], v[44:45], v[46:47], s[68:69] op_sel:[0,0,0] op_sel_hi:[1,1,0]
    v_pk_fma_f32 v[32:33], v[32:33], v[192:193], s[74:75] op_sel:[0,0,1] op_sel_hi:[1,1,1] clamp
    v_pk_fma_f32 v[36:37], v[36:37], v[194:195], s[74:75] op_sel:[0,0,1] op_sel_hi:[1,1,1] clamp
    v_pk_fma_f32 v[40:41], v[40:41], v[208:209], s[74:75] op_sel:[0,0,1] op_sel_hi:[1,1,1] clamp
    v_pk_fma_f32 v[44:45], v[44:45], v[210:211], s[74:75] op_sel:[0,0,1] op_sel_hi:[1,1,1] clamp
    v_pk_mul_f32 v[192:193], v[192:193], v[104:105] op_sel:[0,0] op_sel_hi:[1,0]
    v_pk_mul_f32 v[194:195], v[194:195], v[104:105] op_sel:[0,0] op_sel_hi:[1,0]
    v_pk_mul_f32 v[208:209], v[208:209], v[104:105] op_sel:[0,0] op_sel_hi:[1,0]
    v_pk_mul_f32 v[210:211], v[210:211], v[104:105] op_sel:[0,0] op_sel_hi:[1,0]
    v_pk_mul_f32 v[32:33], v[32:33], v[192:193]
    v_pk_mul_f32 v[36:37], v[36:37], v[194:195]
    v_pk_mul_f32 v[40:41], v[40:41], v[208:209]
    v_pk_mul_f32 v[44:45], v[44:45], v[210:211]
    v_cvt_pk_bf16_f32 v24, v32, v33
    v_cvt_pk_bf16_f32 v25, v36, v37
    v_cvt_pk_bf16_f32 v26, v40, v41
    v_cvt_pk_bf16_f32 v27, v44, v45
    s_nop 1
    v_permlane16_swap_b32 v24, v26
    v_permlane16_swap_b32 v25, v27
    buffer_store_dwordx4 v[24:27], v9, s[12:15], s66 offen offset:128 sc1
    s_add_u32 s66, s66, 180224
    s_waitcnt lgkmcnt(0)
    s_barrier
    s_cmp_lg_u32 s61, 0
    s_cbranch_scc1 mlp_x3
    ds_read_b64 v[94:95], v12
    ds_read_b64 v[98:99], v12 offset:8
    s_branch mlp_x4
mlp_x3:
    ds_read_b64 v[92:93], v12
    ds_read_b64 v[96:97], v12 offset:8
mlp_x4:
    v_pk_fma_f32 v[48:49], v[112:113], v[116:117], v[64:65] op_sel:[1,0,0] op_sel_hi:[1,1,1]
    v_pk_fma_f32 v[52:53], v[112:113], v[118:119], v[66:67] op_sel:[1,0,0] op_sel_hi:[1,1,1]
    v_pk_fma_f32 v[56:57], v[112:113], v[120:121], v[68:69] op_sel:[1,0,0] op_sel_hi:[1,1,1]
    v_pk_fma_f32 v[60:61], v[112:113], v[122:123], v[70:71] op_sel:[1,0,0] op_sel_hi:[1,1,1]
    v_pk_fma_f32 v[132:133], v[106:107], v[132:133], v[48:49] op_sel:[1,0,0] op_sel_hi:[1,1,1]
    v_pk_fma_f32 v[134:135], v[106:107], v[134:135], v[52:53] op_sel:[1,0,0] op_sel_hi:[1,1,1]
    v_pk_fma_f32 v[148:149], v[106:107], v[148:149], v[56:57] op_sel:[1,0,0] op_sel_hi:[1,1,1]
    v_pk_fma_f32 v[150:151], v[106:107], v[150:151], v[60:61] op_sel:[1,0,0] op_sel_hi:[1,1,1]
    v_pk_mul_f32 v[50:51], v[132:133], v[132:133] clamp
    v_pk_mul_f32 v[54:55], v[134:135], v[134:135] clamp
    v_pk_mul_f32 v[58:59], v[148:149], v[148:149] clamp
    v_pk_mul_f32 v[62:63], v[150:151], v[150:151] clamp
    v_pk_fma_f32 v[48:49], v[50:51], v[10:11], s[74:75] op_sel:[0,0,0] op_sel_hi:[1,0,0]
    v_pk_fma_f32 v[52:53], v[54:55], v[10:11], s[74:75] op_sel:[0,0,0] op_sel_hi:[1,0,0]
    v_pk_fma_f32 v[56:57], v[58:59], v[10:11], s[74:75] op_sel:[0,0,0] op_sel_hi:[1,0,0]
    v_pk_fma_f32 v[60:61], v[62:63], v[10:11], s[74:75] op_sel:[0,0,0] op_sel_hi:[1,0,0]
    v_pk_fma_f32 v[48:49], v[48:49], v[50:51], s[72:73] op_sel:[0,0,1] op_sel_hi:[1,1,1]
    v_pk_fma_f32 v[52:53], v[52:53], v[54:55], s[72:73] op_sel:[0,0,1] op_sel_hi:[1,1,1]
    v_pk_fma_f32 v[56:57], v[56:57], v[58:59], s[72:73] op_sel:[0,0,1] op_sel_hi:[1,1,1]
    v_pk_fma_f32 v[60:61], v[60:61], v[62:63], s[72:73] op_sel:[0,0,1] op_sel_hi:[1,1,1]
    v_pk_fma_f32 v[48:49], v[48:49], v[50:51], s[72:73] op_sel:[0,0,0] op_sel_hi:[1,1,0]
    v_pk_fma_f32 v[52:53], v[52:53], v[54:55], s[72:73] op_sel:[0,0,0] op_sel_hi:[1,1,0]
    v_pk_fma_f32 v[56:57], v[56:57], v[58:59], s[72:73] op_sel:[0,0,0] op_sel_hi:[1,1,0]
    v_pk_fma_f32 v[60:61], v[60:61], v[62:63], s[72:73] op_sel:[0,0,0] op_sel_hi:[1,1,0]
    v_pk_fma_f32 v[48:49], v[48:49], v[50:51], s[70:71] op_sel:[0,0,1] op_sel_hi:[1,1,1]
    v_pk_fma_f32 v[52:53], v[52:53], v[54:55], s[70:71] op_sel:[0,0,1] op_sel_hi:[1,1,1]
    v_pk_fma_f32 v[56:57], v[56:57], v[58:59], s[70:71] op_sel:[0,0,1] op_sel_hi:[1,1,1]
    v_pk_fma_f32 v[60:61], v[60:61], v[62:63], s[70:71] op_sel:[0,0,1] op_sel_hi:[1,1,1]
    v_pk_fma_f32 v[48:49], v[48:49], v[50:51], s[70:71] op_sel:[0,0,0] op_sel_hi:[1,1,0]
    v_pk_fma_f32 v[52:53], v[52:53], v[54:55], s[70:71] op_sel:[0,0,0] op_sel_hi:[1,1,0]
    v_pk_fma_f32 v[56:57], v[56:57], v[58:59], s[70:71] op_sel:[0,0,0] op_sel_hi:[1,1,0]
    v_pk_fma_f32 v[60:61], v[60:61], v[62:63], s[70:71] op_sel:[0,0,0] op_sel_hi:[1,1,0]
    v_pk_fma_f32 v[48:49], v[48:49], v[50:51], s[68:69] op_sel:[0,0,1] op_sel_hi:[1,1,1]
    v_pk_fma_f32 v[52:53], v[52:53], v[54:55], s[68:69] op_sel:[0,0,1] op_sel_hi:[1,1,1]
    v_pk_fma_f32 v[56:57], v[56:57], v[58:59], s[68:69] op_sel:[0,0,1] op_sel_hi:[1,1,1]
    v_pk_fma_f32 v[60:61], v[60:61], v[62:63], s[68:69] op_sel:[0,0,1] op_sel_hi:[1,1,1]
    v_pk_fma_f32 v[48:49], v[48:49], v[50:51], s[68:69] op_sel:[0,0,0] op_sel_hi:[1,1,0]
    v_pk_fma_f32 v[52:53], v[52:53], v[54:55], s[68:69] op_sel:[0,0,0] op_sel_hi:[1,1,0]
    v_pk_fma_f32 v[56:57], v[56:57], v[58:59], s[68:69] op_sel:[0,0,0] op_sel_hi:[1,1,0]
    v_pk_fma_f32 v[60:61], v[60:61], v[62:63], s[68:69] op_sel:[0,0,0] op_sel_hi:[1,1,0]
    v_pk_fma_f32 v[48:49], v[48:49], v[132:133], s[74:75] op_sel:[0,0,1] op_sel_hi:[1,1,1] clamp
    v_pk_fma_f32 v[52:53], v[52:53], v[134:135], s[74:75] op_sel:[0,0,1] op_sel_hi:[1,1,1] clamp
    v_pk_fma_f32 v[56:57], v[56:57], v[148:149], s[74:75] op_sel:[0,0,1] op_sel_hi:[1,1,1] clamp
    v_pk_fma_f32 v[60:61], v[60:61], v[150:151], s[74:75] op_sel:[0,0,1] op_sel_hi:[1,1,1] clamp
    v_pk_mul_f32 v[132:133], v[132:133], v[106:107] op_sel:[0,0] op_sel_hi:[1,0]
    v_pk_mul_f32 v[134:135], v[134:135], v[106:107] op_sel:[0,0] op_sel_hi:[1,0]
    v_pk_mul_f32 v[148:149], v[148:149], v[106:107] op_sel:[0,0] op_sel_hi:[1,0]
    v_pk_mul_f32 v[150:151], v[150:151], v[106:107] op_sel:[0,0] op_sel_hi:[1,0]
    v_pk_mul_f32 v[48:49], v[48:49], v[132:133]
    v_pk_mul_f32 v[52:53], v[52:53], v[134:135]
    v_pk_mul_f32 v[56:57], v[56:57], v[148:149]
    v_pk_mul_f32 v[60:61], v[60:61], v[150:151]
    v_cvt_pk_bf16_f32 v28, v48, v49
    v_cvt_pk_bf16_f32 v29, v52, v53
    v_cvt_pk_bf16_f32 v30, v56, v57
    v_cvt_pk_bf16_f32 v31, v60, v61
    s_nop 1
    v_permlane16_swap_b32 v28, v30
    v_permlane16_swap_b32 v29, v31
    buffer_store_dwordx4 v[28:31], v9, s[12:15], s66 offen offset:0 sc1
    v_pk_fma_f32 v[32:33], v[112:113], v[124:125], v[72:73] op_sel:[1,0,0] op_sel_hi:[1,1,1]
    v_pk_fma_f32 v[36:37], v[112:113], v[126:127], v[74:75] op_sel:[1,0,0] op_sel_hi:[1,1,1]
    v_pk_fma_f32 v[40:41], v[112:113], v[240:241], v[76:77] op_sel:[1,0,0] op_sel_hi:[1,1,1]
    v_pk_fma_f32 v[44:45], v[112:113], v[242:243], v[78:79] op_sel:[1,0,0] op_sel_hi:[1,1,1]
    v_pk_fma_f32 v[164:165], v[106:107], v[164:165], v[32:33] op_sel:[1,0,0] op_sel_hi:[1,1,1]
    v_pk_fma_f32 v[166:167], v[106:107], v[166:167], v[36:37] op_sel:[1,0,0] op_sel_hi:[1,1,1]
    v_pk_fma_f32 v[180:181], v[106:107], v[180:181], v[40:41] op_sel:[1,0,0] op_sel_hi:[1,1,1]
    v_pk_fma_f32 v[182:183], v[106:107], v[182:183], v[44:45] op_sel:[1,0,0] op_sel_hi:[1,1,1]
    v_pk_mul_f32 v[34:35], v[164:165], v[164:165] clamp
    v_pk_mul_f32 v[38:39], v[166:167], v[166:167] clamp
    v_pk_mul_f32 v[42:43], v[180:181], v[180:181] clamp
    v_pk_mul_f32 v[46:47], v[182:183], v[182:183] clamp
    v_pk_fma_f32 v[32:33], v[34:35], v[10:11], s[74:75] op_sel:[0,0,0] op_sel_hi:[1,0,0]
    v_pk_fma_f32 v[36:37], v[38:39], v[10:11], s[74:75] op_sel:[0,0,0] op_sel_hi:[1,0,0]
    v_pk_fma_f32 v[40:41], v[42:43], v[10:11], s[74:75] op_sel:[0,0,0] op_sel_hi:[1,0,0]
    v_pk_fma_f32 v[44:45], v[46:47], v[10:11], s[74:75] op_sel:[0,0,0] op_sel_hi:[1,0,0]
    v_pk_fma_f32 v[32:33], v[32:33], v[34:35], s[72:73] op_sel:[0,0,1] op_sel_hi:[1,1,1]
    v_pk_fma_f32 v[36:37], v[36:37], v[38:39], s[72:73] op_sel:[0,0,1] op_sel_hi:[1,1,1]
    v_pk_fma_f32 v[40:41], v[40:41], v[42:43], s[72:73] op_sel:[0,0,1] op_sel_hi:[1,1,1]
    v_pk_fma_f32 v[44:45], v[44:45], v[46:47], s[72:73] op_sel:[0,0,1] op_sel_hi:[1,1,1]
    v_pk_fma_f32 v[32:33], v[32:33], v[34:35], s[72:73] op_sel:[0,0,0] op_sel_hi:[1,1,0]
    v_pk_fma_f32 v[36:37], v[36:37], v[38:39], s[72:73] op_sel:[0,0,0] op_sel_hi:[1,1,0]
    v_pk_fma_f32 v[40:41], v[40:41], v[42:43], s[72:73] op_sel:[0,0,0] op_sel_hi:[1,1,0]
    v_pk_fma_f32 v[44:45], v[44:45], v[46:47], s[72:73] op_sel:[0,0,0] op_sel_hi:[1,1,0]
    v_pk_fma_f32 v[32:33], v[32:33], v[34:35], s[70:71] op_sel:[0,0,1] op_sel_hi:[1,1,1]
    v_pk_fma_f32 v[36:37], v[36:37], v[38:39], s[70:71] op_sel:[0,0,1] op_sel_hi:[1,1,1]
    v_pk_fma_f32 v[40:41], v[40:41], v[42:43], s[70:71] op_sel:[0,0,1] op_sel_hi:[1,1,1]
    v_pk_fma_f32 v[44:45], v[44:45], v[46:47], s[70:71] op_sel:[0,0,1] op_sel_hi:[1,1,1]
    v_pk_fma_f32 v[32:33], v[32:33], v[34:35], s[70:71] op_sel:[0,0,0] op_sel_hi:[1,1,0]
    v_pk_fma_f32 v[36:37], v[36:37], v[38:39], s[70:71] op_sel:[0,0,0] op_sel_hi:[1,1,0]
    v_pk_fma_f32 v[40:41], v[40:41], v[42:43], s[70:71] op_sel:[0,0,0] op_sel_hi:[1,1,0]
    v_pk_fma_f32 v[44:45], v[44:45], v[46:47], s[70:71] op_sel:[0,0,0] op_sel_hi:[1,1,0]
    v_pk_fma_f32 v[32:33], v[32:33], v[34:35], s[68:69] op_sel:[0,0,1] op_sel_hi:[1,1,1]
    v_pk_fma_f32 v[36:37], v[36:37], v[38:39], s[68:69] op_sel:[0,0,1] op_sel_hi:[1,1,1]
    v_pk_fma_f32 v[40:41], v[40:41], v[42:43], s[68:69] op_sel:[0,0,1] op_sel_hi:[1,1,1]
    v_pk_fma_f32 v[44:45], v[44:45], v[46:47], s[68:69] op_sel:[0,0,1] op_sel_hi:[1,1,1]
    v_pk_fma_f32 v[32:33], v[32:33], v[34:35], s[68:69] op_sel:[0,0,0] op_sel_hi:[1,1,0]
    v_pk_fma_f32 v[36:37], v[36:37], v[38:39], s[68:69] op_sel:[0,0,0] op_sel_hi:[1,1,0]
    v_pk_fma_f32 v[40:41], v[40:41], v[42:43], s[68:69] op_sel:[0,0,0] op_sel_hi:[1,1,0]
    v_pk_fma_f32 v[44:45], v[44:45], v[46:47], s[68:69] op_sel:[0,0,0] op_sel_hi:[1,1,0]
    v_pk_fma_f32 v[32:33], v[32:33], v[164:165], s[74:75] op_sel:[0,0,1] op_sel_hi:[1,1,1] clamp
    v_pk_fma_f32 v[36:37], v[36:37], v[166:167], s[74:75] op_sel:[0,0,1] op_sel_hi:[1,1,1] clamp
    v_pk_fma_f32 v[40:41], v[40:41], v[180:181], s[74:75] op_sel:[0,0,1] op_sel_hi:[1,1,1] clamp
    v_pk_fma_f32 v[44:45], v[44:45], v[182:183], s[74:75] op_sel:[0,0,1] op_sel_hi:[1,1,1] clamp
    v_pk_mul_f32 v[164:165], v[164:165], v[106:107] op_sel:[0,0] op_sel_hi:[1,0]
    v_pk_mul_f32 v[166:167], v[166:167], v[106:107] op_sel:[0,0] op_sel_hi:[1,0]
    v_pk_mul_f32 v[180:181], v[180:181], v[106:107] op_sel:[0,0] op_sel_hi:[1,0]
    v_pk_mul_f32 v[182:183], v[182:183], v[106:107] op_sel:[0,0] op_sel_hi:[1,0]
    v_pk_mul_f32 v[32:33], v[32:33], v[164:165]
    v_pk_mul_f32 v[36:37], v[36:37], v[166:167]
    v_pk_mul_f32 v[40:41], v[40:41], v[180:181]
    v_pk_mul_f32 v[44:45], v[44:45], v[182:183]
    v_cvt_pk_bf16_f32 v16, v32, v33
    v_cvt_pk_bf16_f32 v17, v36, v37
    v_cvt_pk_bf16_f32 v18, v40, v41
    v_cvt_pk_bf16_f32 v19, v44, v45
    s_nop 1
    v_permlane16_swap_b32 v16, v18
    v_permlane16_swap_b32 v17, v19
    buffer_store_dwordx4 v[16:19], v9, s[12:15], s66 offen offset:64 sc1
    v_pk_fma_f32 v[48:49], v[112:113], v[244:245], v[80:81] op_sel:[1,0,0] op_sel_hi:[1,1,1]
    v_pk_fma_f32 v[52:53], v[112:113], v[246:247], v[82:83] op_sel:[1,0,0] op_sel_hi:[1,1,1]
    v_pk_fma_f32 v[56:57], v[112:113], v[248:249], v[84:85] op_sel:[1,0,0] op_sel_hi:[1,1,1]
    v_pk_fma_f32 v[60:61], v[112:113], v[250:251], v[86:87] op_sel:[1,0,0] op_sel_hi:[1,1,1]
    v_pk_fma_f32 v[196:197], v[106:107], v[196:197], v[48:49] op_sel:[1,0,0] op_sel_hi:[1,1,1]
    v_pk_fma_f32 v[198:199], v[106:107], v[198:199], v[52:53] op_sel:[1,0,0] op_sel_hi:[1,1,1]
    v_pk_fma_f32 v[212:213], v[106:107], v[212:213], v[56:57] op_sel:[1,0,0] op_sel_hi:[1,1,1]
    v_pk_fma_f32 v[214:215], v[106:107], v[214:215], v[60:61] op_sel:[1,0,0] op_sel_hi:[1,1,1]
    v_pk_mul_f32 v[50:51], v[196:197], v[196:197] clamp
    v_pk_mul_f32 v[54:55], v[198:199], v[198:199] clamp
    v_pk_mul_f32 v[58:59], v[212:213], v[212:213] clamp
    v_pk_mul_f32 v[62:63], v[214:215], v[214:215] clamp
    v_pk_fma_f32 v[48:49], v[50:51], v[10:11], s[74:75] op_sel:[0,0,0] op_sel_hi:[1,0,0]
    v_pk_fma_f32 v[52:53], v[54:55], v[10:11], s[74:75] op_sel:[0,0,0] op_sel_hi:[1,0,0]
    v_pk_fma_f32 v[56:57], v[58:59], v[10:11], s[74:75] op_sel:[0,0,0] op_sel_hi:[1,0,0]
    v_pk_fma_f32 v[60:61], v[62:63], v[10:11], s[74:75] op_sel:[0,0,0] op_sel_hi:[1,0,0]
    v_pk_fma_f32 v[48:49], v[48:49], v[50:51], s[72:73] op_sel:[0,0,1] op_sel_hi:[1,1,1]
    v_pk_fma_f32 v[52:53], v[52:53], v[54:55], s[72:73] op_sel:[0,0,1] op_sel_hi:[1,1,1]
    v_pk_fma_f32 v[56:57], v[56:57], v[58:59], s[72:73] op_sel:[0,0,1] op_sel_hi:[1,1,1]
    v_pk_fma_f32 v[60:61], v[60:61], v[62:63], s[72:73] op_sel:[0,0,1] op_sel_hi:[1,1,1]
    v_pk_fma_f32 v[48:49], v[48:49], v[50:51], s[72:73] op_sel:[0,0,0] op_sel_hi:[1,1,0]
    v_pk_fma_f32 v[52:53], v[52:53], v[54:55], s[72:73] op_sel:[0,0,0] op_sel_hi:[1,1,0]
    v_pk_fma_f32 v[56:57], v[56:57], v[58:59], s[72:73] op_sel:[0,0,0] op_sel_hi:[1,1,0]
    v_pk_fma_f32 v[60:61], v[60:61], v[62:63], s[72:73] op_sel:[0,0,0] op_sel_hi:[1,1,0]
    v_pk_fma_f32 v[48:49], v[48:49], v[50:51], s[70:71] op_sel:[0,0,1] op_sel_hi:[1,1,1]
    v_pk_fma_f32 v[52:53], v[52:53], v[54:55], s[70:71] op_sel:[0,0,1] op_sel_hi:[1,1,1]
    v_pk_fma_f32 v[56:57], v[56:57], v[58:59], s[70:71] op_sel:[0,0,1] op_sel_hi:[1,1,1]
    v_pk_fma_f32 v[60:61], v[60:61], v[62:63], s[70:71] op_sel:[0,0,1] op_sel_hi:[1,1,1]
    v_pk_fma_f32 v[48:49], v[48:49], v[50:51], s[70:71] op_sel:[0,0,0] op_sel_hi:[1,1,0]
    v_pk_fma_f32 v[52:53], v[52:53], v[54:55], s[70:71] op_sel:[0,0,0] op_sel_hi:[1,1,0]
    v_pk_fma_f32 v[56:57], v[56:57], v[58:59], s[70:71] op_sel:[0,0,0] op_sel_hi:[1,1,0]
    v_pk_fma_f32 v[60:61], v[60:61], v[62:63], s[70:71] op_sel:[0,0,0] op_sel_hi:[1,1,0]
    v_pk_fma_f32 v[48:49], v[48:49], v[50:51], s[68:69] op_sel:[0,0,1] op_sel_hi:[1,1,1]
    v_pk_fma_f32 v[52:53], v[52:53], v[54:55], s[68:69] op_sel:[0,0,1] op_sel_hi:[1,1,1]
    v_pk_fma_f32 v[56:57], v[56:57], v[58:59], s[68:69] op_sel:[0,0,1] op_sel_hi:[1,1,1]
    v_pk_fma_f32 v[60:61], v[60:61], v[62:63], s[68:69] op_sel:[0,0,1] op_sel_hi:[1,1,1]
    v_pk_fma_f32 v[48:49], v[48:49], v[50:51], s[68:69] op_sel:[0,0,0] op_sel_hi:[1,1,0]
    v_pk_fma_f32 v[52:53], v[52:53], v[54:55], s[68:69] op_sel:[0,0,0] op_sel_hi:[1,1,0]
    v_pk_fma_f32 v[56:57], v[56:57], v[58:59], s[68:69] op_sel:[0,0,0] op_sel_hi:[1,1,0]
    v_pk_fma_f32 v[60:61], v[60:61], v[62:63], s[68:69] op_sel:[0,0,0] op_sel_hi:[1,1,0]
    v_pk_fma_f32 v[48:49], v[48:49], v[196:197], s[74:75] op_sel:[0,0,1] op_sel_hi:[1,1,1] clamp
    v_pk_fma_f32 v[52:53], v[52:53], v[198:199], s[74:75] op_sel:[0,0,1] op_sel_hi:[1,1,1] clamp
    v_pk_fma_f32 v[56:57], v[56:57], v[212:213], s[74:75] op_sel:[0,0,1] op_sel_hi:[1,1,1] clamp
    v_pk_fma_f32 v[60:61], v[60:61], v[214:215], s[74:75] op_sel:[0,0,1] op_sel_hi:[1,1,1] clamp
    v_pk_mul_f32 v[196:197], v[196:197], v[106:107] op_sel:[0,0] op_sel_hi:[1,0]
    v_pk_mul_f32 v[198:199], v[198:199], v[106:107] op_sel:[0,0] op_sel_hi:[1,0]
    v_pk_mul_f32 v[212:213], v[212:213], v[106:107] op_sel:[0,0] op_sel_hi:[1,0]
    v_pk_mul_f32 v[214:215], v[214:215], v[106:107] op_sel:[0,0] op_sel_hi:[1,0]
    v_pk_mul_f32 v[48:49], v[48:49], v[196:197]
    v_pk_mul_f32 v[52:53], v[52:53], v[198:199]
    v_pk_mul_f32 v[56:57], v[56:57], v[212:213]
    v_pk_mul_f32 v[60:61], v[60:61], v[214:215]
    v_cvt_pk_bf16_f32 v20, v48, v49
    v_cvt_pk_bf16_f32 v21, v52, v53
    v_cvt_pk_bf16_f32 v22, v56, v57
    v_cvt_pk_bf16_f32 v23, v60, v61
    s_nop 1
    v_permlane16_swap_b32 v20, v22
    v_permlane16_swap_b32 v21, v23
    buffer_store_dwordx4 v[20:23], v9, s[12:15], s66 offen offset:128 sc1
    s_add_u32 s66, s66, 180224
    s_add_u32 s76, s58, 4456448
    s_addc_u32 s77, s59, 0
    s_mov_b32 s78, 65536
    s_mov_b32 s79, 0x00020000
    s_lshl_b32 s80, s34, 3
    s_and_b32 s81, s2, 2
    s_lshl_b32 s81, s81, 1
    s_add_u32 s80, s80, s81
    s_bfe_u32 s81, s2, 0x20005
    s_add_u32 s80, s80, s81
    s_lshl_b32 s80, s80, 2
    s_bfe_u32 s81, s2, 0x10002
    s_add_u32 s80, s80, s81
    s_add_u32 s80, s80, 2
    s_lshl_b32 s80, s80, 8
    v_lshlrev_b32 v13, 2, v6
    buffer_load_dword v14, v13, s[76:79], s80 offen sc0 sc1
    v_pk_fma_f32 v[32:33], v[114:115], v[116:117], v[64:65] op_sel:[0,0,0] op_sel_hi:[0,1,1]
    v_pk_fma_f32 v[36:37], v[114:115], v[118:119], v[66:67] op_sel:[0,0,0] op_sel_hi:[0,1,1]
    v_pk_fma_f32 v[40:41], v[114:115], v[120:121], v[68:69] op_sel:[0,0,0] op_sel_hi:[0,1,1]
    v_pk_fma_f32 v[44:45], v[114:115], v[122:123], v[70:71] op_sel:[0,0,0] op_sel_hi:[0,1,1]
    v_pk_fma_f32 v[136:137], v[108:109], v[136:137], v[32:33] op_sel:[1,0,0] op_sel_hi:[1,1,1]
    v_pk_fma_f32 v[138:139], v[108:109], v[138:139], v[36:37] op_sel:[1,0,0] op_sel_hi:[1,1,1]
    v_pk_fma_f32 v[152:153], v[108:109], v[152:153], v[40:41] op_sel:[1,0,0] op_sel_hi:[1,1,1]
    v_pk_fma_f32 v[154:155], v[108:109], v[154:155], v[44:45] op_sel:[1,0,0] op_sel_hi:[1,1,1]
    v_pk_mul_f32 v[34:35], v[136:137], v[136:137] clamp
    v_pk_mul_f32 v[38:39], v[138:139], v[138:139] clamp
    v_pk_mul_f32 v[42:43], v[152:153], v[152:153] clamp
    v_pk_mul_f32 v[46:47], v[154:155], v[154:155] clamp
    v_pk_fma_f32 v[32:33], v[34:35], v[10:11], s[74:75] op_sel:[0,0,0] op_sel_hi:[1,0,0]
    v_pk_fma_f32 v[36:37], v[38:39], v[10:11], s[74:75] op_sel:[0,0,0] op_sel_hi:[1,0,0]
    v_pk_fma_f32 v[40:41], v[42:43], v[10:11], s[74:75] op_sel:[0,0,0] op_sel_hi:[1,0,0]
    v_pk_fma_f32 v[44:45], v[46:47], v[10:11], s[74:75] op_sel:[0,0,0] op_sel_hi:[1,0,0]
    v_pk_fma_f32 v[32:33], v[32:33], v[34:35], s[72:73] op_sel:[0,0,1] op_sel_hi:[1,1,1]
    v_pk_fma_f32 v[36:37], v[36:37], v[38:39], s[72:73] op_sel:[0,0,1] op_sel_hi:[1,1,1]
    v_pk_fma_f32 v[40:41], v[40:41], v[42:43], s[72:73] op_sel:[0,0,1] op_sel_hi:[1,1,1]
    v_pk_fma_f32 v[44:45], v[44:45], v[46:47], s[72:73] op_sel:[0,0,1] op_sel_hi:[1,1,1]
    v_pk_fma_f32 v[32:33], v[32:33], v[34:35], s[72:73] op_sel:[0,0,0] op_sel_hi:[1,1,0]
    v_pk_fma_f32 v[36:37], v[36:37], v[38:39], s[72:73] op_sel:[0,0,0] op_sel_hi:[1,1,0]
    v_pk_fma_f32 v[40:41], v[40:41], v[42:43], s[72:73] op_sel:[0,0,0] op_sel_hi:[1,1,0]
    v_pk_fma_f32 v[44:45], v[44:45], v[46:47], s[72:73] op_sel:[0,0,0] op_sel_hi:[1,1,0]
    v_pk_fma_f32 v[32:33], v[32:33], v[34:35], s[70:71] op_sel:[0,0,1] op_sel_hi:[1,1,1]
    v_pk_fma_f32 v[36:37], v[36:37], v[38:39], s[70:71] op_sel:[0,0,1] op_sel_hi:[1,1,1]
    v_pk_fma_f32 v[40:41], v[40:41], v[42:43], s[70:71] op_sel:[0,0,1] op_sel_hi:[1,1,1]
    v_pk_fma_f32 v[44:45], v[44:45], v[46:47], s[70:71] op_sel:[0,0,1] op_sel_hi:[1,1,1]
    v_pk_fma_f32 v[32:33], v[32:33], v[34:35], s[70:71] op_sel:[0,0,0] op_sel_hi:[1,1,0]
    v_pk_fma_f32 v[36:37], v[36:37], v[38:39], s[70:71] op_sel:[0,0,0] op_sel_hi:[1,1,0]
    v_pk_fma_f32 v[40:41], v[40:41], v[42:43], s[70:71] op_sel:[0,0,0] op_sel_hi:[1,1,0]
    v_pk_fma_f32 v[44:45], v[44:45], v[46:47], s[70:71] op_sel:[0,0,0] op_sel_hi:[1,1,0]
    v_pk_fma_f32 v[32:33], v[32:33], v[34:35], s[68:69] op_sel:[0,0,1] op_sel_hi:[1,1,1]
    v_pk_fma_f32 v[36:37], v[36:37], v[38:39], s[68:69] op_sel:[0,0,1] op_sel_hi:[1,1,1]
    v_pk_fma_f32 v[40:41], v[40:41], v[42:43], s[68:69] op_sel:[0,0,1] op_sel_hi:[1,1,1]
    v_pk_fma_f32 v[44:45], v[44:45], v[46:47], s[68:69] op_sel:[0,0,1] op_sel_hi:[1,1,1]
    v_pk_fma_f32 v[32:33], v[32:33], v[34:35], s[68:69] op_sel:[0,0,0] op_sel_hi:[1,1,0]
    v_pk_fma_f32 v[36:37], v[36:37], v[38:39], s[68:69] op_sel:[0,0,0] op_sel_hi:[1,1,0]
    v_pk_fma_f32 v[40:41], v[40:41], v[42:43], s[68:69] op_sel:[0,0,0] op_sel_hi:[1,1,0]
    v_pk_fma_f32 v[44:45], v[44:45], v[46:47], s[68:69] op_sel:[0,0,0] op_sel_hi:[1,1,0]
    v_pk_fma_f32 v[32:33], v[32:33], v[136:137], s[74:75] op_sel:[0,0,1] op_sel_hi:[1,1,1] clamp
    v_pk_fma_f32 v[36:37], v[36:37], v[138:139], s[74:75] op_sel:[0,0,1] op_sel_hi:[1,1,1] clamp
    v_pk_fma_f32 v[40:41], v[40:41], v[152:153], s[74:75] op_sel:[0,0,1] op_sel_hi:[1,1,1] clamp
    v_pk_fma_f32 v[44:45], v[44:45], v[154:155], s[74:75] op_sel:[0,0,1] op_sel_hi:[1,1,1] clamp
    v_pk_mul_f32 v[136:137], v[136:137], v[108:109] op_sel:[0,0] op_sel_hi:[1,0]
    v_pk_mul_f32 v[138:139], v[138:139], v[108:109] op_sel:[0,0] op_sel_hi:[1,0]
    v_pk_mul_f32 v[152:153], v[152:153], v[108:109] op_sel:[0,0] op_sel_hi:[1,0]
    v_pk_mul_f32 v[154:155], v[154:155], v[108:109] op_sel:[0,0] op_sel_hi:[1,0]
    v_pk_mul_f32 v[32:33], v[32:33], v[136:137]
    v_pk_mul_f32 v[36:37], v[36:37], v[138:139]
    v_pk_mul_f32 v[40:41], v[40:41], v[152:153]
    v_pk_mul_f32 v[44:45], v[44:45], v[154:155]
    v_cvt_pk_bf16_f32 v24, v32, v33
    v_cvt_pk_bf16_f32 v25, v36, v37
    v_cvt_pk_bf16_f32 v26, v40, v41
    v_cvt_pk_bf16_f32 v27, v44, v45
    s_nop 1
    v_permlane16_swap_b32 v24, v26
    v_permlane16_swap_b32 v25, v27
    buffer_store_dwordx4 v[24:27], v9, s[12:15], s66 offen offset:0 sc1
    v_pk_fma_f32 v[48:49], v[114:115], v[124:125], v[72:73] op_sel:[0,0,0] op_sel_hi:[0,1,1]
    v_pk_fma_f32 v[52:53], v[114:115], v[126:127], v[74:75] op_sel:[0,0,0] op_sel_hi:[0,1,1]
    v_pk_fma_f32 v[56:57], v[114:115], v[240:241], v[76:77] op_sel:[0,0,0] op_sel_hi:[0,1,1]
    v_pk_fma_f32 v[60:61], v[114:115], v[242:243], v[78:79] op_sel:[0,0,0] op_sel_hi:[0,1,1]
    v_pk_fma_f32 v[168:169], v[108:109], v[168:169], v[48:49] op_sel:[1,0,0] op_sel_hi:[1,1,1]
    v_pk_fma_f32 v[170:171], v[108:109], v[170:171], v[52:53] op_sel:[1,0,0] op_sel_hi:[1,1,1]
    v_pk_fma_f32 v[184:185], v[108:109], v[184:185], v[56:57] op_sel:[1,0,0] op_sel_hi:[1,1,1]
    v_pk_fma_f32 v[186:187], v[108:109], v[186:187], v[60:61] op_sel:[1,0,0] op_sel_hi:[1,1,1]
    v_pk_mul_f32 v[50:51], v[168:169], v[168:169] clamp
    v_pk_mul_f32 v[54:55], v[170:171], v[170:171] clamp
    v_pk_mul_f32 v[58:59], v[184:185], v[184:185] clamp
    v_pk_mul_f32 v[62:63], v[186:187], v[186:187] clamp
    v_pk_fma_f32 v[48:49], v[50:51], v[10:11], s[74:75] op_sel:[0,0,0] op_sel_hi:[1,0,0]
    v_pk_fma_f32 v[52:53], v[54:55], v[10:11], s[74:75] op_sel:[0,0,0] op_sel_hi:[1,0,0]
    v_pk_fma_f32 v[56:57], v[58:59], v[10:11], s[74:75] op_sel:[0,0,0] op_sel_hi:[1,0,0]
    v_pk_fma_f32 v[60:61], v[62:63], v[10:11], s[74:75] op_sel:[0,0,0] op_sel_hi:[1,0,0]
    v_pk_fma_f32 v[48:49], v[48:49], v[50:51], s[72:73] op_sel:[0,0,1] op_sel_hi:[1,1,1]
    v_pk_fma_f32 v[52:53], v[52:53], v[54:55], s[72:73] op_sel:[0,0,1] op_sel_hi:[1,1,1]
    v_pk_fma_f32 v[56:57], v[56:57], v[58:59], s[72:73] op_sel:[0,0,1] op_sel_hi:[1,1,1]
    v_pk_fma_f32 v[60:61], v[60:61], v[62:63], s[72:73] op_sel:[0,0,1] op_sel_hi:[1,1,1]
    v_pk_fma_f32 v[48:49], v[48:49], v[50:51], s[72:73] op_sel:[0,0,0] op_sel_hi:[1,1,0]
    v_pk_fma_f32 v[52:53], v[52:53], v[54:55], s[72:73] op_sel:[0,0,0] op_sel_hi:[1,1,0]
    v_pk_fma_f32 v[56:57], v[56:57], v[58:59], s[72:73] op_sel:[0,0,0] op_sel_hi:[1,1,0]
    v_pk_fma_f32 v[60:61], v[60:61], v[62:63], s[72:73] op_sel:[0,0,0] op_sel_hi:[1,1,0]
    v_pk_fma_f32 v[48:49], v[48:49], v[50:51], s[70:71] op_sel:[0,0,1] op_sel_hi:[1,1,1]
    v_pk_fma_f32 v[52:53], v[52:53], v[54:55], s[70:71] op_sel:[0,0,1] op_sel_hi:[1,1,1]
    v_pk_fma_f32 v[56:57], v[56:57], v[58:59], s[70:71] op_sel:[0,0,1] op_sel_hi:[1,1,1]
    v_pk_fma_f32 v[60:61], v[60:61], v[62:63], s[70:71] op_sel:[0,0,1] op_sel_hi:[1,1,1]
    v_pk_fma_f32 v[48:49], v[48:49], v[50:51], s[70:71] op_sel:[0,0,0] op_sel_hi:[1,1,0]
    v_pk_fma_f32 v[52:53], v[52:53], v[54:55], s[70:71] op_sel:[0,0,0] op_sel_hi:[1,1,0]
    v_pk_fma_f32 v[56:57], v[56:57], v[58:59], s[70:71] op_sel:[0,0,0] op_sel_hi:[1,1,0]
    v_pk_fma_f32 v[60:61], v[60:61], v[62:63], s[70:71] op_sel:[0,0,0] op_sel_hi:[1,1,0]
    v_pk_fma_f32 v[48:49], v[48:49], v[50:51], s[68:69] op_sel:[0,0,1] op_sel_hi:[1,1,1]
    v_pk_fma_f32 v[52:53], v[52:53], v[54:55], s[68:69] op_sel:[0,0,1] op_sel_hi:[1,1,1]
    v_pk_fma_f32 v[56:57], v[56:57], v[58:59], s[68:69] op_sel:[0,0,1] op_sel_hi:[1,1,1]
    v_pk_fma_f32 v[60:61], v[60:61], v[62:63], s[68:69] op_sel:[0,0,1] op_sel_hi:[1,1,1]
    v_pk_fma_f32 v[48:49], v[48:49], v[50:51], s[68:69] op_sel:[0,0,0] op_sel_hi:[1,1,0]
    v_pk_fma_f32 v[52:53], v[52:53], v[54:55], s[68:69] op_sel:[0,0,0] op_sel_hi:[1,1,0]
    v_pk_fma_f32 v[56:57], v[56:57], v[58:59], s[68:69] op_sel:[0,0,0] op_sel_hi:[1,1,0]
    v_pk_fma_f32 v[60:61], v[60:61], v[62:63], s[68:69] op_sel:[0,0,0] op_sel_hi:[1,1,0]
    v_pk_fma_f32 v[48:49], v[48:49], v[168:169], s[74:75] op_sel:[0,0,1] op_sel_hi:[1,1,1] clamp
    v_pk_fma_f32 v[52:53], v[52:53], v[170:171], s[74:75] op_sel:[0,0,1] op_sel_hi:[1,1,1] clamp
    v_pk_fma_f32 v[56:57], v[56:57], v[184:185], s[74:75] op_sel:[0,0,1] op_sel_hi:[1,1,1] clamp
    v_pk_fma_f32 v[60:61], v[60:61], v[186:187], s[74:75] op_sel:[0,0,1] op_sel_hi:[1,1,1] clamp
    v_pk_mul_f32 v[168:169], v[168:169], v[108:109] op_sel:[0,0] op_sel_hi:[1,0]
    v_pk_mul_f32 v[170:171], v[170:171], v[108:109] op_sel:[0,0] op_sel_hi:[1,0]
    v_pk_mul_f32 v[184:185], v[184:185], v[108:109] op_sel:[0,0] op_sel_hi:[1,0]
    v_pk_mul_f32 v[186:187], v[186:187], v[108:109] op_sel:[0,0] op_sel_hi:[1,0]
    v_pk_mul_f32 v[48:49], v[48:49], v[168:169]
    v_pk_mul_f32 v[52:53], v[52:53], v[170:171]
    v_pk_mul_f32 v[56:57], v[56:57], v[184:185]
    v_pk_mul_f32 v[60:61], v[60:61], v[186:187]
    v_cvt_pk_bf16_f32 v28, v48, v49
    v_cvt_pk_bf16_f32 v29, v52, v53
    v_cvt_pk_bf16_f32 v30, v56, v57
    v_cvt_pk_bf16_f32 v31, v60, v61
    s_nop 1
    v_permlane16_swap_b32 v28, v30
    v_permlane16_swap_b32 v29, v31
    buffer_store_dwordx4 v[28:31], v9, s[12:15], s66 offen offset:64 sc1
    v_pk_fma_f32 v[32:33], v[114:115], v[244:245], v[80:81] op_sel:[0,0,0] op_sel_hi:[0,1,1]
    v_pk_fma_f32 v[36:37], v[114:115], v[246:247], v[82:83] op_sel:[0,0,0] op_sel_hi:[0,1,1]
    v_pk_fma_f32 v[40:41], v[114:115], v[248:249], v[84:85] op_sel:[0,0,0] op_sel_hi:[0,1,1]
    v_pk_fma_f32 v[44:45], v[114:115], v[250:251], v[86:87] op_sel:[0,0,0] op_sel_hi:[0,1,1]
    v_pk_fma_f32 v[200:201], v[108:109], v[200:201], v[32:33] op_sel:[1,0,0] op_sel_hi:[1,1,1]
    v_pk_fma_f32 v[202:203], v[108:109], v[202:203], v[36:37] op_sel:[1,0,0] op_sel_hi:[1,1,1]
    v_pk_fma_f32 v[216:217], v[108:109], v[216:217], v[40:41] op_sel:[1,0,0] op_sel_hi:[1,1,1]
    v_pk_fma_f32 v[218:219], v[108:109], v[218:219], v[44:45] op_sel:[1,0,0] op_sel_hi:[1,1,1]
    v_pk_mul_f32 v[34:35], v[200:201], v[200:201] clamp
    v_pk_mul_f32 v[38:39], v[202:203], v[202:203] clamp
    v_pk_mul_f32 v[42:43], v[216:217], v[216:217] clamp
    v_pk_mul_f32 v[46:47], v[218:219], v[218:219] clamp
    v_pk_fma_f32 v[32:33], v[34:35], v[10:11], s[74:75] op_sel:[0,0,0] op_sel_hi:[1,0,0]
    v_pk_fma_f32 v[36:37], v[38:39], v[10:11], s[74:75] op_sel:[0,0,0] op_sel_hi:[1,0,0]
    v_pk_fma_f32 v[40:41], v[42:43], v[10:11], s[74:75] op_sel:[0,0,0] op_sel_hi:[1,0,0]
    v_pk_fma_f32 v[44:45], v[46:47], v[10:11], s[74:75] op_sel:[0,0,0] op_sel_hi:[1,0,0]
    v_pk_fma_f32 v[32:33], v[32:33], v[34:35], s[72:73] op_sel:[0,0,1] op_sel_hi:[1,1,1]
    v_pk_fma_f32 v[36:37], v[36:37], v[38:39], s[72:73] op_sel:[0,0,1] op_sel_hi:[1,1,1]
    v_pk_fma_f32 v[40:41], v[40:41], v[42:43], s[72:73] op_sel:[0,0,1] op_sel_hi:[1,1,1]
    v_pk_fma_f32 v[44:45], v[44:45], v[46:47], s[72:73] op_sel:[0,0,1] op_sel_hi:[1,1,1]
    v_pk_fma_f32 v[32:33], v[32:33], v[34:35], s[72:73] op_sel:[0,0,0] op_sel_hi:[1,1,0]
    v_pk_fma_f32 v[36:37], v[36:37], v[38:39], s[72:73] op_sel:[0,0,0] op_sel_hi:[1,1,0]
    v_pk_fma_f32 v[40:41], v[40:41], v[42:43], s[72:73] op_sel:[0,0,0] op_sel_hi:[1,1,0]
    v_pk_fma_f32 v[44:45], v[44:45], v[46:47], s[72:73] op_sel:[0,0,0] op_sel_hi:[1,1,0]
    v_pk_fma_f32 v[32:33], v[32:33], v[34:35], s[70:71] op_sel:[0,0,1] op_sel_hi:[1,1,1]
    v_pk_fma_f32 v[36:37], v[36:37], v[38:39], s[70:71] op_sel:[0,0,1] op_sel_hi:[1,1,1]
    v_pk_fma_f32 v[40:41], v[40:41], v[42:43], s[70:71] op_sel:[0,0,1] op_sel_hi:[1,1,1]
    v_pk_fma_f32 v[44:45], v[44:45], v[46:47], s[70:71] op_sel:[0,0,1] op_sel_hi:[1,1,1]
    v_pk_fma_f32 v[32:33], v[32:33], v[34:35], s[70:71] op_sel:[0,0,0] op_sel_hi:[1,1,0]
    v_pk_fma_f32 v[36:37], v[36:37], v[38:39], s[70:71] op_sel:[0,0,0] op_sel_hi:[1,1,0]
    v_pk_fma_f32 v[40:41], v[40:41], v[42:43], s[70:71] op_sel:[0,0,0] op_sel_hi:[1,1,0]
    v_pk_fma_f32 v[44:45], v[44:45], v[46:47], s[70:71] op_sel:[0,0,0] op_sel_hi:[1,1,0]
    v_pk_fma_f32 v[32:33], v[32:33], v[34:35], s[68:69] op_sel:[0,0,1] op_sel_hi:[1,1,1]
    v_pk_fma_f32 v[36:37], v[36:37], v[38:39], s[68:69] op_sel:[0,0,1] op_sel_hi:[1,1,1]
    v_pk_fma_f32 v[40:41], v[40:41], v[42:43], s[68:69] op_sel:[0,0,1] op_sel_hi:[1,1,1]
    v_pk_fma_f32 v[44:45], v[44:45], v[46:47], s[68:69] op_sel:[0,0,1] op_sel_hi:[1,1,1]
    v_pk_fma_f32 v[32:33], v[32:33], v[34:35], s[68:69] op_sel:[0,0,0] op_sel_hi:[1,1,0]
    v_pk_fma_f32 v[36:37], v[36:37], v[38:39], s[68:69] op_sel:[0,0,0] op_sel_hi:[1,1,0]
    v_pk_fma_f32 v[40:41], v[40:41], v[42:43], s[68:69] op_sel:[0,0,0] op_sel_hi:[1,1,0]
    v_pk_fma_f32 v[44:45], v[44:45], v[46:47], s[68:69] op_sel:[0,0,0] op_sel_hi:[1,1,0]
    v_pk_fma_f32 v[32:33], v[32:33], v[200:201], s[74:75] op_sel:[0,0,1] op_sel_hi:[1,1,1] clamp
    v_pk_fma_f32 v[36:37], v[36:37], v[202:203], s[74:75] op_sel:[0,0,1] op_sel_hi:[1,1,1] clamp
    v_pk_fma_f32 v[40:41], v[40:41], v[216:217], s[74:75] op_sel:[0,0,1] op_sel_hi:[1,1,1] clamp
    v_pk_fma_f32 v[44:45], v[44:45], v[218:219], s[74:75] op_sel:[0,0,1] op_sel_hi:[1,1,1] clamp
    v_pk_mul_f32 v[200:201], v[200:201], v[108:109] op_sel:[0,0] op_sel_hi:[1,0]
    v_pk_mul_f32 v[202:203], v[202:203], v[108:109] op_sel:[0,0] op_sel_hi:[1,0]
    v_pk_mul_f32 v[216:217], v[216:217], v[108:109] op_sel:[0,0] op_sel_hi:[1,0]
    v_pk_mul_f32 v[218:219], v[218:219], v[108:109] op_sel:[0,0] op_sel_hi:[1,0]
    v_pk_mul_f32 v[32:33], v[32:33], v[200:201]
    v_pk_mul_f32 v[36:37], v[36:37], v[202:203]
    v_pk_mul_f32 v[40:41], v[40:41], v[216:217]
    v_pk_mul_f32 v[44:45], v[44:45], v[218:219]
    v_cvt_pk_bf16_f32 v16, v32, v33
    v_cvt_pk_bf16_f32 v17, v36, v37
    v_cvt_pk_bf16_f32 v18, v40, v41
    v_cvt_pk_bf16_f32 v19, v44, v45
    s_nop 1
    v_permlane16_swap_b32 v16, v18
    v_permlane16_swap_b32 v17, v19
    buffer_store_dwordx4 v[16:19], v9, s[12:15], s66 offen offset:128 sc1
    s_add_u32 s66, s66, 180224
    s_waitcnt lgkmcnt(0)
    s_barrier
    v_pk_fma_f32 v[48:49], v[114:115], v[116:117], v[64:65] op_sel:[1,0,0] op_sel_hi:[1,1,1]
    v_pk_fma_f32 v[52:53], v[114:115], v[118:119], v[66:67] op_sel:[1,0,0] op_sel_hi:[1,1,1]
    v_pk_fma_f32 v[56:57], v[114:115], v[120:121], v[68:69] op_sel:[1,0,0] op_sel_hi:[1,1,1]
    v_pk_fma_f32 v[60:61], v[114:115], v[122:123], v[70:71] op_sel:[1,0,0] op_sel_hi:[1,1,1]
    v_pk_fma_f32 v[140:141], v[110:111], v[140:141], v[48:49] op_sel:[1,0,0] op_sel_hi:[1,1,1]
    v_pk_fma_f32 v[142:143], v[110:111], v[142:143], v[52:53] op_sel:[1,0,0] op_sel_hi:[1,1,1]
    v_pk_fma_f32 v[156:157], v[110:111], v[156:157], v[56:57] op_sel:[1,0,0] op_sel_hi:[1,1,1]
    v_pk_fma_f32 v[158:159], v[110:111], v[158:159], v[60:61] op_sel:[1,0,0] op_sel_hi:[1,1,1]
    v_pk_mul_f32 v[50:51], v[140:141], v[140:141] clamp
    v_pk_mul_f32 v[54:55], v[142:143], v[142:143] clamp
    v_pk_mul_f32 v[58:59], v[156:157], v[156:157] clamp
    v_pk_mul_f32 v[62:63], v[158:159], v[158:159] clamp
    v_pk_fma_f32 v[48:49], v[50:51], v[10:11], s[74:75] op_sel:[0,0,0] op_sel_hi:[1,0,0]
    v_pk_fma_f32 v[52:53], v[54:55], v[10:11], s[74:75] op_sel:[0,0,0] op_sel_hi:[1,0,0]
    v_pk_fma_f32 v[56:57], v[58:59], v[10:11], s[74:75] op_sel:[0,0,0] op_sel_hi:[1,0,0]
    v_pk_fma_f32 v[60:61], v[62:63], v[10:11], s[74:75] op_sel:[0,0,0] op_sel_hi:[1,0,0]
    v_pk_fma_f32 v[48:49], v[48:49], v[50:51], s[72:73] op_sel:[0,0,1] op_sel_hi:[1,1,1]
    v_pk_fma_f32 v[52:53], v[52:53], v[54:55], s[72:73] op_sel:[0,0,1] op_sel_hi:[1,1,1]
    v_pk_fma_f32 v[56:57], v[56:57], v[58:59], s[72:73] op_sel:[0,0,1] op_sel_hi:[1,1,1]
    v_pk_fma_f32 v[60:61], v[60:61], v[62:63], s[72:73] op_sel:[0,0,1] op_sel_hi:[1,1,1]
    v_pk_fma_f32 v[48:49], v[48:49], v[50:51], s[72:73] op_sel:[0,0,0] op_sel_hi:[1,1,0]
    v_pk_fma_f32 v[52:53], v[52:53], v[54:55], s[72:73] op_sel:[0,0,0] op_sel_hi:[1,1,0]
    v_pk_fma_f32 v[56:57], v[56:57], v[58:59], s[72:73] op_sel:[0,0,0] op_sel_hi:[1,1,0]
    v_pk_fma_f32 v[60:61], v[60:61], v[62:63], s[72:73] op_sel:[0,0,0] op_sel_hi:[1,1,0]
    v_pk_fma_f32 v[48:49], v[48:49], v[50:51], s[70:71] op_sel:[0,0,1] op_sel_hi:[1,1,1]
    v_pk_fma_f32 v[52:53], v[52:53], v[54:55], s[70:71] op_sel:[0,0,1] op_sel_hi:[1,1,1]
    v_pk_fma_f32 v[56:57], v[56:57], v[58:59], s[70:71] op_sel:[0,0,1] op_sel_hi:[1,1,1]
    v_pk_fma_f32 v[60:61], v[60:61], v[62:63], s[70:71] op_sel:[0,0,1] op_sel_hi:[1,1,1]
    v_pk_fma_f32 v[48:49], v[48:49], v[50:51], s[70:71] op_sel:[0,0,0] op_sel_hi:[1,1,0]
    v_pk_fma_f32 v[52:53], v[52:53], v[54:55], s[70:71] op_sel:[0,0,0] op_sel_hi:[1,1,0]
    v_pk_fma_f32 v[56:57], v[56:57], v[58:59], s[70:71] op_sel:[0,0,0] op_sel_hi:[1,1,0]
    v_pk_fma_f32 v[60:61], v[60:61], v[62:63], s[70:71] op_sel:[0,0,0] op_sel_hi:[1,1,0]
    v_pk_fma_f32 v[48:49], v[48:49], v[50:51], s[68:69] op_sel:[0,0,1] op_sel_hi:[1,1,1]
    v_pk_fma_f32 v[52:53], v[52:53], v[54:55], s[68:69] op_sel:[0,0,1] op_sel_hi:[1,1,1]
    v_pk_fma_f32 v[56:57], v[56:57], v[58:59], s[68:69] op_sel:[0,0,1] op_sel_hi:[1,1,1]
    v_pk_fma_f32 v[60:61], v[60:61], v[62:63], s[68:69] op_sel:[0,0,1] op_sel_hi:[1,1,1]
    v_pk_fma_f32 v[48:49], v[48:49], v[50:51], s[68:69] op_sel:[0,0,0] op_sel_hi:[1,1,0]
    v_pk_fma_f32 v[52:53], v[52:53], v[54:55], s[68:69] op_sel:[0,0,0] op_sel_hi:[1,1,0]
    v_pk_fma_f32 v[56:57], v[56:57], v[58:59], s[68:69] op_sel:[0,0,0] op_sel_hi:[1,1,0]
    v_pk_fma_f32 v[60:61], v[60:61], v[62:63], s[68:69] op_sel:[0,0,0] op_sel_hi:[1,1,0]
    v_pk_fma_f32 v[48:49], v[48:49], v[140:141], s[74:75] op_sel:[0,0,1] op_sel_hi:[1,1,1] clamp
    v_pk_fma_f32 v[52:53], v[52:53], v[142:143], s[74:75] op_sel:[0,0,1] op_sel_hi:[1,1,1] clamp
    v_pk_fma_f32 v[56:57], v[56:57], v[156:157], s[74:75] op_sel:[0,0,1] op_sel_hi:[1,1,1] clamp
    v_pk_fma_f32 v[60:61], v[60:61], v[158:159], s[74:75] op_sel:[0,0,1] op_sel_hi:[1,1,1] clamp
    v_pk_mul_f32 v[140:141], v[140:141], v[110:111] op_sel:[0,0] op_sel_hi:[1,0]
    v_pk_mul_f32 v[142:143], v[142:143], v[110:111] op_sel:[0,0] op_sel_hi:[1,0]
    v_pk_mul_f32 v[156:157], v[156:157], v[110:111] op_sel:[0,0] op_sel_hi:[1,0]
    v_pk_mul_f32 v[158:159], v[158:159], v[110:111] op_sel:[0,0] op_sel_hi:[1,0]
    v_pk_mul_f32 v[48:49], v[48:49], v[140:141]
    v_pk_mul_f32 v[52:53], v[52:53], v[142:143]
    v_pk_mul_f32 v[56:57], v[56:57], v[156:157]
    v_pk_mul_f32 v[60:61], v[60:61], v[158:159]
    v_cvt_pk_bf16_f32 v20, v48, v49
    v_cvt_pk_bf16_f32 v21, v52, v53
    v_cvt_pk_bf16_f32 v22, v56, v57
    v_cvt_pk_bf16_f32 v23, v60, v61
    s_nop 1
    v_permlane16_swap_b32 v20, v22
    v_permlane16_swap_b32 v21, v23
    buffer_store_dwordx4 v[20:23], v9, s[12:15], s66 offen offset:0 sc1
    v_pk_fma_f32 v[32:33], v[114:115], v[124:125], v[72:73] op_sel:[1,0,0] op_sel_hi:[1,1,1]
    v_pk_fma_f32 v[36:37], v[114:115], v[126:127], v[74:75] op_sel:[1,0,0] op_sel_hi:[1,1,1]
    v_pk_fma_f32 v[40:41], v[114:115], v[240:241], v[76:77] op_sel:[1,0,0] op_sel_hi:[1,1,1]
    v_pk_fma_f32 v[44:45], v[114:115], v[242:243], v[78:79] op_sel:[1,0,0] op_sel_hi:[1,1,1]
    v_pk_fma_f32 v[172:173], v[110:111], v[172:173], v[32:33] op_sel:[1,0,0] op_sel_hi:[1,1,1]
    v_pk_fma_f32 v[174:175], v[110:111], v[174:175], v[36:37] op_sel:[1,0,0] op_sel_hi:[1,1,1]
    v_pk_fma_f32 v[188:189], v[110:111], v[188:189], v[40:41] op_sel:[1,0,0] op_sel_hi:[1,1,1]
    v_pk_fma_f32 v[190:191], v[110:111], v[190:191], v[44:45] op_sel:[1,0,0] op_sel_hi:[1,1,1]
    v_pk_mul_f32 v[34:35], v[172:173], v[172:173] clamp
    v_pk_mul_f32 v[38:39], v[174:175], v[174:175] clamp
    v_pk_mul_f32 v[42:43], v[188:189], v[188:189] clamp
    v_pk_mul_f32 v[46:47], v[190:191], v[190:191] clamp
    v_pk_fma_f32 v[32:33], v[34:35], v[10:11], s[74:75] op_sel:[0,0,0] op_sel_hi:[1,0,0]
    v_pk_fma_f32 v[36:37], v[38:39], v[10:11], s[74:75] op_sel:[0,0,0] op_sel_hi:[1,0,0]
    v_pk_fma_f32 v[40:41], v[42:43], v[10:11], s[74:75] op_sel:[0,0,0] op_sel_hi:[1,0,0]
    v_pk_fma_f32 v[44:45], v[46:47], v[10:11], s[74:75] op_sel:[0,0,0] op_sel_hi:[1,0,0]
    v_pk_fma_f32 v[32:33], v[32:33], v[34:35], s[72:73] op_sel:[0,0,1] op_sel_hi:[1,1,1]
    v_pk_fma_f32 v[36:37], v[36:37], v[38:39], s[72:73] op_sel:[0,0,1] op_sel_hi:[1,1,1]
    v_pk_fma_f32 v[40:41], v[40:41], v[42:43], s[72:73] op_sel:[0,0,1] op_sel_hi:[1,1,1]
    v_pk_fma_f32 v[44:45], v[44:45], v[46:47], s[72:73] op_sel:[0,0,1] op_sel_hi:[1,1,1]
    v_pk_fma_f32 v[32:33], v[32:33], v[34:35], s[72:73] op_sel:[0,0,0] op_sel_hi:[1,1,0]
    v_pk_fma_f32 v[36:37], v[36:37], v[38:39], s[72:73] op_sel:[0,0,0] op_sel_hi:[1,1,0]
    v_pk_fma_f32 v[40:41], v[40:41], v[42:43], s[72:73] op_sel:[0,0,0] op_sel_hi:[1,1,0]
    v_pk_fma_f32 v[44:45], v[44:45], v[46:47], s[72:73] op_sel:[0,0,0] op_sel_hi:[1,1,0]
    v_pk_fma_f32 v[32:33], v[32:33], v[34:35], s[70:71] op_sel:[0,0,1] op_sel_hi:[1,1,1]
    v_pk_fma_f32 v[36:37], v[36:37], v[38:39], s[70:71] op_sel:[0,0,1] op_sel_hi:[1,1,1]
    v_pk_fma_f32 v[40:41], v[40:41], v[42:43], s[70:71] op_sel:[0,0,1] op_sel_hi:[1,1,1]
    v_pk_fma_f32 v[44:45], v[44:45], v[46:47], s[70:71] op_sel:[0,0,1] op_sel_hi:[1,1,1]
    v_pk_fma_f32 v[32:33], v[32:33], v[34:35], s[70:71] op_sel:[0,0,0] op_sel_hi:[1,1,0]
    v_pk_fma_f32 v[36:37], v[36:37], v[38:39], s[70:71] op_sel:[0,0,0] op_sel_hi:[1,1,0]
    v_pk_fma_f32 v[40:41], v[40:41], v[42:43], s[70:71] op_sel:[0,0,0] op_sel_hi:[1,1,0]
    v_pk_fma_f32 v[44:45], v[44:45], v[46:47], s[70:71] op_sel:[0,0,0] op_sel_hi:[1,1,0]
    v_pk_fma_f32 v[32:33], v[32:33], v[34:35], s[68:69] op_sel:[0,0,1] op_sel_hi:[1,1,1]
    v_pk_fma_f32 v[36:37], v[36:37], v[38:39], s[68:69] op_sel:[0,0,1] op_sel_hi:[1,1,1]
    v_pk_fma_f32 v[40:41], v[40:41], v[42:43], s[68:69] op_sel:[0,0,1] op_sel_hi:[1,1,1]
    v_pk_fma_f32 v[44:45], v[44:45], v[46:47], s[68:69] op_sel:[0,0,1] op_sel_hi:[1,1,1]
    v_pk_fma_f32 v[32:33], v[32:33], v[34:35], s[68:69] op_sel:[0,0,0] op_sel_hi:[1,1,0]
    v_pk_fma_f32 v[36:37], v[36:37], v[38:39], s[68:69] op_sel:[0,0,0] op_sel_hi:[1,1,0]
    v_pk_fma_f32 v[40:41], v[40:41], v[42:43], s[68:69] op_sel:[0,0,0] op_sel_hi:[1,1,0]
    v_pk_fma_f32 v[44:45], v[44:45], v[46:47], s[68:69] op_sel:[0,0,0] op_sel_hi:[1,1,0]
    v_pk_fma_f32 v[32:33], v[32:33], v[172:173], s[74:75] op_sel:[0,0,1] op_sel_hi:[1,1,1] clamp
    v_pk_fma_f32 v[36:37], v[36:37], v[174:175], s[74:75] op_sel:[0,0,1] op_sel_hi:[1,1,1] clamp
    v_pk_fma_f32 v[40:41], v[40:41], v[188:189], s[74:75] op_sel:[0,0,1] op_sel_hi:[1,1,1] clamp
    v_pk_fma_f32 v[44:45], v[44:45], v[190:191], s[74:75] op_sel:[0,0,1] op_sel_hi:[1,1,1] clamp
    v_pk_mul_f32 v[172:173], v[172:173], v[110:111] op_sel:[0,0] op_sel_hi:[1,0]
    v_pk_mul_f32 v[174:175], v[174:175], v[110:111] op_sel:[0,0] op_sel_hi:[1,0]
    v_pk_mul_f32 v[188:189], v[188:189], v[110:111] op_sel:[0,0] op_sel_hi:[1,0]
    v_pk_mul_f32 v[190:191], v[190:191], v[110:111] op_sel:[0,0] op_sel_hi:[1,0]
    v_pk_mul_f32 v[32:33], v[32:33], v[172:173]
    v_pk_mul_f32 v[36:37], v[36:37], v[174:175]
    v_pk_mul_f32 v[40:41], v[40:41], v[188:189]
    v_pk_mul_f32 v[44:45], v[44:45], v[190:191]
    v_cvt_pk_bf16_f32 v24, v32, v33
    v_cvt_pk_bf16_f32 v25, v36, v37
    v_cvt_pk_bf16_f32 v26, v40, v41
    v_cvt_pk_bf16_f32 v27, v44, v45
    s_nop 1
    v_permlane16_swap_b32 v24, v26
    v_permlane16_swap_b32 v25, v27
    buffer_store_dwordx4 v[24:27], v9, s[12:15], s66 offen offset:64 sc1
    v_pk_fma_f32 v[48:49], v[114:115], v[244:245], v[80:81] op_sel:[1,0,0] op_sel_hi:[1,1,1]
    v_pk_fma_f32 v[52:53], v[114:115], v[246:247], v[82:83] op_sel:[1,0,0] op_sel_hi:[1,1,1]
    v_pk_fma_f32 v[56:57], v[114:115], v[248:249], v[84:85] op_sel:[1,0,0] op_sel_hi:[1,1,1]
    v_pk_fma_f32 v[60:61], v[114:115], v[250:251], v[86:87] op_sel:[1,0,0] op_sel_hi:[1,1,1]
    v_pk_fma_f32 v[204:205], v[110:111], v[204:205], v[48:49] op_sel:[1,0,0] op_sel_hi:[1,1,1]
    v_pk_fma_f32 v[206:207], v[110:111], v[206:207], v[52:53] op_sel:[1,0,0] op_sel_hi:[1,1,1]
    v_pk_fma_f32 v[220:221], v[110:111], v[220:221], v[56:57] op_sel:[1,0,0] op_sel_hi:[1,1,1]
    v_pk_fma_f32 v[222:223], v[110:111], v[222:223], v[60:61] op_sel:[1,0,0] op_sel_hi:[1,1,1]
    v_pk_mul_f32 v[50:51], v[204:205], v[204:205] clamp
    v_pk_mul_f32 v[54:55], v[206:207], v[206:207] clamp
    v_pk_mul_f32 v[58:59], v[220:221], v[220:221] clamp
    v_pk_mul_f32 v[62:63], v[222:223], v[222:223] clamp
    v_pk_fma_f32 v[48:49], v[50:51], v[10:11], s[74:75] op_sel:[0,0,0] op_sel_hi:[1,0,0]
    v_pk_fma_f32 v[52:53], v[54:55], v[10:11], s[74:75] op_sel:[0,0,0] op_sel_hi:[1,0,0]
    v_pk_fma_f32 v[56:57], v[58:59], v[10:11], s[74:75] op_sel:[0,0,0] op_sel_hi:[1,0,0]
    v_pk_fma_f32 v[60:61], v[62:63], v[10:11], s[74:75] op_sel:[0,0,0] op_sel_hi:[1,0,0]
    v_pk_fma_f32 v[48:49], v[48:49], v[50:51], s[72:73] op_sel:[0,0,1] op_sel_hi:[1,1,1]
    v_pk_fma_f32 v[52:53], v[52:53], v[54:55], s[72:73] op_sel:[0,0,1] op_sel_hi:[1,1,1]
    v_pk_fma_f32 v[56:57], v[56:57], v[58:59], s[72:73] op_sel:[0,0,1] op_sel_hi:[1,1,1]
    v_pk_fma_f32 v[60:61], v[60:61], v[62:63], s[72:73] op_sel:[0,0,1] op_sel_hi:[1,1,1]
    v_pk_fma_f32 v[48:49], v[48:49], v[50:51], s[72:73] op_sel:[0,0,0] op_sel_hi:[1,1,0]
    v_pk_fma_f32 v[52:53], v[52:53], v[54:55], s[72:73] op_sel:[0,0,0] op_sel_hi:[1,1,0]
    v_pk_fma_f32 v[56:57], v[56:57], v[58:59], s[72:73] op_sel:[0,0,0] op_sel_hi:[1,1,0]
    v_pk_fma_f32 v[60:61], v[60:61], v[62:63], s[72:73] op_sel:[0,0,0] op_sel_hi:[1,1,0]
    v_pk_fma_f32 v[48:49], v[48:49], v[50:51], s[70:71] op_sel:[0,0,1] op_sel_hi:[1,1,1]
    v_pk_fma_f32 v[52:53], v[52:53], v[54:55], s[70:71] op_sel:[0,0,1] op_sel_hi:[1,1,1]
    v_pk_fma_f32 v[56:57], v[56:57], v[58:59], s[70:71] op_sel:[0,0,1] op_sel_hi:[1,1,1]
    v_pk_fma_f32 v[60:61], v[60:61], v[62:63], s[70:71] op_sel:[0,0,1] op_sel_hi:[1,1,1]
    v_pk_fma_f32 v[48:49], v[48:49], v[50:51], s[70:71] op_sel:[0,0,0] op_sel_hi:[1,1,0]
    v_pk_fma_f32 v[52:53], v[52:53], v[54:55], s[70:71] op_sel:[0,0,0] op_sel_hi:[1,1,0]
    v_pk_fma_f32 v[56:57], v[56:57], v[58:59], s[70:71] op_sel:[0,0,0] op_sel_hi:[1,1,0]
    v_pk_fma_f32 v[60:61], v[60:61], v[62:63], s[70:71] op_sel:[0,0,0] op_sel_hi:[1,1,0]
    v_pk_fma_f32 v[48:49], v[48:49], v[50:51], s[68:69] op_sel:[0,0,1] op_sel_hi:[1,1,1]
    v_pk_fma_f32 v[52:53], v[52:53], v[54:55], s[68:69] op_sel:[0,0,1] op_sel_hi:[1,1,1]
    v_pk_fma_f32 v[56:57], v[56:57], v[58:59], s[68:69] op_sel:[0,0,1] op_sel_hi:[1,1,1]
    v_pk_fma_f32 v[60:61], v[60:61], v[62:63], s[68:69] op_sel:[0,0,1] op_sel_hi:[1,1,1]
    v_pk_fma_f32 v[48:49], v[48:49], v[50:51], s[68:69] op_sel:[0,0,0] op_sel_hi:[1,1,0]
    v_pk_fma_f32 v[52:53], v[52:53], v[54:55], s[68:69] op_sel:[0,0,0] op_sel_hi:[1,1,0]
    v_pk_fma_f32 v[56:57], v[56:57], v[58:59], s[68:69] op_sel:[0,0,0] op_sel_hi:[1,1,0]
    v_pk_fma_f32 v[60:61], v[60:61], v[62:63], s[68:69] op_sel:[0,0,0] op_sel_hi:[1,1,0]
    v_pk_fma_f32 v[48:49], v[48:49], v[204:205], s[74:75] op_sel:[0,0,1] op_sel_hi:[1,1,1] clamp
    v_pk_fma_f32 v[52:53], v[52:53], v[206:207], s[74:75] op_sel:[0,0,1] op_sel_hi:[1,1,1] clamp
    v_pk_fma_f32 v[56:57], v[56:57], v[220:221], s[74:75] op_sel:[0,0,1] op_sel_hi:[1,1,1] clamp
    v_pk_fma_f32 v[60:61], v[60:61], v[222:223], s[74:75] op_sel:[0,0,1] op_sel_hi:[1,1,1] clamp
    v_pk_mul_f32 v[204:205], v[204:205], v[110:111] op_sel:[0,0] op_sel_hi:[1,0]
    v_pk_mul_f32 v[206:207], v[206:207], v[110:111] op_sel:[0,0] op_sel_hi:[1,0]
    v_pk_mul_f32 v[220:221], v[220:221], v[110:111] op_sel:[0,0] op_sel_hi:[1,0]
    v_pk_mul_f32 v[222:223], v[222:223], v[110:111] op_sel:[0,0] op_sel_hi:[1,0]
    v_pk_mul_f32 v[48:49], v[48:49], v[204:205]
    v_pk_mul_f32 v[52:53], v[52:53], v[206:207]
    v_pk_mul_f32 v[56:57], v[56:57], v[220:221]
    v_pk_mul_f32 v[60:61], v[60:61], v[222:223]
    v_cvt_pk_bf16_f32 v28, v48, v49
    v_cvt_pk_bf16_f32 v29, v52, v53
    v_cvt_pk_bf16_f32 v30, v56, v57
    v_cvt_pk_bf16_f32 v31, v60, v61
    s_nop 1
    v_permlane16_swap_b32 v28, v30
    v_permlane16_swap_b32 v29, v31
    buffer_store_dwordx4 v[28:31], v9, s[12:15], s66 offen offset:128 sc1
    s_waitcnt lgkmcnt(0)
    v_permlane16_swap_b32 v92, v94
    v_permlane16_swap_b32 v93, v95
    buffer_store_dwordx4 v[92:95], v9, s[12:15], s67 offen offset:192 sc1
    s_add_u32 s67, s67, 180224
    v_permlane16_swap_b32 v96, v98
    v_permlane16_swap_b32 v97, v99
    buffer_store_dwordx4 v[96:99], v9, s[12:15], s67 offen offset:192 sc1
    s_waitcnt vmcnt(8)
    v_cmp_eq_u32 vcc, 1, v14
    s_cmp_eq_u32 vcc_lo, -1
    s_cselect_b32 s25, 1, 0
    s_branch s2_entry
s1_ssm:
    s_mov_b32 s4, s36
    s_mov_b32 s5, s37
    s_mov_b32 s6, 4194304
    s_mov_b32 s7, 0x00020000
    v_mov_b32 v12, 0
    s_cmp_lg_u32 s32, 0
    s_cbranch_scc1 ssm_nz
    s_add_u32 s68, s58, 4456448
    s_addc_u32 s69, s59, 0
    s_mov_b32 s70, 65536
    s_mov_b32 s71, 0x00020000
    s_lshl_b32 s63, s34, 4
    s_add_u32 s63, s63, s35
    s_lshl_b32 s63, s63, 9
    v_lshlrev_b32 v9, 3, v2
    v_mov_b32 v14, 0
    v_mov_b32 v15, 0
    buffer_store_dwordx2 v[14:15], v9, s[68:71], s63 offen sc0 sc1
    s_add_u32 s72, s58, 5242880
    s_addc_u32 s73, s59, 0
    s_mov_b32 s74, 65536
    s_mov_b32 s75, 0x00020000
    v_lshlrev_b32 v11, 3, v2
    v_mov_b32 v12, -1
    v_mov_b32 v13, -1
    buffer_store_dwordx2 v[12:13], v11, s[72:75], s63 offen sc0 sc1
ssm_nz:
    s_cmp_lt_u32 s32, 4
    s_cselect_b32 s8, s44, s46
    s_cselect_b32 s9, s45, s47
    s_mov_b32 s10, 0x200000
    s_mov_b32 s11, 0x00020000
    v_lshrrev_b32 v9, 2, v3
    v_and_b32 v10, 3, v3
    v_lshl_add_u32 v9, v9, 4, v10
    v_lshl_add_u32 v112, v9, 11, v4
    s_lshl_b32 s84, s87, 10
    v_add_u32 v112, s84, v112
    v_xor_b32 v113, 64, v112
    s_lshl_b32 s20, s34, 8
    s_lshl_b32 s63, s60, 6
    s_add_u32 s20, s20, s63
    s_lshl_b32 s63, s61, 3
    s_add_u32 s20, s20, s63
    s_lshl_b32 s20, s20, 11
    s_add_u32 s21, s20, 65536
    s_add_u32 s22, s20, 8192
    s_add_u32 s23, s20, 73728
    v_lshl_add_u32 v114, v3, 12, v4
    v_add_u32 v114, s84, v114
    s_lshl_b32 s84, s84, 1
    v_xor_b32 v115, 64, v114
    s_lshl_b32 s64, s35, 6
    s_and_b32 s63, s60, 1
    s_lshl_b32 s63, s63, 5
    s_add_u32 s24, s64, s63
    s_add_u32 s24, s24, s61
    s_lshl_b32 s24, s24, 11
    s_add_u32 s25, s24, 32768
    s_lshl_b32 s30, s32, 11
    s_add_u32 s30, s30, 32768
    s_add_u32 m0, s29, 0
    s_nop 0
    buffer_load_dwordx4 v112, s[4:7], s20 offen lds
    s_add_u32 m0, s29, 1024
    s_nop 0
    buffer_load_dwordx4 v113, s[4:7], s21 offen lds
    s_add_u32 m0, s29, 2048
    s_nop 0
    buffer_load_dwordx4 v112, s[4:7], s22 offen lds
    s_add_u32 m0, s29, 3072
    s_nop 0
    buffer_load_dwordx4 v113, s[4:7], s23 offen lds
    s_add_u32 m0, s30, 0
    s_nop 0
    buffer_load_dwordx4 v114, s[8:11], s24 offen lds
    s_add_u32 m0, s30, 1024
    s_nop 0
    buffer_load_dwordx4 v115, s[8:11], s25 offen lds
    v_add_u32 v112, 128, v112
    v_add_u32 v113, 128, v113
    v_add_u32 v114, 128, v114
    v_add_u32 v115, 128, v115
    s_add_u32 m0, s29, 61440
    s_nop 0
    buffer_load_dwordx4 v112, s[4:7], s20 offen lds
    s_add_u32 m0, s29, 62464
    s_nop 0
    buffer_load_dwordx4 v113, s[4:7], s21 offen lds
    s_add_u32 m0, s29, 63488
    s_nop 0
    buffer_load_dwordx4 v112, s[4:7], s22 offen lds
    s_add_u32 m0, s29, 64512
    s_nop 0
    buffer_load_dwordx4 v113, s[4:7], s23 offen lds
    s_add_u32 m0, s30, 61440
    s_nop 0
    buffer_load_dwordx4 v114, s[8:11], s24 offen lds
    s_add_u32 m0, s30, 62464
    s_nop 0
    buffer_load_dwordx4 v115, s[8:11], s25 offen lds
    v_add_u32 v112, 128, v112
    v_add_u32 v113, 128, v113
    v_add_u32 v114, 128, v114
    v_add_u32 v115, 128, v115
    s_lshl_b32 s63, s61, 12
    s_add_u32 s63, s63, 32768
    v_add_u32 v108, s63, v8
    v_xor_b32 v109, 64, v108
    v_add_u32 v110, 61440, v108
    v_add_u32 v111, 61440, v109
    s_mov_b32 s68, s40
    s_mov_b32 s69, s41
    s_mov_b32 s70, 2048
    s_mov_b32 s71, 0x00020000
    s_mov_b32 s72, s42
    s_mov_b32 s73, s43
    s_mov_b32 s74, 2048
    s_mov_b32 s75, 0x00020000
    s_mov_b32 s76, s48
    s_mov_b32 s77, s49
    s_mov_b32 s78, 2048
    s_mov_b32 s79, 0x00020000
    s_lshl_b32 s63, s61, 5
    s_add_u32 s63, s63, s64
    s_lshl_b32 s63, s63, 1
    v_lshlrev_b32 v9, 2, v6
    buffer_load_dword v16, v9, s[68:71], s63 offen
    buffer_load_dword v17, v9, s[72:75], s63 offen
    buffer_load_dword v18, v9, s[76:79], s63 offen
    s_lshl_b32 s63, s64, 1
    v_lshlrev_b32 v9, 1, v2
    buffer_load_ushort v19, v9, s[68:71], s63 offen
    buffer_load_ushort v20, v9, s[72:75], s63 offen
    buffer_load_ushort v21, v9, s[76:79], s63 offen
    s_load_dwordx2 s[50:51], s[0:1], 112
    s_load_dwordx4 s[40:43], s[0:1], 40
    s_lshl_b32 s85, s34, 8
    s_lshl_b32 s63, s35, 4
    s_add_u32 s85, s85, s63
    s_lshl_b32 s63, s32, 1
    s_add_u32 s85, s85, s63
    s_lshl_b32 s86, s85, 11
    v_lshlrev_b32 v9, 4, v2
    buffer_load_dwordx4 v[32:35], v9, s[4:7], s86 offen offset:0
    buffer_load_dwordx4 v[36:39], v9, s[4:7], s86 offen offset:1024
    buffer_load_dwordx4 v[40:43], v9, s[4:7], s86 offen offset:2048
    buffer_load_dwordx4 v[44:47], v9, s[4:7], s86 offen offset:3072
    s_waitcnt lgkmcnt(0)
    s_mov_b32 s80, s50
    s_mov_b32 s81, s51
    s_mov_b32 s82, 2048
    s_mov_b32 s83, 0x00020000
    buffer_load_dwordx4 v[48:51], v9, s[80:83], 0 offen
    buffer_load_dwordx4 v[52:55], v9, s[80:83], 0 offen offset:1024
    s_lshl_b32 s63, s34, 4
    s_add_u32 s63, s63, s35
    s_and_b32 s66, s32, 1
    s_lshl_b32 s66, s66, 7
    s_add_u32 s66, s66, s63
    s_lshl_b32 s66, s66, 13
    v_lshlrev_b32 v216, 7, v2
    s_bitcmp1_b32 s32, 1
    s_cselect_b32 s66, 0, s66
    buffer_load_dword v217, v216, s[8:11], s66 offen
    v_mov_b32 v128, 0
    v_mov_b32 v129, 0
    v_mov_b32 v130, 0
    v_mov_b32 v131, 0
    v_mov_b32 v132, 0
    v_mov_b32 v133, 0
    v_mov_b32 v134, 0
    v_mov_b32 v135, 0
    v_mov_b32 v136, 0
    v_mov_b32 v137, 0
    v_mov_b32 v138, 0
    v_mov_b32 v139, 0
    v_mov_b32 v140, 0
    v_mov_b32 v141, 0
    v_mov_b32 v142, 0
    v_mov_b32 v143, 0
    v_mov_b32 v144, 0
    v_mov_b32 v145, 0
    v_mov_b32 v146, 0
    v_mov_b32 v147, 0
    v_mov_b32 v148, 0
    v_mov_b32 v149, 0
    v_mov_b32 v150, 0
    v_mov_b32 v151, 0
    v_mov_b32 v152, 0
    v_mov_b32 v153, 0
    v_mov_b32 v154, 0
    v_mov_b32 v155, 0
    v_mov_b32 v156, 0
    v_mov_b32 v157, 0
    v_mov_b32 v158, 0
    v_mov_b32 v159, 0
    v_mov_b32 v160, 0
    v_mov_b32 v161, 0
    v_mov_b32 v162, 0
    v_mov_b32 v163, 0
    v_mov_b32 v164, 0
    v_mov_b32 v165, 0
    v_mov_b32 v166, 0
    v_mov_b32 v167, 0
    v_mov_b32 v168, 0
    v_mov_b32 v169, 0
    v_mov_b32 v170, 0
    v_mov_b32 v171, 0
    v_mov_b32 v172, 0
    v_mov_b32 v173, 0
    v_mov_b32 v174, 0
    v_mov_b32 v175, 0
    v_mov_b32 v176, 0
    v_mov_b32 v177, 0
    v_mov_b32 v178, 0
    v_mov_b32 v179, 0
    v_mov_b32 v180, 0
    v_mov_b32 v181, 0
    v_mov_b32 v182, 0
    v_mov_b32 v183, 0
    v_mov_b32 v184, 0
    v_mov_b32 v185, 0
    v_mov_b32 v186, 0
    v_mov_b32 v187, 0
    v_mov_b32 v188, 0
    v_mov_b32 v189, 0
    v_mov_b32 v190, 0
    v_mov_b32 v191, 0
    s_mov_b32 s65, 0xffff0000
    s_waitcnt vmcnt(7)
    v_lshlrev_b32 v22, 16, v16
    v_lshlrev_b32 v23, 16, v17
    v_lshlrev_b32 v24, 16, v18
    v_mul_f32 v26, 0x3fb8aa3b, v24
    v_exp_f32 v26, v26
    s_nop 0
    v_cvt_pk_bf16_f32 v26, v26, v26
    v_lshlrev_b32 v26, 16, v26
    v_mul_f32 v27, v26, v22
    v_mul_f32 v28, v26, v23
    v_mul_f32 v27, 0x3fb8aa3b, v27
    v_exp_f32 v27, v27
    v_mul_f32 v28, 0x3e22f983, v28
    v_rndne_f32 v29, v28
    v_sub_f32 v28, v28, v29
    v_cos_f32 v29, v28
    v_sin_f32 v30, v28
    s_nop 0
    v_mul_f32 v200, v27, v29
    v_mul_f32 v201, v27, v30
    v_add_f32 v26, -1.0, v200
    v_mul_f32 v27, v22, v22
    v_fmac_f32 v27, v23, v23
    v_rcp_f32 v27, v27
    v_mul_f32 v28, v26, v22
    v_fmac_f32 v28, v201, v23
    v_mul_f32 v29, v201, v22
    v_fma_f32 v29, -v26, v23, v29
    v_mul_f32 v202, v28, v27
    v_mul_f32 v203, v29, v27
    v_and_b32 v22, s65, v16
    v_and_b32 v23, s65, v17
    v_and_b32 v24, s65, v18
    v_mul_f32 v26, 0x3fb8aa3b, v24
    v_exp_f32 v26, v26
    s_nop 0
    v_cvt_pk_bf16_f32 v26, v26, v26
    v_lshlrev_b32 v26, 16, v26
    v_mul_f32 v27, v26, v22
    v_mul_f32 v28, v26, v23
    v_mul_f32 v27, 0x3fb8aa3b, v27
    v_exp_f32 v27, v27
    v_mul_f32 v28, 0x3e22f983, v28
    v_rndne_f32 v29, v28
    v_sub_f32 v28, v28, v29
    v_cos_f32 v29, v28
    v_sin_f32 v30, v28
    s_nop 0
    v_mul_f32 v204, v27, v29
    v_mul_f32 v205, v27, v30
    v_add_f32 v26, -1.0, v204
    v_mul_f32 v27, v22, v22
    v_fmac_f32 v27, v23, v23
    v_rcp_f32 v27, v27
    v_mul_f32 v28, v26, v22
    v_fmac_f32 v28, v205, v23
    v_mul_f32 v29, v205, v22
    v_fma_f32 v29, -v26, v23, v29
    v_mul_f32 v206, v28, v27
    v_mul_f32 v207, v29, v27
    v_lshlrev_b32 v22, 16, v19
    v_lshlrev_b32 v23, 16, v20
    v_lshlrev_b32 v24, 16, v21
    v_mul_f32 v26, 0x3fb8aa3b, v24
    v_exp_f32 v26, v26
    s_nop 0
    v_cvt_pk_bf16_f32 v26, v26, v26
    v_lshlrev_b32 v26, 16, v26
    v_mul_f32 v27, v26, v22
    v_mul_f32 v28, v26, v23
    v_mul_f32 v27, 0x3fb8aa3b, v27
    v_exp_f32 v27, v27
    v_mul_f32 v28, 0x3e22f983, v28
    v_rndne_f32 v29, v28
    v_sub_f32 v28, v28, v29
    v_cos_f32 v29, v28
    v_sin_f32 v30, v28
    s_nop 0
    v_mul_f32 v208, v27, v29
    v_mul_f32 v209, v27, v30
    v_mul_f32 v26, v209, v209
    v_mul_f32 v209, v208, v209
    v_fma_f32 v208, v208, v208, -v26
    v_add_f32 v209, v209, v209
    v_mul_f32 v26, v209, v209
    v_mul_f32 v209, v208, v209
    v_fma_f32 v208, v208, v208, -v26
    v_add_f32 v209, v209, v209
    v_mul_f32 v26, v209, v209
    v_mul_f32 v209, v208, v209
    v_fma_f32 v208, v208, v208, -v26
    v_add_f32 v209, v209, v209
    v_mul_f32 v26, v209, v209
    v_mul_f32 v209, v208, v209
    v_fma_f32 v208, v208, v208, -v26
    v_add_f32 v209, v209, v209
    v_mov_b32 v210, v208
    v_mov_b32 v211, v209
    v_mul_f32 v26, v211, v211
    v_mul_f32 v211, v210, v211
    v_fma_f32 v210, v210, v210, -v26
    v_add_f32 v211, v211, v211
    v_mul_f32 v26, v211, v211
    v_mul_f32 v211, v210, v211
    v_fma_f32 v210, v210, v210, -v26
    v_add_f32 v211, v211, v211
    v_mul_f32 v26, v211, v211
    v_mul_f32 v211, v210, v211
    v_fma_f32 v210, v210, v210, -v26
    v_add_f32 v211, v211, v211
    v_mul_f32 v26, v211, v211
    v_mul_f32 v211, v210, v211
    v_fma_f32 v210, v210, v210, -v26
    v_add_f32 v211, v211, v211
    s_waitcnt vmcnt(1)
    s_add_u32 s68, s58, 4194304
    s_addc_u32 s69, s59, 0
    s_mov_b32 s70, 16384
    s_mov_b32 s71, 0x00020000
    s_add_u32 s72, s58, 4210688
    s_addc_u32 s73, s59, 0
    s_mov_b32 s74, 16384
    s_mov_b32 s75, 0x00020000
    v_lshlrev_b32 v80, 16, v48
    v_and_b32 v81, s65, v48
    v_lshlrev_b32 v82, 16, v49
    v_and_b32 v83, s65, v49
    v_lshlrev_b32 v84, 16, v50
    v_and_b32 v85, s65, v50
    v_lshlrev_b32 v86, 16, v51
    v_and_b32 v87, s65, v51
    v_lshlrev_b32 v88, 16, v52
    v_and_b32 v89, s65, v52
    v_lshlrev_b32 v90, 16, v53
    v_and_b32 v91, s65, v53
    v_lshlrev_b32 v92, 16, v54
    v_and_b32 v93, s65, v54
    v_lshlrev_b32 v94, 16, v55
    v_and_b32 v95, s65, v55
    v_lshlrev_b32 v56, 16, v32
    v_and_b32 v57, s65, v32
    v_lshlrev_b32 v58, 16, v33
    v_and_b32 v59, s65, v33
    v_lshlrev_b32 v60, 16, v34
    v_and_b32 v61, s65, v34
    v_lshlrev_b32 v62, 16, v35
    v_and_b32 v63, s65, v35
    v_lshlrev_b32 v64, 16, v36
    v_and_b32 v65, s65, v36
    v_lshlrev_b32 v66, 16, v37
    v_and_b32 v67, s65, v37
    v_lshlrev_b32 v68, 16, v38
    v_and_b32 v69, s65, v38
    v_lshlrev_b32 v70, 16, v39
    v_and_b32 v71, s65, v39
    v_mul_f32 v16, v56, v80
    v_mul_f32 v17, v57, v81
    v_mul_f32 v18, v58, v82
    v_mul_f32 v19, v59, v83
    v_mul_f32 v20, v60, v84
    v_mul_f32 v21, v61, v85
    v_mul_f32 v22, v62, v86
    v_mul_f32 v23, v63, v87
    v_mul_f32 v24, v64, v88
    v_mul_f32 v25, v65, v89
    v_mul_f32 v26, v66, v90
    v_mul_f32 v27, v67, v91
    v_mul_f32 v28, v68, v92
    v_mul_f32 v29, v69, v93
    v_mul_f32 v30, v70, v94
    v_mul_f32 v31, v71, v95
    v_cvt_pk_bf16_f32 v32, v16, v17
    v_cvt_pk_bf16_f32 v33, v18, v19
    v_cvt_pk_bf16_f32 v34, v20, v21
    v_cvt_pk_bf16_f32 v35, v22, v23
    v_cvt_pk_bf16_f32 v36, v24, v25
    v_cvt_pk_bf16_f32 v37, v26, v27
    v_cvt_pk_bf16_f32 v38, v28, v29
    v_cvt_pk_bf16_f32 v39, v30, v31
    v_lshlrev_b32 v16, 16, v32
    v_and_b32 v17, s65, v32
    v_lshlrev_b32 v18, 16, v33
    v_and_b32 v19, s65, v33
    v_lshlrev_b32 v20, 16, v34
    v_and_b32 v21, s65, v34
    v_lshlrev_b32 v22, 16, v35
    v_and_b32 v23, s65, v35
    v_lshlrev_b32 v24, 16, v36
    v_and_b32 v25, s65, v36
    v_lshlrev_b32 v26, 16, v37
    v_and_b32 v27, s65, v37
    v_lshlrev_b32 v28, 16, v38
    v_and_b32 v29, s65, v38
    v_lshlrev_b32 v30, 16, v39
    v_and_b32 v31, s65, v39
    v_add_f32 v96, v56, v57
    v_add_f32 v97, v16, v17
    v_add_f32 v96, v96, v58
    v_add_f32 v97, v97, v18
    v_add_f32 v96, v96, v59
    v_add_f32 v97, v97, v19
    v_add_f32 v96, v96, v60
    v_add_f32 v97, v97, v20
    v_add_f32 v96, v96, v61
    v_add_f32 v97, v97, v21
    v_add_f32 v96, v96, v62
    v_add_f32 v97, v97, v22
    v_add_f32 v96, v96, v63
    v_add_f32 v97, v97, v23
    v_add_f32 v96, v96, v64
    v_add_f32 v97, v97, v24
    v_add_f32 v96, v96, v65
    v_add_f32 v97, v97, v25
    v_add_f32 v96, v96, v66
    v_add_f32 v97, v97, v26
    v_add_f32 v96, v96, v67
    v_add_f32 v97, v97, v27
    v_add_f32 v96, v96, v68
    v_add_f32 v97, v97, v28
    v_add_f32 v96, v96, v69
    v_add_f32 v97, v97, v29
    v_add_f32 v96, v96, v70
    v_add_f32 v97, v97, v30
    v_add_f32 v96, v96, v71
    v_add_f32 v97, v97, v31
    v_lshlrev_b32 v220, 16, v40
    v_and_b32 v221, s65, v40
    v_lshlrev_b32 v222, 16, v41
    v_and_b32 v223, s65, v41
    v_lshlrev_b32 v224, 16, v42
    v_and_b32 v225, s65, v42
    v_lshlrev_b32 v226, 16, v43
    v_and_b32 v227, s65, v43
    v_lshlrev_b32 v228, 16, v44
    v_and_b32 v229, s65, v44
    v_lshlrev_b32 v230, 16, v45
    v_and_b32 v231, s65, v45
    v_lshlrev_b32 v232, 16, v46
    v_and_b32 v233, s65, v46
    v_lshlrev_b32 v234, 16, v47
    v_and_b32 v235, s65, v47
    v_mul_f32 v236, v220, v80
    v_mul_f32 v237, v221, v81
    v_mul_f32 v238, v222, v82
    v_mul_f32 v239, v223, v83
    v_mul_f32 v240, v224, v84
    v_mul_f32 v241, v225, v85
    v_mul_f32 v242, v226, v86
    v_mul_f32 v243, v227, v87
    v_mul_f32 v244, v228, v88
    v_mul_f32 v245, v229, v89
    v_mul_f32 v246, v230, v90
    v_mul_f32 v247, v231, v91
    v_mul_f32 v248, v232, v92
    v_mul_f32 v249, v233, v93
    v_mul_f32 v250, v234, v94
    v_mul_f32 v251, v235, v95
    v_cvt_pk_bf16_f32 v40, v236, v237
    v_cvt_pk_bf16_f32 v41, v238, v239
    v_cvt_pk_bf16_f32 v42, v240, v241
    v_cvt_pk_bf16_f32 v43, v242, v243
    v_cvt_pk_bf16_f32 v44, v244, v245
    v_cvt_pk_bf16_f32 v45, v246, v247
    v_cvt_pk_bf16_f32 v46, v248, v249
    v_cvt_pk_bf16_f32 v47, v250, v251
    v_lshlrev_b32 v236, 16, v40
    v_and_b32 v237, s65, v40
    v_lshlrev_b32 v238, 16, v41
    v_and_b32 v239, s65, v41
    v_lshlrev_b32 v240, 16, v42
    v_and_b32 v241, s65, v42
    v_lshlrev_b32 v242, 16, v43
    v_and_b32 v243, s65, v43
    v_lshlrev_b32 v244, 16, v44
    v_and_b32 v245, s65, v44
    v_lshlrev_b32 v246, 16, v45
    v_and_b32 v247, s65, v45
    v_lshlrev_b32 v248, 16, v46
    v_and_b32 v249, s65, v46
    v_lshlrev_b32 v250, 16, v47
    v_and_b32 v251, s65, v47
    v_add_f32 v100, v220, v221
    v_add_f32 v101, v236, v237
    v_add_f32 v100, v100, v222
    v_add_f32 v101, v101, v238
    v_add_f32 v100, v100, v223
    v_add_f32 v101, v101, v239
    v_add_f32 v100, v100, v224
    v_add_f32 v101, v101, v240
    v_add_f32 v100, v100, v225
    v_add_f32 v101, v101, v241
    v_add_f32 v100, v100, v226
    v_add_f32 v101, v101, v242
    v_add_f32 v100, v100, v227
    v_add_f32 v101, v101, v243
    v_add_f32 v100, v100, v228
    v_add_f32 v101, v101, v244
    v_add_f32 v100, v100, v229
    v_add_f32 v101, v101, v245
    v_add_f32 v100, v100, v230
    v_add_f32 v101, v101, v246
    v_add_f32 v100, v100, v231
    v_add_f32 v101, v101, v247
    v_add_f32 v100, v100, v232
    v_add_f32 v101, v101, v248
    v_add_f32 v100, v100, v233
    v_add_f32 v101, v101, v249
    v_add_f32 v100, v100, v234
    v_add_f32 v101, v101, v250
    v_add_f32 v100, v100, v235
    v_add_f32 v101, v101, v251
    s_nop 1
    v_add_f32_dpp v96, v96, v96 quad_perm:[1,0,3,2] row_mask:0xf bank_mask:0xf
    v_add_f32_dpp v97, v97, v97 quad_perm:[1,0,3,2] row_mask:0xf bank_mask:0xf
    v_add_f32_dpp v100, v100, v100 quad_perm:[1,0,3,2] row_mask:0xf bank_mask:0xf
    v_add_f32_dpp v101, v101, v101 quad_perm:[1,0,3,2] row_mask:0xf bank_mask:0xf
    s_nop 1
    v_add_f32_dpp v96, v96, v96 quad_perm:[2,3,0,1] row_mask:0xf bank_mask:0xf
    v_add_f32_dpp v97, v97, v97 quad_perm:[2,3,0,1] row_mask:0xf bank_mask:0xf
    v_add_f32_dpp v100, v100, v100 quad_perm:[2,3,0,1] row_mask:0xf bank_mask:0xf
    v_add_f32_dpp v101, v101, v101 quad_perm:[2,3,0,1] row_mask:0xf bank_mask:0xf
    s_nop 1
    v_add_f32_dpp v96, v96, v96 row_half_mirror row_mask:0xf bank_mask:0xf
    v_add_f32_dpp v97, v97, v97 row_half_mirror row_mask:0xf bank_mask:0xf
    v_add_f32_dpp v100, v100, v100 row_half_mirror row_mask:0xf bank_mask:0xf
    v_add_f32_dpp v101, v101, v101 row_half_mirror row_mask:0xf bank_mask:0xf
    s_nop 1
    v_add_f32_dpp v96, v96, v96 row_mirror row_mask:0xf bank_mask:0xf
    v_add_f32_dpp v97, v97, v97 row_mirror row_mask:0xf bank_mask:0xf
    v_add_f32_dpp v100, v100, v100 row_mirror row_mask:0xf bank_mask:0xf
    v_add_f32_dpp v101, v101, v101 row_mirror row_mask:0xf bank_mask:0xf
    s_nop 1
    v_readlane_b32 s76, v96, 0
    v_readlane_b32 s77, v96, 16
    v_readlane_b32 s78, v96, 32
    v_readlane_b32 s79, v96, 48
    s_nop 1
    v_mov_b32 v96, s76
    v_add_f32 v96, s77, v96
    v_add_f32 v96, s78, v96
    v_add_f32 v96, s79, v96
    s_nop 1
    v_readlane_b32 s76, v97, 0
    v_readlane_b32 s77, v97, 16
    v_readlane_b32 s78, v97, 32
    v_readlane_b32 s79, v97, 48
    s_nop 1
    v_mov_b32 v97, s76
    v_add_f32 v97, s77, v97
    v_add_f32 v97, s78, v97
    v_add_f32 v97, s79, v97
    s_nop 1
    v_readlane_b32 s76, v100, 0
    v_readlane_b32 s77, v100, 16
    v_readlane_b32 s78, v100, 32
    v_readlane_b32 s79, v100, 48
    s_nop 1
    v_mov_b32 v100, s76
    v_add_f32 v100, s77, v100
    v_add_f32 v100, s78, v100
    v_add_f32 v100, s79, v100
    s_nop 1
    v_readlane_b32 s76, v101, 0
    v_readlane_b32 s77, v101, 16
    v_readlane_b32 s78, v101, 32
    v_readlane_b32 s79, v101, 48
    s_nop 1
    v_mov_b32 v101, s76
    v_add_f32 v101, s77, v101
    v_add_f32 v101, s78, v101
    v_add_f32 v101, s79, v101
    v_mul_f32 v96, 0x3a800000, v96
    v_sub_f32 v16, v56, v96
    v_sub_f32 v17, v57, v96
    v_sub_f32 v18, v58, v96
    v_sub_f32 v19, v59, v96
    v_sub_f32 v20, v60, v96
    v_sub_f32 v21, v61, v96
    v_sub_f32 v22, v62, v96
    v_sub_f32 v23, v63, v96
    v_sub_f32 v24, v64, v96
    v_sub_f32 v25, v65, v96
    v_sub_f32 v26, v66, v96
    v_sub_f32 v27, v67, v96
    v_sub_f32 v28, v68, v96
    v_sub_f32 v29, v69, v96
    v_sub_f32 v30, v70, v96
    v_sub_f32 v31, v71, v96
    v_mul_f32 v98, v16, v16
    v_fmac_f32 v98, v17, v17
    v_fmac_f32 v98, v18, v18
    v_fmac_f32 v98, v19, v19
    v_fmac_f32 v98, v20, v20
    v_fmac_f32 v98, v21, v21
    v_fmac_f32 v98, v22, v22
    v_fmac_f32 v98, v23, v23
    v_fmac_f32 v98, v24, v24
    v_fmac_f32 v98, v25, v25
    v_fmac_f32 v98, v26, v26
    v_fmac_f32 v98, v27, v27
    v_fmac_f32 v98, v28, v28
    v_fmac_f32 v98, v29, v29
    v_fmac_f32 v98, v30, v30
    v_fmac_f32 v98, v31, v31
    v_mul_f32 v100, 0x3a800000, v100
    v_sub_f32 v236, v220, v100
    v_sub_f32 v237, v221, v100
    v_sub_f32 v238, v222, v100
    v_sub_f32 v239, v223, v100
    v_sub_f32 v240, v224, v100
    v_sub_f32 v241, v225, v100
    v_sub_f32 v242, v226, v100
    v_sub_f32 v243, v227, v100
    v_sub_f32 v244, v228, v100
    v_sub_f32 v245, v229, v100
    v_sub_f32 v246, v230, v100
    v_sub_f32 v247, v231, v100
    v_sub_f32 v248, v232, v100
    v_sub_f32 v249, v233, v100
    v_sub_f32 v250, v234, v100
    v_sub_f32 v251, v235, v100
    v_mul_f32 v102, v236, v236
    v_fmac_f32 v102, v237, v237
    v_fmac_f32 v102, v238, v238
    v_fmac_f32 v102, v239, v239
    v_fmac_f32 v102, v240, v240
    v_fmac_f32 v102, v241, v241
    v_fmac_f32 v102, v242, v242
    v_fmac_f32 v102, v243, v243
    v_fmac_f32 v102, v244, v244
    v_fmac_f32 v102, v245, v245
    v_fmac_f32 v102, v246, v246
    v_fmac_f32 v102, v247, v247
    v_fmac_f32 v102, v248, v248
    v_fmac_f32 v102, v249, v249
    v_fmac_f32 v102, v250, v250
    v_fmac_f32 v102, v251, v251
    s_nop 1
    v_add_f32_dpp v98, v98, v98 quad_perm:[1,0,3,2] row_mask:0xf bank_mask:0xf
    v_add_f32_dpp v102, v102, v102 quad_perm:[1,0,3,2] row_mask:0xf bank_mask:0xf
    s_nop 1
    v_add_f32_dpp v98, v98, v98 quad_perm:[2,3,0,1] row_mask:0xf bank_mask:0xf
    v_add_f32_dpp v102, v102, v102 quad_perm:[2,3,0,1] row_mask:0xf bank_mask:0xf
    s_nop 1
    v_add_f32_dpp v98, v98, v98 row_half_mirror row_mask:0xf bank_mask:0xf
    v_add_f32_dpp v102, v102, v102 row_half_mirror row_mask:0xf bank_mask:0xf
    s_nop 1
    v_add_f32_dpp v98, v98, v98 row_mirror row_mask:0xf bank_mask:0xf
    v_add_f32_dpp v102, v102, v102 row_mirror row_mask:0xf bank_mask:0xf
    s_nop 1
    v_readlane_b32 s76, v98, 0
    v_readlane_b32 s77, v98, 16
    v_readlane_b32 s78, v98, 32
    v_readlane_b32 s79, v98, 48
    s_nop 1
    v_mov_b32 v98, s76
    v_add_f32 v98, s77, v98
    v_add_f32 v98, s78, v98
    v_add_f32 v98, s79, v98
    s_nop 1
    v_readlane_b32 s76, v102, 0
    v_readlane_b32 s77, v102, 16
    v_readlane_b32 s78, v102, 32
    v_readlane_b32 s79, v102, 48
    s_nop 1
    v_mov_b32 v102, s76
    v_add_f32 v102, s77, v102
    v_add_f32 v102, s78, v102
    v_add_f32 v102, s79, v102
    v_mul_f32 v98, 0x3a800000, v98
    v_cvt_pk_bf16_f32 v98, v98, v98
    v_lshlrev_b32 v98, 16, v98
    v_add_f32 v98, 0x3727c5ac, v98
    v_cvt_pk_bf16_f32 v98, v98, v98
    v_lshlrev_b32 v98, 16, v98
    v_sqrt_f32 v98, v98
    v_cvt_pk_bf16_f32 v97, v97, v97
    v_lshlrev_b32 v97, 16, v97
    v_mul_f32 v97, 0xbfb8aa3b, v97
    v_cvt_pk_bf16_f32 v98, v98, v98
    v_lshlrev_b32 v98, 16, v98
    v_exp_f32 v97, v97
    v_rcp_f32 v33, v98
    v_cvt_pk_bf16_f32 v32, v96, v96
    v_lshlrev_b32 v32, 16, v32
    v_add_f32 v97, 1.0, v97
    v_rcp_f32 v97, v97
    s_nop 0
    v_cvt_pk_bf16_f32 v36, v97, v97
    v_lshlrev_b32 v36, 16, v36
    v_mul_f32 v102, 0x3a800000, v102
    v_cvt_pk_bf16_f32 v102, v102, v102
    v_lshlrev_b32 v102, 16, v102
    v_add_f32 v102, 0x3727c5ac, v102
    v_cvt_pk_bf16_f32 v102, v102, v102
    v_lshlrev_b32 v102, 16, v102
    v_sqrt_f32 v102, v102
    v_cvt_pk_bf16_f32 v101, v101, v101
    v_lshlrev_b32 v101, 16, v101
    v_mul_f32 v101, 0xbfb8aa3b, v101
    v_cvt_pk_bf16_f32 v102, v102, v102
    v_lshlrev_b32 v102, 16, v102
    v_exp_f32 v101, v101
    v_rcp_f32 v35, v102
    v_cvt_pk_bf16_f32 v34, v100, v100
    v_lshlrev_b32 v34, 16, v34
    v_add_f32 v101, 1.0, v101
    v_rcp_f32 v101, v101
    s_nop 0
    v_cvt_pk_bf16_f32 v37, v101, v101
    v_lshlrev_b32 v37, 16, v37
    s_lshr_b32 s63, s85, 4
    s_lshl_b32 s63, s63, 7
    s_lshl_b32 s66, s32, 3
    s_add_u32 s63, s63, s66
    s_lshl_b32 s66, s85, 3
    v_mov_b32 v10, 0
    s_mov_b64 exec, 1
    buffer_store_dwordx4 v[32:35], v10, s[72:75], s66 offen sc0 sc1
    buffer_store_dwordx2 v[36:37], v10, s[68:71], s63 offen sc0 sc1
    s_mov_b64 exec, -1
    s_nop 1
    s_barrier
    ds_read_b128 v[16:19], v104 offset:0
    ds_read_b128 v[32:35], v108 offset:0
    ds_read_b128 v[20:23], v104 offset:2048
    ds_read_b128 v[36:39], v108 offset:8192
    ds_read_b128 v[24:27], v104 offset:4096
    ds_read_b128 v[40:43], v108 offset:2048
    ds_read_b128 v[28:31], v104 offset:6144
    ds_read_b128 v[44:47], v108 offset:10240
    s_mov_b32 s80, s56
    s_mov_b32 s81, s57
    s_mov_b32 s82, 256
    s_mov_b32 s83, 0x00020000
    s_cmp_eq_u32 s32, 0
    s_cselect_b32 s88, 6, 99
    s_cselect_b32 s89, 2, 99
    s_mov_b32 s31, 7
ssm_loop:
    s_cmp_lg_u32 s31, 4
    s_cbranch_scc1 ssm_h1
    v_subrev_u32 v112, s84, v112
    v_subrev_u32 v113, s84, v113
    v_subrev_u32 v114, s84, v114
    v_subrev_u32 v115, s84, v115
ssm_h1:
    s_cmp_lg_u32 s31, s88
    s_cbranch_scc1 ssm_h2
    s_lshl_b32 s63, s34, 2
    v_mov_b32 v9, 1
    v_mov_b32 v10, 0
    s_mov_b64 exec, 1
    buffer_atomic_add v9, v10, s[80:83], s63 offen sc1
    s_mov_b64 exec, -1
ssm_h2:
    s_cmp_lg_u32 s31, s89
    s_cbranch_scc1 ssm_h3
    v_and_b32 v12, 7, v2
    v_lshlrev_b32 v12, 2, v12
    buffer_load_dword v13, v12, s[80:83], 0 offen sc1
ssm_h3:
    s_waitcnt lgkmcnt(0)
    v_mfma_f32_16x16x32_bf16 v[128:131], v[16:19], v[32:35], v[128:131]
    ds_read_b128 v[48:51], v105 offset:0
    v_mfma_f32_16x16x32_bf16 v[132:135], v[20:23], v[32:35], v[132:135]
    ds_read_b128 v[64:67], v109 offset:0
    v_mfma_f32_16x16x32_bf16 v[136:139], v[24:27], v[32:35], v[136:139]
    ds_read_b128 v[52:55], v105 offset:2048
    v_mfma_f32_16x16x32_bf16 v[140:143], v[28:31], v[32:35], v[140:143]
    ds_read_b128 v[68:71], v109 offset:8192
    v_mfma_f32_16x16x32_bf16 v[144:147], v[16:19], v[36:39], v[144:147]
    ds_read_b128 v[56:59], v105 offset:4096
    v_mfma_f32_16x16x32_bf16 v[148:151], v[20:23], v[36:39], v[148:151]
    ds_read_b128 v[72:75], v109 offset:2048
    v_mfma_f32_16x16x32_bf16 v[152:155], v[24:27], v[36:39], v[152:155]
    ds_read_b128 v[60:63], v105 offset:6144
    v_mfma_f32_16x16x32_bf16 v[156:159], v[28:31], v[36:39], v[156:159]
    ds_read_b128 v[76:79], v109 offset:10240
    v_mfma_f32_16x16x32_bf16 v[160:163], v[16:19], v[40:43], v[160:163]
    v_mfma_f32_16x16x32_bf16 v[164:167], v[20:23], v[40:43], v[164:167]
    v_mfma_f32_16x16x32_bf16 v[168:171], v[24:27], v[40:43], v[168:171]
    v_mfma_f32_16x16x32_bf16 v[172:175], v[28:31], v[40:43], v[172:175]
    v_mfma_f32_16x16x32_bf16 v[176:179], v[16:19], v[44:47], v[176:179]
    v_mfma_f32_16x16x32_bf16 v[180:183], v[20:23], v[44:47], v[180:183]
    v_mfma_f32_16x16x32_bf16 v[184:187], v[24:27], v[44:47], v[184:187]
    v_mfma_f32_16x16x32_bf16 v[188:191], v[28:31], v[44:47], v[188:191]
    s_waitcnt vmcnt(3)
    s_cmp_eq_u32 s31, 7
    s_cbranch_scc1 ssm_w1
    s_waitcnt vmcnt(1)
    s_cmp_eq_u32 s31, s88
    s_cbranch_scc1 ssm_w1
    s_cmp_eq_u32 s31, s89
    s_cbranch_scc1 ssm_w1
    s_waitcnt vmcnt(0)
ssm_w1:
    s_waitcnt lgkmcnt(0)
    s_barrier
    v_mfma_f32_16x16x32_bf16 v[128:131], v[48:51], v[64:67], v[128:131]
    ds_read_b128 v[16:19], v106 offset:0
    v_mfma_f32_16x16x32_bf16 v[132:135], v[52:55], v[64:67], v[132:135]
    ds_read_b128 v[32:35], v110 offset:0
    v_mfma_f32_16x16x32_bf16 v[136:139], v[56:59], v[64:67], v[136:139]
    s_add_u32 m0, s29, 0
    s_nop 0
    buffer_load_dwordx4 v112, s[4:7], s20 offen lds
    v_mfma_f32_16x16x32_bf16 v[140:143], v[60:63], v[64:67], v[140:143]
    ds_read_b128 v[20:23], v106 offset:2048
    v_mfma_f32_16x16x32_bf16 v[144:147], v[48:51], v[68:71], v[144:147]
    ds_read_b128 v[36:39], v110 offset:8192
    v_mfma_f32_16x16x32_bf16 v[148:151], v[52:55], v[68:71], v[148:151]
    s_add_u32 m0, s29, 1024
    s_nop 0
    buffer_load_dwordx4 v113, s[4:7], s21 offen lds
    v_mfma_f32_16x16x32_bf16 v[152:155], v[56:59], v[68:71], v[152:155]
    ds_read_b128 v[24:27], v106 offset:4096
    v_mfma_f32_16x16x32_bf16 v[156:159], v[60:63], v[68:71], v[156:159]
    ds_read_b128 v[40:43], v110 offset:2048
    v_mfma_f32_16x16x32_bf16 v[160:163], v[48:51], v[72:75], v[160:163]
    s_add_u32 m0, s29, 2048
    s_nop 0
    buffer_load_dwordx4 v112, s[4:7], s22 offen lds
    v_mfma_f32_16x16x32_bf16 v[164:167], v[52:55], v[72:75], v[164:167]
    ds_read_b128 v[28:31], v106 offset:6144
    v_mfma_f32_16x16x32_bf16 v[168:171], v[56:59], v[72:75], v[168:171]
    ds_read_b128 v[44:47], v110 offset:10240
    v_mfma_f32_16x16x32_bf16 v[172:175], v[60:63], v[72:75], v[172:175]
    s_add_u32 m0, s29, 3072
    s_nop 0
    buffer_load_dwordx4 v113, s[4:7], s23 offen lds
    v_mfma_f32_16x16x32_bf16 v[176:179], v[48:51], v[76:79], v[176:179]
    s_add_u32 m0, s30, 0
    s_nop 0
    buffer_load_dwordx4 v114, s[8:11], s24 offen lds
    v_mfma_f32_16x16x32_bf16 v[180:183], v[52:55], v[76:79], v[180:183]
    s_add_u32 m0, s30, 1024
    s_nop 0
    buffer_load_dwordx4 v115, s[8:11], s25 offen lds
    v_mfma_f32_16x16x32_bf16 v[184:187], v[56:59], v[76:79], v[184:187]
    v_add_u32 v112, 128, v112
    v_add_u32 v113, 128, v113
    v_add_u32 v114, 128, v114
    v_add_u32 v115, 128, v115
    v_mfma_f32_16x16x32_bf16 v[188:191], v[60:63], v[76:79], v[188:191]
    s_waitcnt lgkmcnt(0)
    v_mfma_f32_16x16x32_bf16 v[128:131], v[16:19], v[32:35], v[128:131]
    ds_read_b128 v[48:51], v107 offset:0
    v_mfma_f32_16x16x32_bf16 v[132:135], v[20:23], v[32:35], v[132:135]
    ds_read_b128 v[64:67], v111 offset:0
    v_mfma_f32_16x16x32_bf16 v[136:139], v[24:27], v[32:35], v[136:139]
    ds_read_b128 v[52:55], v107 offset:2048
    v_mfma_f32_16x16x32_bf16 v[140:143], v[28:31], v[32:35], v[140:143]
    ds_read_b128 v[68:71], v111 offset:8192
    v_mfma_f32_16x16x32_bf16 v[144:147], v[16:19], v[36:39], v[144:147]
    ds_read_b128 v[56:59], v107 offset:4096
    v_mfma_f32_16x16x32_bf16 v[148:151], v[20:23], v[36:39], v[148:151]
    ds_read_b128 v[72:75], v111 offset:2048
    v_mfma_f32_16x16x32_bf16 v[152:155], v[24:27], v[36:39], v[152:155]
    ds_read_b128 v[60:63], v107 offset:6144
    v_mfma_f32_16x16x32_bf16 v[156:159], v[28:31], v[36:39], v[156:159]
    ds_read_b128 v[76:79], v111 offset:10240
    v_mfma_f32_16x16x32_bf16 v[160:163], v[16:19], v[40:43], v[160:163]
    v_mfma_f32_16x16x32_bf16 v[164:167], v[20:23], v[40:43], v[164:167]
    v_mfma_f32_16x16x32_bf16 v[168:171], v[24:27], v[40:43], v[168:171]
    v_mfma_f32_16x16x32_bf16 v[172:175], v[28:31], v[40:43], v[172:175]
    v_mfma_f32_16x16x32_bf16 v[176:179], v[16:19], v[44:47], v[176:179]
    v_mfma_f32_16x16x32_bf16 v[180:183], v[20:23], v[44:47], v[180:183]
    v_mfma_f32_16x16x32_bf16 v[184:187], v[24:27], v[44:47], v[184:187]
    v_mfma_f32_16x16x32_bf16 v[188:191], v[28:31], v[44:47], v[188:191]
    s_waitcnt vmcnt(0) lgkmcnt(0)
    s_barrier
    v_mfma_f32_16x16x32_bf16 v[128:131], v[48:51], v[64:67], v[128:131]
    ds_read_b128 v[16:19], v104 offset:0
    v_mfma_f32_16x16x32_bf16 v[132:135], v[52:55], v[64:67], v[132:135]
    ds_read_b128 v[32:35], v108 offset:0
    v_mfma_f32_16x16x32_bf16 v[136:139], v[56:59], v[64:67], v[136:139]
    s_add_u32 m0, s29, 61440
    s_nop 0
    buffer_load_dwordx4 v112, s[4:7], s20 offen lds
    v_mfma_f32_16x16x32_bf16 v[140:143], v[60:63], v[64:67], v[140:143]
    ds_read_b128 v[20:23], v104 offset:2048
    v_mfma_f32_16x16x32_bf16 v[144:147], v[48:51], v[68:71], v[144:147]
    ds_read_b128 v[36:39], v108 offset:8192
    v_mfma_f32_16x16x32_bf16 v[148:151], v[52:55], v[68:71], v[148:151]
    s_add_u32 m0, s29, 62464
    s_nop 0
    buffer_load_dwordx4 v113, s[4:7], s21 offen lds
    v_mfma_f32_16x16x32_bf16 v[152:155], v[56:59], v[68:71], v[152:155]
    ds_read_b128 v[24:27], v104 offset:4096
    v_mfma_f32_16x16x32_bf16 v[156:159], v[60:63], v[68:71], v[156:159]
    ds_read_b128 v[40:43], v108 offset:2048
    v_mfma_f32_16x16x32_bf16 v[160:163], v[48:51], v[72:75], v[160:163]
    s_add_u32 m0, s29, 63488
    s_nop 0
    buffer_load_dwordx4 v112, s[4:7], s22 offen lds
    v_mfma_f32_16x16x32_bf16 v[164:167], v[52:55], v[72:75], v[164:167]
    ds_read_b128 v[28:31], v104 offset:6144
    v_mfma_f32_16x16x32_bf16 v[168:171], v[56:59], v[72:75], v[168:171]
    ds_read_b128 v[44:47], v108 offset:10240
    v_mfma_f32_16x16x32_bf16 v[172:175], v[60:63], v[72:75], v[172:175]
    s_add_u32 m0, s29, 64512
    s_nop 0
    buffer_load_dwordx4 v113, s[4:7], s23 offen lds
    v_mfma_f32_16x16x32_bf16 v[176:179], v[48:51], v[76:79], v[176:179]
    s_add_u32 m0, s30, 61440
    s_nop 0
    buffer_load_dwordx4 v114, s[8:11], s24 offen lds
    v_mfma_f32_16x16x32_bf16 v[180:183], v[52:55], v[76:79], v[180:183]
    s_add_u32 m0, s30, 62464
    s_nop 0
    buffer_load_dwordx4 v115, s[8:11], s25 offen lds
    v_mfma_f32_16x16x32_bf16 v[184:187], v[56:59], v[76:79], v[184:187]
    v_add_u32 v112, 128, v112
    v_add_u32 v113, 128, v113
    v_add_u32 v114, 128, v114
    v_add_u32 v115, 128, v115
    v_mfma_f32_16x16x32_bf16 v[188:191], v[60:63], v[76:79], v[188:191]
    s_sub_u32 s31, s31, 1
    s_cmp_lg_u32 s31, 0
    s_cbranch_scc1 ssm_loop
    s_waitcnt lgkmcnt(0)
    v_mfma_f32_16x16x32_bf16 v[128:131], v[16:19], v[32:35], v[128:131]
    ds_read_b128 v[48:51], v105 offset:0
    v_mfma_f32_16x16x32_bf16 v[132:135], v[20:23], v[32:35], v[132:135]
    ds_read_b128 v[64:67], v109 offset:0
    v_mfma_f32_16x16x32_bf16 v[136:139], v[24:27], v[32:35], v[136:139]
    ds_read_b128 v[52:55], v105 offset:2048
    v_mfma_f32_16x16x32_bf16 v[140:143], v[28:31], v[32:35], v[140:143]
    ds_read_b128 v[68:71], v109 offset:8192
    v_mfma_f32_16x16x32_bf16 v[144:147], v[16:19], v[36:39], v[144:147]
    ds_read_b128 v[56:59], v105 offset:4096
    v_mfma_f32_16x16x32_bf16 v[148:151], v[20:23], v[36:39], v[148:151]
    ds_read_b128 v[72:75], v109 offset:2048
    v_mfma_f32_16x16x32_bf16 v[152:155], v[24:27], v[36:39], v[152:155]
    ds_read_b128 v[60:63], v105 offset:6144
    v_mfma_f32_16x16x32_bf16 v[156:159], v[28:31], v[36:39], v[156:159]
    ds_read_b128 v[76:79], v109 offset:10240
    v_mfma_f32_16x16x32_bf16 v[160:163], v[16:19], v[40:43], v[160:163]
    v_mfma_f32_16x16x32_bf16 v[164:167], v[20:23], v[40:43], v[164:167]
    v_mfma_f32_16x16x32_bf16 v[168:171], v[24:27], v[40:43], v[168:171]
    v_mfma_f32_16x16x32_bf16 v[172:175], v[28:31], v[40:43], v[172:175]
    v_mfma_f32_16x16x32_bf16 v[176:179], v[16:19], v[44:47], v[176:179]
    v_mfma_f32_16x16x32_bf16 v[180:183], v[20:23], v[44:47], v[180:183]
    v_mfma_f32_16x16x32_bf16 v[184:187], v[24:27], v[44:47], v[184:187]
    v_mfma_f32_16x16x32_bf16 v[188:191], v[28:31], v[44:47], v[188:191]
    s_waitcnt vmcnt(0) lgkmcnt(0)
    s_barrier
    v_mfma_f32_16x16x32_bf16 v[128:131], v[48:51], v[64:67], v[128:131]
    ds_read_b128 v[16:19], v106 offset:0
    v_mfma_f32_16x16x32_bf16 v[132:135], v[52:55], v[64:67], v[132:135]
    ds_read_b128 v[32:35], v110 offset:0
    v_mfma_f32_16x16x32_bf16 v[136:139], v[56:59], v[64:67], v[136:139]
    ds_read_b128 v[20:23], v106 offset:2048
    v_mfma_f32_16x16x32_bf16 v[140:143], v[60:63], v[64:67], v[140:143]
    ds_read_b128 v[36:39], v110 offset:8192
    v_mfma_f32_16x16x32_bf16 v[144:147], v[48:51], v[68:71], v[144:147]
    ds_read_b128 v[24:27], v106 offset:4096
    v_mfma_f32_16x16x32_bf16 v[148:151], v[52:55], v[68:71], v[148:151]
    ds_read_b128 v[40:43], v110 offset:2048
    v_mfma_f32_16x16x32_bf16 v[152:155], v[56:59], v[68:71], v[152:155]
    ds_read_b128 v[28:31], v106 offset:6144
    v_mfma_f32_16x16x32_bf16 v[156:159], v[60:63], v[68:71], v[156:159]
    ds_read_b128 v[44:47], v110 offset:10240
    v_mfma_f32_16x16x32_bf16 v[160:163], v[48:51], v[72:75], v[160:163]
    v_mfma_f32_16x16x32_bf16 v[164:167], v[52:55], v[72:75], v[164:167]
    v_mfma_f32_16x16x32_bf16 v[168:171], v[56:59], v[72:75], v[168:171]
    v_mfma_f32_16x16x32_bf16 v[172:175], v[60:63], v[72:75], v[172:175]
    v_mfma_f32_16x16x32_bf16 v[176:179], v[48:51], v[76:79], v[176:179]
    v_mfma_f32_16x16x32_bf16 v[180:183], v[52:55], v[76:79], v[180:183]
    v_mfma_f32_16x16x32_bf16 v[184:187], v[56:59], v[76:79], v[184:187]
    v_mfma_f32_16x16x32_bf16 v[188:191], v[60:63], v[76:79], v[188:191]
    s_waitcnt lgkmcnt(0)
    v_mfma_f32_16x16x32_bf16 v[128:131], v[16:19], v[32:35], v[128:131]
    ds_read_b128 v[48:51], v107 offset:0
    v_mfma_f32_16x16x32_bf16 v[132:135], v[20:23], v[32:35], v[132:135]
    ds_read_b128 v[64:67], v111 offset:0
    v_mfma_f32_16x16x32_bf16 v[136:139], v[24:27], v[32:35], v[136:139]
    ds_read_b128 v[52:55], v107 offset:2048
    v_mfma_f32_16x16x32_bf16 v[140:143], v[28:31], v[32:35], v[140:143]
    ds_read_b128 v[68:71], v111 offset:8192
    v_mfma_f32_16x16x32_bf16 v[144:147], v[16:19], v[36:39], v[144:147]
    ds_read_b128 v[56:59], v107 offset:4096
    v_mfma_f32_16x16x32_bf16 v[148:151], v[20:23], v[36:39], v[148:151]
    ds_read_b128 v[72:75], v111 offset:2048
    v_mfma_f32_16x16x32_bf16 v[152:155], v[24:27], v[36:39], v[152:155]
    ds_read_b128 v[60:63], v107 offset:6144
    v_mfma_f32_16x16x32_bf16 v[156:159], v[28:31], v[36:39], v[156:159]
    ds_read_b128 v[76:79], v111 offset:10240
    v_mfma_f32_16x16x32_bf16 v[160:163], v[16:19], v[40:43], v[160:163]
    v_mfma_f32_16x16x32_bf16 v[164:167], v[20:23], v[40:43], v[164:167]
    v_mfma_f32_16x16x32_bf16 v[168:171], v[24:27], v[40:43], v[168:171]
    v_mfma_f32_16x16x32_bf16 v[172:175], v[28:31], v[40:43], v[172:175]
    v_mfma_f32_16x16x32_bf16 v[176:179], v[16:19], v[44:47], v[176:179]
    v_mfma_f32_16x16x32_bf16 v[180:183], v[20:23], v[44:47], v[180:183]
    v_mfma_f32_16x16x32_bf16 v[184:187], v[24:27], v[44:47], v[184:187]
    v_mfma_f32_16x16x32_bf16 v[188:191], v[28:31], v[44:47], v[188:191]
    s_waitcnt vmcnt(0) lgkmcnt(0)
    s_barrier
    v_mfma_f32_16x16x32_bf16 v[128:131], v[48:51], v[64:67], v[128:131]
    v_mfma_f32_16x16x32_bf16 v[132:135], v[52:55], v[64:67], v[132:135]
    v_mfma_f32_16x16x32_bf16 v[136:139], v[56:59], v[64:67], v[136:139]
    v_mfma_f32_16x16x32_bf16 v[140:143], v[60:63], v[64:67], v[140:143]
    v_mfma_f32_16x16x32_bf16 v[144:147], v[48:51], v[68:71], v[144:147]
    v_mfma_f32_16x16x32_bf16 v[148:151], v[52:55], v[68:71], v[148:151]
    v_mfma_f32_16x16x32_bf16 v[152:155], v[56:59], v[68:71], v[152:155]
    v_mfma_f32_16x16x32_bf16 v[156:159], v[60:63], v[68:71], v[156:159]
    v_mfma_f32_16x16x32_bf16 v[160:163], v[48:51], v[72:75], v[160:163]
    v_mfma_f32_16x16x32_bf16 v[164:167], v[52:55], v[72:75], v[164:167]
    v_mfma_f32_16x16x32_bf16 v[168:171], v[56:59], v[72:75], v[168:171]
    v_mfma_f32_16x16x32_bf16 v[172:175], v[60:63], v[72:75], v[172:175]
    v_mfma_f32_16x16x32_bf16 v[176:179], v[48:51], v[76:79], v[176:179]
    v_mfma_f32_16x16x32_bf16 v[180:183], v[52:55], v[76:79], v[180:183]
    v_mfma_f32_16x16x32_bf16 v[184:187], v[56:59], v[76:79], v[184:187]
    v_mfma_f32_16x16x32_bf16 v[188:191], v[60:63], v[76:79], v[188:191]
    s_cmp_lt_u32 s32, 4
    s_cbranch_scc1 ssm_pf3
    s_cmp_lt_u32 s32, 6
    s_cselect_b32 s40, s42, s40
    s_cselect_b32 s41, s43, s41
    s_lshl_b32 s63, s34, 4
    s_add_u32 s63, s63, s35
    s_lshl_b32 s66, s61, 7
    s_add_u32 s63, s63, s66
    s_lshl_b32 s66, s63, 13
    s_mov_b32 s72, s40
    s_mov_b32 s73, s41
    s_mov_b32 s74, 2097152
    s_mov_b32 s75, 0x00020000
    buffer_load_dword v218, v216, s[72:75], s66 offen
ssm_pf3:
    s_cmp_lg_u32 s32, 0
    s_cbranch_scc1 ssm_mrok
    s_mov_b32 s84, 0x100000
ssm_mr:
    v_cmp_eq_u32 vcc, 16, v13
    s_cmp_eq_u32 vcc_lo, -1
    s_cbranch_scc1 ssm_mrok
    s_sleep 64
    buffer_load_dword v13, v12, s[80:83], 0 offen sc0 sc1
    s_waitcnt vmcnt(0)
    s_sub_u32 s84, s84, 1
    s_cmp_lg_u32 s84, 0
    s_cbranch_scc1 ssm_mr
ssm_mrok:
    s_nop 7
    s_nop 7
    v_mul_f32 v16, v203, v144
    v_mul_f32 v17, v203, v128
    v_fma_f32 v128, v202, v128, -v16
    v_fma_f32 v144, v202, v144, v17
    v_mul_f32 v18, v207, v176
    v_mul_f32 v19, v207, v160
    v_fma_f32 v160, v206, v160, -v18
    v_fma_f32 v176, v206, v176, v19
    v_mul_f32 v16, v203, v145
    v_mul_f32 v17, v203, v129
    v_fma_f32 v129, v202, v129, -v16
    v_fma_f32 v145, v202, v145, v17
    v_mul_f32 v18, v207, v177
    v_mul_f32 v19, v207, v161
    v_fma_f32 v161, v206, v161, -v18
    v_fma_f32 v177, v206, v177, v19
    v_mul_f32 v16, v203, v146
    v_mul_f32 v17, v203, v130
    v_fma_f32 v130, v202, v130, -v16
    v_fma_f32 v146, v202, v146, v17
    v_mul_f32 v18, v207, v178
    v_mul_f32 v19, v207, v162
    v_fma_f32 v162, v206, v162, -v18
    v_fma_f32 v178, v206, v178, v19
    v_mul_f32 v16, v203, v147
    v_mul_f32 v17, v203, v131
    v_fma_f32 v131, v202, v131, -v16
    v_fma_f32 v147, v202, v147, v17
    v_mul_f32 v18, v207, v179
    v_mul_f32 v19, v207, v163
    v_fma_f32 v163, v206, v163, -v18
    v_fma_f32 v179, v206, v179, v19
    v_mul_f32 v16, v203, v148
    v_mul_f32 v17, v203, v132
    v_fma_f32 v132, v202, v132, -v16
    v_fma_f32 v148, v202, v148, v17
    v_mul_f32 v18, v207, v180
    v_mul_f32 v19, v207, v164
    v_fma_f32 v164, v206, v164, -v18
    v_fma_f32 v180, v206, v180, v19
    v_mul_f32 v16, v203, v149
    v_mul_f32 v17, v203, v133
    v_fma_f32 v133, v202, v133, -v16
    v_fma_f32 v149, v202, v149, v17
    v_mul_f32 v18, v207, v181
    v_mul_f32 v19, v207, v165
    v_fma_f32 v165, v206, v165, -v18
    v_fma_f32 v181, v206, v181, v19
    v_mul_f32 v16, v203, v150
    v_mul_f32 v17, v203, v134
    v_fma_f32 v134, v202, v134, -v16
    v_fma_f32 v150, v202, v150, v17
    v_mul_f32 v18, v207, v182
    v_mul_f32 v19, v207, v166
    v_fma_f32 v166, v206, v166, -v18
    v_fma_f32 v182, v206, v182, v19
    v_mul_f32 v16, v203, v151
    v_mul_f32 v17, v203, v135
    v_fma_f32 v135, v202, v135, -v16
    v_fma_f32 v151, v202, v151, v17
    v_mul_f32 v18, v207, v183
    v_mul_f32 v19, v207, v167
    v_fma_f32 v167, v206, v167, -v18
    v_fma_f32 v183, v206, v183, v19
    v_mul_f32 v16, v203, v152
    v_mul_f32 v17, v203, v136
    v_fma_f32 v136, v202, v136, -v16
    v_fma_f32 v152, v202, v152, v17
    v_mul_f32 v18, v207, v184
    v_mul_f32 v19, v207, v168
    v_fma_f32 v168, v206, v168, -v18
    v_fma_f32 v184, v206, v184, v19
    v_mul_f32 v16, v203, v153
    v_mul_f32 v17, v203, v137
    v_fma_f32 v137, v202, v137, -v16
    v_fma_f32 v153, v202, v153, v17
    v_mul_f32 v18, v207, v185
    v_mul_f32 v19, v207, v169
    v_fma_f32 v169, v206, v169, -v18
    v_fma_f32 v185, v206, v185, v19
    v_mul_f32 v16, v203, v154
    v_mul_f32 v17, v203, v138
    v_fma_f32 v138, v202, v138, -v16
    v_fma_f32 v154, v202, v154, v17
    v_mul_f32 v18, v207, v186
    v_mul_f32 v19, v207, v170
    v_fma_f32 v170, v206, v170, -v18
    v_fma_f32 v186, v206, v186, v19
    v_mul_f32 v16, v203, v155
    v_mul_f32 v17, v203, v139
    v_fma_f32 v139, v202, v139, -v16
    v_fma_f32 v155, v202, v155, v17
    v_mul_f32 v18, v207, v187
    v_mul_f32 v19, v207, v171
    v_fma_f32 v171, v206, v171, -v18
    v_fma_f32 v187, v206, v187, v19
    v_mul_f32 v16, v203, v156
    v_mul_f32 v17, v203, v140
    v_fma_f32 v140, v202, v140, -v16
    v_fma_f32 v156, v202, v156, v17
    v_mul_f32 v18, v207, v188
    v_mul_f32 v19, v207, v172
    v_fma_f32 v172, v206, v172, -v18
    v_fma_f32 v188, v206, v188, v19
    v_mul_f32 v16, v203, v157
    v_mul_f32 v17, v203, v141
    v_fma_f32 v141, v202, v141, -v16
    v_fma_f32 v157, v202, v157, v17
    v_mul_f32 v18, v207, v189
    v_mul_f32 v19, v207, v173
    v_fma_f32 v173, v206, v173, -v18
    v_fma_f32 v189, v206, v189, v19
    v_mul_f32 v16, v203, v158
    v_mul_f32 v17, v203, v142
    v_fma_f32 v142, v202, v142, -v16
    v_fma_f32 v158, v202, v158, v17
    v_mul_f32 v18, v207, v190
    v_mul_f32 v19, v207, v174
    v_fma_f32 v174, v206, v174, -v18
    v_fma_f32 v190, v206, v190, v19
    v_mul_f32 v16, v203, v159
    v_mul_f32 v17, v203, v143
    v_fma_f32 v143, v202, v143, -v16
    v_fma_f32 v159, v202, v159, v17
    v_mul_f32 v18, v207, v191
    v_mul_f32 v19, v207, v175
    v_fma_f32 v175, v206, v175, -v18
    v_fma_f32 v191, v206, v191, v19
    v_mov_b32 v24, v128
    v_mov_b32 v25, v144
    v_mov_b32 v26, v160
    v_mov_b32 v27, v176
    v_fma_f32 v28, v200, v24, v129
    v_fma_f32 v29, v200, v25, v145
    v_fma_f32 v30, v204, v26, v161
    v_fma_f32 v31, v204, v27, v177
    v_fma_f32 v20, -v201, v25, v28
    v_fma_f32 v21, v201, v24, v29
    v_fma_f32 v22, -v205, v27, v30
    v_fma_f32 v23, v205, v26, v31
    v_fma_f32 v28, v200, v20, v130
    v_fma_f32 v29, v200, v21, v146
    v_fma_f32 v30, v204, v22, v162
    v_fma_f32 v31, v204, v23, v178
    v_fma_f32 v24, -v201, v21, v28
    v_fma_f32 v25, v201, v20, v29
    v_fma_f32 v26, -v205, v23, v30
    v_fma_f32 v27, v205, v22, v31
    v_fma_f32 v28, v200, v24, v131
    v_fma_f32 v29, v200, v25, v147
    v_fma_f32 v30, v204, v26, v163
    v_fma_f32 v31, v204, v27, v179
    v_fma_f32 v20, -v201, v25, v28
    v_fma_f32 v21, v201, v24, v29
    v_fma_f32 v22, -v205, v27, v30
    v_fma_f32 v23, v205, v26, v31
    v_fma_f32 v28, v200, v20, v132
    v_fma_f32 v29, v200, v21, v148
    v_fma_f32 v30, v204, v22, v164
    v_fma_f32 v31, v204, v23, v180
    v_fma_f32 v24, -v201, v21, v28
    v_fma_f32 v25, v201, v20, v29
    v_fma_f32 v26, -v205, v23, v30
    v_fma_f32 v27, v205, v22, v31
    v_fma_f32 v28, v200, v24, v133
    v_fma_f32 v29, v200, v25, v149
    v_fma_f32 v30, v204, v26, v165
    v_fma_f32 v31, v204, v27, v181
    v_fma_f32 v20, -v201, v25, v28
    v_fma_f32 v21, v201, v24, v29
    v_fma_f32 v22, -v205, v27, v30
    v_fma_f32 v23, v205, v26, v31
    v_fma_f32 v28, v200, v20, v134
    v_fma_f32 v29, v200, v21, v150
    v_fma_f32 v30, v204, v22, v166
    v_fma_f32 v31, v204, v23, v182
    v_fma_f32 v24, -v201, v21, v28
    v_fma_f32 v25, v201, v20, v29
    v_fma_f32 v26, -v205, v23, v30
    v_fma_f32 v27, v205, v22, v31
    v_fma_f32 v28, v200, v24, v135
    v_fma_f32 v29, v200, v25, v151
    v_fma_f32 v30, v204, v26, v167
    v_fma_f32 v31, v204, v27, v183
    v_fma_f32 v20, -v201, v25, v28
    v_fma_f32 v21, v201, v24, v29
    v_fma_f32 v22, -v205, v27, v30
    v_fma_f32 v23, v205, v26, v31
    v_fma_f32 v28, v200, v20, v136
    v_fma_f32 v29, v200, v21, v152
    v_fma_f32 v30, v204, v22, v168
    v_fma_f32 v31, v204, v23, v184
    v_fma_f32 v24, -v201, v21, v28
    v_fma_f32 v25, v201, v20, v29
    v_fma_f32 v26, -v205, v23, v30
    v_fma_f32 v27, v205, v22, v31
    v_fma_f32 v28, v200, v24, v137
    v_fma_f32 v29, v200, v25, v153
    v_fma_f32 v30, v204, v26, v169
    v_fma_f32 v31, v204, v27, v185
    v_fma_f32 v20, -v201, v25, v28
    v_fma_f32 v21, v201, v24, v29
    v_fma_f32 v22, -v205, v27, v30
    v_fma_f32 v23, v205, v26, v31
    v_fma_f32 v28, v200, v20, v138
    v_fma_f32 v29, v200, v21, v154
    v_fma_f32 v30, v204, v22, v170
    v_fma_f32 v31, v204, v23, v186
    v_fma_f32 v24, -v201, v21, v28
    v_fma_f32 v25, v201, v20, v29
    v_fma_f32 v26, -v205, v23, v30
    v_fma_f32 v27, v205, v22, v31
    v_fma_f32 v28, v200, v24, v139
    v_fma_f32 v29, v200, v25, v155
    v_fma_f32 v30, v204, v26, v171
    v_fma_f32 v31, v204, v27, v187
    v_fma_f32 v20, -v201, v25, v28
    v_fma_f32 v21, v201, v24, v29
    v_fma_f32 v22, -v205, v27, v30
    v_fma_f32 v23, v205, v26, v31
    v_fma_f32 v28, v200, v20, v140
    v_fma_f32 v29, v200, v21, v156
    v_fma_f32 v30, v204, v22, v172
    v_fma_f32 v31, v204, v23, v188
    v_fma_f32 v24, -v201, v21, v28
    v_fma_f32 v25, v201, v20, v29
    v_fma_f32 v26, -v205, v23, v30
    v_fma_f32 v27, v205, v22, v31
    v_fma_f32 v28, v200, v24, v141
    v_fma_f32 v29, v200, v25, v157
    v_fma_f32 v30, v204, v26, v173
    v_fma_f32 v31, v204, v27, v189
    v_fma_f32 v20, -v201, v25, v28
    v_fma_f32 v21, v201, v24, v29
    v_fma_f32 v22, -v205, v27, v30
    v_fma_f32 v23, v205, v26, v31
    v_fma_f32 v28, v200, v20, v142
    v_fma_f32 v29, v200, v21, v158
    v_fma_f32 v30, v204, v22, v174
    v_fma_f32 v31, v204, v23, v190
    v_fma_f32 v24, -v201, v21, v28
    v_fma_f32 v25, v201, v20, v29
    v_fma_f32 v26, -v205, v23, v30
    v_fma_f32 v27, v205, v22, v31
    v_fma_f32 v28, v200, v24, v143
    v_fma_f32 v29, v200, v25, v159
    v_fma_f32 v30, v204, v26, v175
    v_fma_f32 v31, v204, v27, v191
    v_fma_f32 v20, -v201, v25, v28
    v_fma_f32 v21, v201, v24, v29
    v_fma_f32 v22, -v205, v27, v30
    v_fma_f32 v23, v205, v26, v31
    s_barrier
    s_lshl_b32 s63, s34, 11
    s_lshl_b32 s66, s60, 9
    s_add_u32 s63, s63, s66
    v_lshlrev_b32 v9, 7, v7
    buffer_load_dwordx4 v[80:83], v9, s[68:71], s63 offen offset:0
    buffer_load_dwordx4 v[84:87], v9, s[68:71], s63 offen offset:16
    buffer_load_dwordx4 v[88:91], v9, s[68:71], s63 offen offset:32
    buffer_load_dwordx4 v[92:95], v9, s[68:71], s63 offen offset:48
    s_lshl_b32 s63, s60, 11
    s_lshl_b32 s66, s61, 8
    s_add_u32 s63, s63, s66
    v_lshlrev_b32 v9, 9, v7
    v_lshl_add_u32 v9, v6, 4, v9
    v_add_u32 v9, s63, v9
    ds_write_b128 v9, v[20:23]
    s_waitcnt lgkmcnt(0)
    s_barrier
    s_cmp_lg_u32 s32, 0
    s_cbranch_scc1 ssm_wait
    v_lshlrev_b32 v10, 3, v2
    ds_read_b64 v[32:33], v10 offset:0
    ds_read_b64 v[34:35], v10 offset:512
    ds_read_b64 v[36:37], v10 offset:1024
    ds_read_b64 v[38:39], v10 offset:1536
    ds_read_b64 v[40:41], v10 offset:2048
    ds_read_b64 v[42:43], v10 offset:2560
    ds_read_b64 v[44:45], v10 offset:3072
    ds_read_b64 v[46:47], v10 offset:3584
    ds_read_b64 v[48:49], v10 offset:4096
    ds_read_b64 v[50:51], v10 offset:4608
    ds_read_b64 v[52:53], v10 offset:5120
    ds_read_b64 v[54:55], v10 offset:5632
    ds_read_b64 v[56:57], v10 offset:6144
    ds_read_b64 v[58:59], v10 offset:6656
    ds_read_b64 v[60:61], v10 offset:7168
    ds_read_b64 v[62:63], v10 offset:7680
    s_add_u32 s68, s58, 5242880
    s_addc_u32 s69, s59, 0
    s_mov_b32 s70, 65536
    s_mov_b32 s71, 0x00020000
    s_mov_b32 s72, s56
    s_mov_b32 s73, s57
    s_mov_b32 s74, 256
    s_mov_b32 s75, 0x00020000
    s_waitcnt lgkmcnt(0)
    v_mov_b32 v24, v32
    v_mov_b32 v25, v33
    v_fma_f32 v28, v208, v24, v34
    v_fma_f32 v29, v208, v25, v35
    v_fma_f32 v28, -v209, v25, v28
    v_fma_f32 v25, v209, v24, v29
    v_mov_b32 v24, v28
    v_fma_f32 v28, v208, v24, v36
    v_fma_f32 v29, v208, v25, v37
    v_fma_f32 v28, -v209, v25, v28
    v_fma_f32 v25, v209, v24, v29
    v_mov_b32 v24, v28
    v_fma_f32 v28, v208, v24, v38
    v_fma_f32 v29, v208, v25, v39
    v_fma_f32 v28, -v209, v25, v28
    v_fma_f32 v25, v209, v24, v29
    v_mov_b32 v24, v28
    v_fma_f32 v28, v208, v24, v40
    v_fma_f32 v29, v208, v25, v41
    v_fma_f32 v28, -v209, v25, v28
    v_fma_f32 v25, v209, v24, v29
    v_mov_b32 v24, v28
    v_fma_f32 v28, v208, v24, v42
    v_fma_f32 v29, v208, v25, v43
    v_fma_f32 v28, -v209, v25, v28
    v_fma_f32 v25, v209, v24, v29
    v_mov_b32 v24, v28
    v_fma_f32 v28, v208, v24, v44
    v_fma_f32 v29, v208, v25, v45
    v_fma_f32 v28, -v209, v25, v28
    v_fma_f32 v25, v209, v24, v29
    v_mov_b32 v24, v28
    v_fma_f32 v28, v208, v24, v46
    v_fma_f32 v29, v208, v25, v47
    v_fma_f32 v28, -v209, v25, v28
    v_fma_f32 v25, v209, v24, v29
    v_mov_b32 v24, v28
    v_fma_f32 v28, v208, v24, v48
    v_fma_f32 v29, v208, v25, v49
    v_fma_f32 v28, -v209, v25, v28
    v_fma_f32 v25, v209, v24, v29
    v_mov_b32 v24, v28
    v_fma_f32 v28, v208, v24, v50
    v_fma_f32 v29, v208, v25, v51
    v_fma_f32 v28, -v209, v25, v28
    v_fma_f32 v25, v209, v24, v29
    v_mov_b32 v24, v28
    v_fma_f32 v28, v208, v24, v52
    v_fma_f32 v29, v208, v25, v53
    v_fma_f32 v28, -v209, v25, v28
    v_fma_f32 v25, v209, v24, v29
    v_mov_b32 v24, v28
    v_fma_f32 v28, v208, v24, v54
    v_fma_f32 v29, v208, v25, v55
    v_fma_f32 v28, -v209, v25, v28
    v_fma_f32 v25, v209, v24, v29
    v_mov_b32 v24, v28
    v_fma_f32 v28, v208, v24, v56
    v_fma_f32 v29, v208, v25, v57
    v_fma_f32 v28, -v209, v25, v28
    v_fma_f32 v25, v209, v24, v29
    v_mov_b32 v24, v28
    v_fma_f32 v28, v208, v24, v58
    v_fma_f32 v29, v208, v25, v59
    v_fma_f32 v28, -v209, v25, v28
    v_fma_f32 v25, v209, v24, v29
    v_mov_b32 v24, v28
    v_fma_f32 v28, v208, v24, v60
    v_fma_f32 v29, v208, v25, v61
    v_fma_f32 v28, -v209, v25, v28
    v_fma_f32 v25, v209, v24, v29
    v_mov_b32 v24, v28
    v_fma_f32 v28, v208, v24, v62
    v_fma_f32 v29, v208, v25, v63
    v_fma_f32 v28, -v209, v25, v28
    v_fma_f32 v25, v209, v24, v29
    v_mov_b32 v24, v28
    s_lshl_b32 s63, s34, 13
    s_lshl_b32 s66, s35, 9
    s_add_u32 s63, s63, s66
    buffer_store_dwordx2 v[24:25], v10, s[68:71], s63 offen sc0 sc1
    v_mov_b32 v24, 0
    v_mov_b32 v25, 0
    s_cmp_eq_u32 s34, 0
    s_cbranch_scc1 ssm_nolook
    v_mov_b32 v64, 0
    v_mov_b32 v65, 0
    v_mov_b32 v66, 0
    v_mov_b32 v67, 0
    v_mov_b32 v68, 0
    v_mov_b32 v69, 0
    v_mov_b32 v70, 0
    v_mov_b32 v71, 0
    v_mov_b32 v72, 0
    v_mov_b32 v73, 0
    v_mov_b32 v74, 0
    v_mov_b32 v75, 0
    v_mov_b32 v76, 0
    v_mov_b32 v77, 0
    s_mov_b32 s81, 0x40000
ssm_poll:
    s_add_u32 s84, s66, 0
    buffer_load_dwordx2 v[64:65], v10, s[68:71], s84 offen sc0 sc1
    s_cmp_le_u32 s34, 1
    s_cbranch_scc1 ssm_loaded
    s_add_u32 s84, s66, 8192
    buffer_load_dwordx2 v[66:67], v10, s[68:71], s84 offen sc0 sc1
    s_cmp_le_u32 s34, 2
    s_cbranch_scc1 ssm_loaded
    s_add_u32 s84, s66, 16384
    buffer_load_dwordx2 v[68:69], v10, s[68:71], s84 offen sc0 sc1
    s_cmp_le_u32 s34, 3
    s_cbranch_scc1 ssm_loaded
    s_add_u32 s84, s66, 24576
    buffer_load_dwordx2 v[70:71], v10, s[68:71], s84 offen sc0 sc1
    s_cmp_le_u32 s34, 4
    s_cbranch_scc1 ssm_loaded
    s_add_u32 s84, s66, 32768
    buffer_load_dwordx2 v[72:73], v10, s[68:71], s84 offen sc0 sc1
    s_cmp_le_u32 s34, 5
    s_cbranch_scc1 ssm_loaded
    s_add_u32 s84, s66, 40960
    buffer_load_dwordx2 v[74:75], v10, s[68:71], s84 offen sc0 sc1
    s_cmp_le_u32 s34, 6
    s_cbranch_scc1 ssm_loaded
    s_add_u32 s84, s66, 49152
    buffer_load_dwordx2 v[76:77], v10, s[68:71], s84 offen sc0 sc1
ssm_loaded:
    s_waitcnt vmcnt(0)
    v_max_u32 v11, v64, v65
    v_max3_u32 v11, v11, v66, v67
    v_max3_u32 v11, v11, v68, v69
    v_max3_u32 v11, v11, v70, v71
    v_max3_u32 v11, v11, v72, v73
    v_max3_u32 v11, v11, v74, v75
    v_max3_u32 v11, v11, v76, v77
    v_cmp_eq_u32 vcc, -1, v11
    s_cmp_eq_u64 vcc, 0
    s_cbranch_scc1 ssm_ready
    s_sleep 4
    s_sub_u32 s81, s81, 1
    s_cmp_lg_u32 s81, 0
    s_cbranch_scc1 ssm_poll
ssm_ready:
    s_cmp_le_u32 s34, 0
    s_cbranch_scc1 ssm_nolook
    v_fma_f32 v28, v210, v24, v64
    v_fma_f32 v29, v210, v25, v65
    v_fma_f32 v28, -v211, v25, v28
    v_fma_f32 v25, v211, v24, v29
    v_mov_b32 v24, v28
    s_cmp_le_u32 s34, 1
    s_cbranch_scc1 ssm_nolook
    v_fma_f32 v28, v210, v24, v66
    v_fma_f32 v29, v210, v25, v67
    v_fma_f32 v28, -v211, v25, v28
    v_fma_f32 v25, v211, v24, v29
    v_mov_b32 v24, v28
    s_cmp_le_u32 s34, 2
    s_cbranch_scc1 ssm_nolook
    v_fma_f32 v28, v210, v24, v68
    v_fma_f32 v29, v210, v25, v69
    v_fma_f32 v28, -v211, v25, v28
    v_fma_f32 v25, v211, v24, v29
    v_mov_b32 v24, v28
    s_cmp_le_u32 s34, 3
    s_cbranch_scc1 ssm_nolook
    v_fma_f32 v28, v210, v24, v70
    v_fma_f32 v29, v210, v25, v71
    v_fma_f32 v28, -v211, v25, v28
    v_fma_f32 v25, v211, v24, v29
    v_mov_b32 v24, v28
    s_cmp_le_u32 s34, 4
    s_cbranch_scc1 ssm_nolook
    v_fma_f32 v28, v210, v24, v72
    v_fma_f32 v29, v210, v25, v73
    v_fma_f32 v28, -v211, v25, v28
    v_fma_f32 v25, v211, v24, v29
    v_mov_b32 v24, v28
    s_cmp_le_u32 s34, 5
    s_cbranch_scc1 ssm_nolook
    v_fma_f32 v28, v210, v24, v74
    v_fma_f32 v29, v210, v25, v75
    v_fma_f32 v28, -v211, v25, v28
    v_fma_f32 v25, v211, v24, v29
    v_mov_b32 v24, v28
    s_cmp_le_u32 s34, 6
    s_cbranch_scc1 ssm_nolook
    v_fma_f32 v28, v210, v24, v76
    v_fma_f32 v29, v210, v25, v77
    v_fma_f32 v28, -v211, v25, v28
    v_fma_f32 v25, v211, v24, v29
    v_mov_b32 v24, v28
ssm_nolook:
    ds_write_b64 v10, v[24:25] offset:8192
    v_fma_f32 v28, v208, v24, v32
    v_fma_f32 v29, v208, v25, v33
    v_fma_f32 v28, -v209, v25, v28
    v_fma_f32 v25, v209, v24, v29
    v_mov_b32 v24, v28
    ds_write_b64 v10, v[24:25] offset:8704
    v_fma_f32 v28, v208, v24, v34
    v_fma_f32 v29, v208, v25, v35
    v_fma_f32 v28, -v209, v25, v28
    v_fma_f32 v25, v209, v24, v29
    v_mov_b32 v24, v28
    ds_write_b64 v10, v[24:25] offset:9216
    v_fma_f32 v28, v208, v24, v36
    v_fma_f32 v29, v208, v25, v37
    v_fma_f32 v28, -v209, v25, v28
    v_fma_f32 v25, v209, v24, v29
    v_mov_b32 v24, v28
    ds_write_b64 v10, v[24:25] offset:9728
    v_fma_f32 v28, v208, v24, v38
    v_fma_f32 v29, v208, v25, v39
    v_fma_f32 v28, -v209, v25, v28
    v_fma_f32 v25, v209, v24, v29
    v_mov_b32 v24, v28
    ds_write_b64 v10, v[24:25] offset:10240
    v_fma_f32 v28, v208, v24, v40
    v_fma_f32 v29, v208, v25, v41
    v_fma_f32 v28, -v209, v25, v28
    v_fma_f32 v25, v209, v24, v29
    v_mov_b32 v24, v28
    ds_write_b64 v10, v[24:25] offset:10752
    v_fma_f32 v28, v208, v24, v42
    v_fma_f32 v29, v208, v25, v43
    v_fma_f32 v28, -v209, v25, v28
    v_fma_f32 v25, v209, v24, v29
    v_mov_b32 v24, v28
    ds_write_b64 v10, v[24:25] offset:11264
    v_fma_f32 v28, v208, v24, v44
    v_fma_f32 v29, v208, v25, v45
    v_fma_f32 v28, -v209, v25, v28
    v_fma_f32 v25, v209, v24, v29
    v_mov_b32 v24, v28
    ds_write_b64 v10, v[24:25] offset:11776
    v_fma_f32 v28, v208, v24, v46
    v_fma_f32 v29, v208, v25, v47
    v_fma_f32 v28, -v209, v25, v28
    v_fma_f32 v25, v209, v24, v29
    v_mov_b32 v24, v28
    ds_write_b64 v10, v[24:25] offset:12288
    v_fma_f32 v28, v208, v24, v48
    v_fma_f32 v29, v208, v25, v49
    v_fma_f32 v28, -v209, v25, v28
    v_fma_f32 v25, v209, v24, v29
    v_mov_b32 v24, v28
    ds_write_b64 v10, v[24:25] offset:12800
    v_fma_f32 v28, v208, v24, v50
    v_fma_f32 v29, v208, v25, v51
    v_fma_f32 v28, -v209, v25, v28
    v_fma_f32 v25, v209, v24, v29
    v_mov_b32 v24, v28
    ds_write_b64 v10, v[24:25] offset:13312
    v_fma_f32 v28, v208, v24, v52
    v_fma_f32 v29, v208, v25, v53
    v_fma_f32 v28, -v209, v25, v28
    v_fma_f32 v25, v209, v24, v29
    v_mov_b32 v24, v28
    ds_write_b64 v10, v[24:25] offset:13824
    v_fma_f32 v28, v208, v24, v54
    v_fma_f32 v29, v208, v25, v55
    v_fma_f32 v28, -v209, v25, v28
    v_fma_f32 v25, v209, v24, v29
    v_mov_b32 v24, v28
    ds_write_b64 v10, v[24:25] offset:14336
    v_fma_f32 v28, v208, v24, v56
    v_fma_f32 v29, v208, v25, v57
    v_fma_f32 v28, -v209, v25, v28
    v_fma_f32 v25, v209, v24, v29
    v_mov_b32 v24, v28
    ds_write_b64 v10, v[24:25] offset:14848
    v_fma_f32 v28, v208, v24, v58
    v_fma_f32 v29, v208, v25, v59
    v_fma_f32 v28, -v209, v25, v28
    v_fma_f32 v25, v209, v24, v29
    v_mov_b32 v24, v28
    ds_write_b64 v10, v[24:25] offset:15360
    v_fma_f32 v28, v208, v24, v60
    v_fma_f32 v29, v208, v25, v61
    v_fma_f32 v28, -v209, v25, v28
    v_fma_f32 v25, v209, v24, v29
    v_mov_b32 v24, v28
    ds_write_b64 v10, v[24:25] offset:15872
    s_waitcnt lgkmcnt(0)
ssm_wait:
    s_barrier
    ds_read_b128 v[20:23], v9 offset:8192
    s_mov_b32 s63, 180224
    v_mul_lo_u32 v10, v7, s63
    v_lshl_add_u32 v10, v6, 2, v10
    s_lshl_b32 s66, s34, 8
    s_lshl_b32 s67, s60, 6
    s_add_u32 s66, s66, s67
    s_mul_i32 s66, s66, 11264
    s_lshl_b32 s67, s61, 6
    s_add_u32 s66, s66, s67
    s_lshl_b32 s67, s64, 1
    s_add_u32 s66, s66, s67
    s_add_u32 s66, s66, 7168
    s_waitcnt lgkmcnt(0)
    s_waitcnt vmcnt(0)
    v_add_f32 v80, v80, v80
    v_add_f32 v81, v81, v81
    v_add_f32 v82, v82, v82
    v_add_f32 v83, v83, v83
    v_add_f32 v84, v84, v84
    v_add_f32 v85, v85, v85
    v_add_f32 v86, v86, v86
    v_add_f32 v87, v87, v87
    v_add_f32 v88, v88, v88
    v_add_f32 v89, v89, v89
    v_add_f32 v90, v90, v90
    v_add_f32 v91, v91, v91
    v_add_f32 v92, v92, v92
    v_add_f32 v93, v93, v93
    v_add_f32 v94, v94, v94
    v_add_f32 v95, v95, v95
    v_fma_f32 v28, v200, v20, v128
    v_fma_f32 v29, v200, v21, v144
    v_fma_f32 v30, v204, v22, v160
    v_fma_f32 v31, v204, v23, v176
    v_fma_f32 v24, -v201, v21, v28
    v_fma_f32 v25, v201, v20, v29
    v_fma_f32 v26, -v205, v23, v30
    v_fma_f32 v27, v205, v22, v31
    v_mul_f32 v96, v80, v24
    v_mul_f32 v97, v80, v25
    v_mul_f32 v98, v80, v26
    v_mul_f32 v99, v80, v27
    v_cvt_pk_bf16_f32 v32, v96, v98
    v_cvt_pk_bf16_f32 v33, -v97, -v99
    buffer_store_dword v32, v10, s[12:15], s66 offen sc1
    buffer_store_dword v33, v10, s[12:15], s66 offen offset:2048 sc1
    s_add_u32 s66, s66, 11264
    v_fma_f32 v28, v200, v24, v129
    v_fma_f32 v29, v200, v25, v145
    v_fma_f32 v30, v204, v26, v161
    v_fma_f32 v31, v204, v27, v177
    v_fma_f32 v20, -v201, v25, v28
    v_fma_f32 v21, v201, v24, v29
    v_fma_f32 v22, -v205, v27, v30
    v_fma_f32 v23, v205, v26, v31
    v_mul_f32 v96, v81, v20
    v_mul_f32 v97, v81, v21
    v_mul_f32 v98, v81, v22
    v_mul_f32 v99, v81, v23
    v_cvt_pk_bf16_f32 v34, v96, v98
    v_cvt_pk_bf16_f32 v35, -v97, -v99
    buffer_store_dword v34, v10, s[12:15], s66 offen sc1
    buffer_store_dword v35, v10, s[12:15], s66 offen offset:2048 sc1
    s_add_u32 s66, s66, 11264
    v_fma_f32 v28, v200, v20, v130
    v_fma_f32 v29, v200, v21, v146
    v_fma_f32 v30, v204, v22, v162
    v_fma_f32 v31, v204, v23, v178
    v_fma_f32 v24, -v201, v21, v28
    v_fma_f32 v25, v201, v20, v29
    v_fma_f32 v26, -v205, v23, v30
    v_fma_f32 v27, v205, v22, v31
    v_mul_f32 v96, v82, v24
    v_mul_f32 v97, v82, v25
    v_mul_f32 v98, v82, v26
    v_mul_f32 v99, v82, v27
    v_cvt_pk_bf16_f32 v36, v96, v98
    v_cvt_pk_bf16_f32 v37, -v97, -v99
    buffer_store_dword v36, v10, s[12:15], s66 offen sc1
    buffer_store_dword v37, v10, s[12:15], s66 offen offset:2048 sc1
    s_add_u32 s66, s66, 11264
    v_fma_f32 v28, v200, v24, v131
    v_fma_f32 v29, v200, v25, v147
    v_fma_f32 v30, v204, v26, v163
    v_fma_f32 v31, v204, v27, v179
    v_fma_f32 v20, -v201, v25, v28
    v_fma_f32 v21, v201, v24, v29
    v_fma_f32 v22, -v205, v27, v30
    v_fma_f32 v23, v205, v26, v31
    v_mul_f32 v96, v83, v20
    v_mul_f32 v97, v83, v21
    v_mul_f32 v98, v83, v22
    v_mul_f32 v99, v83, v23
    v_cvt_pk_bf16_f32 v38, v96, v98
    v_cvt_pk_bf16_f32 v39, -v97, -v99
    buffer_store_dword v38, v10, s[12:15], s66 offen sc1
    buffer_store_dword v39, v10, s[12:15], s66 offen offset:2048 sc1
    s_add_u32 s66, s66, 11264
    v_fma_f32 v28, v200, v20, v132
    v_fma_f32 v29, v200, v21, v148
    v_fma_f32 v30, v204, v22, v164
    v_fma_f32 v31, v204, v23, v180
    v_fma_f32 v24, -v201, v21, v28
    v_fma_f32 v25, v201, v20, v29
    v_fma_f32 v26, -v205, v23, v30
    v_fma_f32 v27, v205, v22, v31
    v_mul_f32 v96, v84, v24
    v_mul_f32 v97, v84, v25
    v_mul_f32 v98, v84, v26
    v_mul_f32 v99, v84, v27
    v_cvt_pk_bf16_f32 v40, v96, v98
    v_cvt_pk_bf16_f32 v41, -v97, -v99
    buffer_store_dword v40, v10, s[12:15], s66 offen sc1
    buffer_store_dword v41, v10, s[12:15], s66 offen offset:2048 sc1
    s_add_u32 s66, s66, 11264
    v_fma_f32 v28, v200, v24, v133
    v_fma_f32 v29, v200, v25, v149
    v_fma_f32 v30, v204, v26, v165
    v_fma_f32 v31, v204, v27, v181
    v_fma_f32 v20, -v201, v25, v28
    v_fma_f32 v21, v201, v24, v29
    v_fma_f32 v22, -v205, v27, v30
    v_fma_f32 v23, v205, v26, v31
    v_mul_f32 v96, v85, v20
    v_mul_f32 v97, v85, v21
    v_mul_f32 v98, v85, v22
    v_mul_f32 v99, v85, v23
    v_cvt_pk_bf16_f32 v42, v96, v98
    v_cvt_pk_bf16_f32 v43, -v97, -v99
    buffer_store_dword v42, v10, s[12:15], s66 offen sc1
    buffer_store_dword v43, v10, s[12:15], s66 offen offset:2048 sc1
    s_add_u32 s66, s66, 11264
    v_fma_f32 v28, v200, v20, v134
    v_fma_f32 v29, v200, v21, v150
    v_fma_f32 v30, v204, v22, v166
    v_fma_f32 v31, v204, v23, v182
    v_fma_f32 v24, -v201, v21, v28
    v_fma_f32 v25, v201, v20, v29
    v_fma_f32 v26, -v205, v23, v30
    v_fma_f32 v27, v205, v22, v31
    v_mul_f32 v96, v86, v24
    v_mul_f32 v97, v86, v25
    v_mul_f32 v98, v86, v26
    v_mul_f32 v99, v86, v27
    v_cvt_pk_bf16_f32 v44, v96, v98
    v_cvt_pk_bf16_f32 v45, -v97, -v99
    buffer_store_dword v44, v10, s[12:15], s66 offen sc1
    buffer_store_dword v45, v10, s[12:15], s66 offen offset:2048 sc1
    s_add_u32 s66, s66, 11264
    v_fma_f32 v28, v200, v24, v135
    v_fma_f32 v29, v200, v25, v151
    v_fma_f32 v30, v204, v26, v167
    v_fma_f32 v31, v204, v27, v183
    v_fma_f32 v20, -v201, v25, v28
    v_fma_f32 v21, v201, v24, v29
    v_fma_f32 v22, -v205, v27, v30
    v_fma_f32 v23, v205, v26, v31
    v_mul_f32 v96, v87, v20
    v_mul_f32 v97, v87, v21
    v_mul_f32 v98, v87, v22
    v_mul_f32 v99, v87, v23
    v_cvt_pk_bf16_f32 v46, v96, v98
    v_cvt_pk_bf16_f32 v47, -v97, -v99
    buffer_store_dword v46, v10, s[12:15], s66 offen sc1
    buffer_store_dword v47, v10, s[12:15], s66 offen offset:2048 sc1
    s_add_u32 s66, s66, 11264
    v_fma_f32 v28, v200, v20, v136
    v_fma_f32 v29, v200, v21, v152
    v_fma_f32 v30, v204, v22, v168
    v_fma_f32 v31, v204, v23, v184
    v_fma_f32 v24, -v201, v21, v28
    v_fma_f32 v25, v201, v20, v29
    v_fma_f32 v26, -v205, v23, v30
    v_fma_f32 v27, v205, v22, v31
    v_mul_f32 v96, v88, v24
    v_mul_f32 v97, v88, v25
    v_mul_f32 v98, v88, v26
    v_mul_f32 v99, v88, v27
    v_cvt_pk_bf16_f32 v32, v96, v98
    v_cvt_pk_bf16_f32 v33, -v97, -v99
    buffer_store_dword v32, v10, s[12:15], s66 offen sc1
    buffer_store_dword v33, v10, s[12:15], s66 offen offset:2048 sc1
    s_add_u32 s66, s66, 11264
    v_fma_f32 v28, v200, v24, v137
    v_fma_f32 v29, v200, v25, v153
    v_fma_f32 v30, v204, v26, v169
    v_fma_f32 v31, v204, v27, v185
    v_fma_f32 v20, -v201, v25, v28
    v_fma_f32 v21, v201, v24, v29
    v_fma_f32 v22, -v205, v27, v30
    v_fma_f32 v23, v205, v26, v31
    v_mul_f32 v96, v89, v20
    v_mul_f32 v97, v89, v21
    v_mul_f32 v98, v89, v22
    v_mul_f32 v99, v89, v23
    v_cvt_pk_bf16_f32 v34, v96, v98
    v_cvt_pk_bf16_f32 v35, -v97, -v99
    buffer_store_dword v34, v10, s[12:15], s66 offen sc1
    buffer_store_dword v35, v10, s[12:15], s66 offen offset:2048 sc1
    s_add_u32 s66, s66, 11264
    v_fma_f32 v28, v200, v20, v138
    v_fma_f32 v29, v200, v21, v154
    v_fma_f32 v30, v204, v22, v170
    v_fma_f32 v31, v204, v23, v186
    v_fma_f32 v24, -v201, v21, v28
    v_fma_f32 v25, v201, v20, v29
    v_fma_f32 v26, -v205, v23, v30
    v_fma_f32 v27, v205, v22, v31
    v_mul_f32 v96, v90, v24
    v_mul_f32 v97, v90, v25
    v_mul_f32 v98, v90, v26
    v_mul_f32 v99, v90, v27
    v_cvt_pk_bf16_f32 v36, v96, v98
    v_cvt_pk_bf16_f32 v37, -v97, -v99
    buffer_store_dword v36, v10, s[12:15], s66 offen sc1
    buffer_store_dword v37, v10, s[12:15], s66 offen offset:2048 sc1
    s_add_u32 s66, s66, 11264
    v_fma_f32 v28, v200, v24, v139
    v_fma_f32 v29, v200, v25, v155
    v_fma_f32 v30, v204, v26, v171
    v_fma_f32 v31, v204, v27, v187
    v_fma_f32 v20, -v201, v25, v28
    v_fma_f32 v21, v201, v24, v29
    v_fma_f32 v22, -v205, v27, v30
    v_fma_f32 v23, v205, v26, v31
    v_mul_f32 v96, v91, v20
    v_mul_f32 v97, v91, v21
    v_mul_f32 v98, v91, v22
    v_mul_f32 v99, v91, v23
    v_cvt_pk_bf16_f32 v38, v96, v98
    v_cvt_pk_bf16_f32 v39, -v97, -v99
    buffer_store_dword v38, v10, s[12:15], s66 offen sc1
    buffer_store_dword v39, v10, s[12:15], s66 offen offset:2048 sc1
    s_add_u32 s66, s66, 11264
    v_fma_f32 v28, v200, v20, v140
    v_fma_f32 v29, v200, v21, v156
    v_fma_f32 v30, v204, v22, v172
    v_fma_f32 v31, v204, v23, v188
    v_fma_f32 v24, -v201, v21, v28
    v_fma_f32 v25, v201, v20, v29
    v_fma_f32 v26, -v205, v23, v30
    v_fma_f32 v27, v205, v22, v31
    v_mul_f32 v96, v92, v24
    v_mul_f32 v97, v92, v25
    v_mul_f32 v98, v92, v26
    v_mul_f32 v99, v92, v27
    v_cvt_pk_bf16_f32 v40, v96, v98
    v_cvt_pk_bf16_f32 v41, -v97, -v99
    buffer_store_dword v40, v10, s[12:15], s66 offen sc1
    buffer_store_dword v41, v10, s[12:15], s66 offen offset:2048 sc1
    s_add_u32 s66, s66, 11264
    v_fma_f32 v28, v200, v24, v141
    v_fma_f32 v29, v200, v25, v157
    v_fma_f32 v30, v204, v26, v173
    v_fma_f32 v31, v204, v27, v189
    v_fma_f32 v20, -v201, v25, v28
    v_fma_f32 v21, v201, v24, v29
    v_fma_f32 v22, -v205, v27, v30
    v_fma_f32 v23, v205, v26, v31
    v_mul_f32 v96, v93, v20
    v_mul_f32 v97, v93, v21
    v_mul_f32 v98, v93, v22
    v_mul_f32 v99, v93, v23
    v_cvt_pk_bf16_f32 v42, v96, v98
    v_cvt_pk_bf16_f32 v43, -v97, -v99
    buffer_store_dword v42, v10, s[12:15], s66 offen sc1
    buffer_store_dword v43, v10, s[12:15], s66 offen offset:2048 sc1
    s_add_u32 s66, s66, 11264
    v_fma_f32 v28, v200, v20, v142
    v_fma_f32 v29, v200, v21, v158
    v_fma_f32 v30, v204, v22, v174
    v_fma_f32 v31, v204, v23, v190
    v_fma_f32 v24, -v201, v21, v28
    v_fma_f32 v25, v201, v20, v29
    v_fma_f32 v26, -v205, v23, v30
    v_fma_f32 v27, v205, v22, v31
    v_mul_f32 v96, v94, v24
    v_mul_f32 v97, v94, v25
    v_mul_f32 v98, v94, v26
    v_mul_f32 v99, v94, v27
    v_cvt_pk_bf16_f32 v44, v96, v98
    v_cvt_pk_bf16_f32 v45, -v97, -v99
    buffer_store_dword v44, v10, s[12:15], s66 offen sc1
    buffer_store_dword v45, v10, s[12:15], s66 offen offset:2048 sc1
    s_add_u32 s66, s66, 11264
    v_fma_f32 v28, v200, v24, v143
    v_fma_f32 v29, v200, v25, v159
    v_fma_f32 v30, v204, v26, v175
    v_fma_f32 v31, v204, v27, v191
    v_fma_f32 v20, -v201, v25, v28
    v_fma_f32 v21, v201, v24, v29
    v_fma_f32 v22, -v205, v27, v30
    v_fma_f32 v23, v205, v26, v31
    v_mul_f32 v96, v95, v20
    v_mul_f32 v97, v95, v21
    v_mul_f32 v98, v95, v22
    v_mul_f32 v99, v95, v23
    v_cvt_pk_bf16_f32 v46, v96, v98
    v_cvt_pk_bf16_f32 v47, -v97, -v99
    buffer_store_dword v46, v10, s[12:15], s66 offen sc1
    buffer_store_dword v47, v10, s[12:15], s66 offen offset:2048 sc1
    s_mov_b32 s25, 0
    s_branch s2_entry
s1_done:
    s_endpgm
s2_entry:
    s_load_dwordx2 s[36:37], s[0:1], 0
    s_load_dwordx4 s[40:43], s[0:1], 40
    s_load_dwordx2 s[44:45], s[0:1], 64
    s_load_dwordx4 s[48:51], s[0:1], 96
    s_load_dwordx2 s[52:53], s[0:1], 120
    v_and_b32 v2, 63, v0
    s_lshl_b32 s88, s34, 13
    s_lshl_b32 s63, s33, 6
    s_add_u32 s88, s88, s63
    s_lshl_b32 s63, s35, 2
    s_add_u32 s88, s88, s63
    s_and_b32 s35, s2, 2
    s_lshl_b32 s35, s35, 1
    s_bfe_u32 s3, s2, 0x20005
    s_add_u32 s35, s35, s3
    s_bfe_u32 s3, s2, 0x10002
    s_lshl_b32 s87, s33, 1
    s_add_u32 s87, s87, s3
    s_lshl_b32 s80, s34, 3
    s_add_u32 s80, s80, s35
    s_lshl_b32 s89, s80, 2
    s_add_u32 s89, s89, s87
    s_lshl_b32 s89, s89, 8
    s_cmp_eq_u32 s33, 0
    s_cselect_b32 s22, 13, 3
    s_cselect_b32 s23, 13, 15
    s_cselect_b32 s84, 0, 13
    s_cselect_b32 s85, 0, 26
    s_mul_i32 s63, s3, s23
    s_add_u32 s85, s85, s63
    s_add_u32 s72, s58, 4456448
    s_addc_u32 s73, s59, 0
    s_mov_b32 s74, 65536
    s_mov_b32 s75, 0x00020000
    s_add_u32 s68, s58, 67108864
    s_addc_u32 s69, s59, 0
    s_mov_b32 s70, 33554432
    s_mov_b32 s71, 0x00020000
    s_cmp_ge_u32 s32, 4
    s_cbranch_scc1 s2_loader
    v_and_b32 v6, 15, v2
    v_lshrrev_b32 v7, 4, v2
    v_lshrrev_b32 v8, 1, v6
    v_xor_b32 v8, v8, v7
    v_lshlrev_b32 v8, 4, v8
    v_lshl_add_u32 v8, v6, 7, v8
    s_lshr_b32 s60, s32, 1
    s_and_b32 s61, s32, 1
    s_lshl_b32 s63, s60, 14
    v_add_u32 v118, s63, v8
    v_xor_b32 v119, 64, v118
    s_lshl_b32 s63, s61, 13
    s_add_u32 s63, s63, 32768
    v_add_u32 v120, s63, v8
    v_xor_b32 v121, 64, v120
    v_lshrrev_b32 v9, 1, v7
    v_lshlrev_b32 v9, 12, v9
    v_and_b32 v10, 1, v7
    v_lshrrev_b32 v11, 2, v6
    v_lshl_add_u32 v11, v10, 3, v11
    v_lshl_add_u32 v9, v11, 6, v9
    v_and_b32 v11, 3, v6
    v_lshl_add_u32 v9, v11, 3, v9
    v_lshl_add_u32 v9, v10, 5, v9
    s_lshl_b32 s64, s61, 11
    s_add_u32 s63, s64, 32768
    v_add_u32 v122, s63, v9
    v_xor_b32 v123, 32, v122
    v_mov_b32 v112, v118
    v_mov_b32 v113, v119
    v_mov_b32 v114, v120
    v_mov_b32 v115, v121
    v_mov_b32 v116, v122
    v_mov_b32 v117, v123
    s_mov_b32 s28, 0
    v_mov_b32 v128, 0
    v_mov_b32 v129, 0
    v_mov_b32 v130, 0
    v_mov_b32 v131, 0
    v_mov_b32 v132, 0
    v_mov_b32 v133, 0
    v_mov_b32 v134, 0
    v_mov_b32 v135, 0
    v_mov_b32 v136, 0
    v_mov_b32 v137, 0
    v_mov_b32 v138, 0
    v_mov_b32 v139, 0
    v_mov_b32 v140, 0
    v_mov_b32 v141, 0
    v_mov_b32 v142, 0
    v_mov_b32 v143, 0
    v_mov_b32 v144, 0
    v_mov_b32 v145, 0
    v_mov_b32 v146, 0
    v_mov_b32 v147, 0
    v_mov_b32 v148, 0
    v_mov_b32 v149, 0
    v_mov_b32 v150, 0
    v_mov_b32 v151, 0
    v_mov_b32 v152, 0
    v_mov_b32 v153, 0
    v_mov_b32 v154, 0
    v_mov_b32 v155, 0
    v_mov_b32 v156, 0
    v_mov_b32 v157, 0
    v_mov_b32 v158, 0
    v_mov_b32 v159, 0
    v_mov_b32 v160, 0
    v_mov_b32 v161, 0
    v_mov_b32 v162, 0
    v_mov_b32 v163, 0
    v_mov_b32 v164, 0
    v_mov_b32 v165, 0
    v_mov_b32 v166, 0
    v_mov_b32 v167, 0
    v_mov_b32 v168, 0
    v_mov_b32 v169, 0
    v_mov_b32 v170, 0
    v_mov_b32 v171, 0
    v_mov_b32 v172, 0
    v_mov_b32 v173, 0
    v_mov_b32 v174, 0
    v_mov_b32 v175, 0
    v_mov_b32 v176, 0
    v_mov_b32 v177, 0
    v_mov_b32 v178, 0
    v_mov_b32 v179, 0
    v_mov_b32 v180, 0
    v_mov_b32 v181, 0
    v_mov_b32 v182, 0
    v_mov_b32 v183, 0
    v_mov_b32 v184, 0
    v_mov_b32 v185, 0
    v_mov_b32 v186, 0
    v_mov_b32 v187, 0
    v_mov_b32 v188, 0
    v_mov_b32 v189, 0
    v_mov_b32 v190, 0
    v_mov_b32 v191, 0
    v_mov_b32 v192, 0
    v_mov_b32 v193, 0
    v_mov_b32 v194, 0
    v_mov_b32 v195, 0
    v_mov_b32 v196, 0
    v_mov_b32 v197, 0
    v_mov_b32 v198, 0
    v_mov_b32 v199, 0
    v_mov_b32 v200, 0
    v_mov_b32 v201, 0
    v_mov_b32 v202, 0
    v_mov_b32 v203, 0
    v_mov_b32 v204, 0
    v_mov_b32 v205, 0
    v_mov_b32 v206, 0
    v_mov_b32 v207, 0
    v_mov_b32 v208, 0
    v_mov_b32 v209, 0
    v_mov_b32 v210, 0
    v_mov_b32 v211, 0
    v_mov_b32 v212, 0
    v_mov_b32 v213, 0
    v_mov_b32 v214, 0
    v_mov_b32 v215, 0
    v_mov_b32 v216, 0
    v_mov_b32 v217, 0
    v_mov_b32 v218, 0
    v_mov_b32 v219, 0
    v_mov_b32 v220, 0
    v_mov_b32 v221, 0
    v_mov_b32 v222, 0
    v_mov_b32 v223, 0
    v_mov_b32 v224, 0
    v_mov_b32 v225, 0
    v_mov_b32 v226, 0
    v_mov_b32 v227, 0
    v_mov_b32 v228, 0
    v_mov_b32 v229, 0
    v_mov_b32 v230, 0
    v_mov_b32 v231, 0
    v_mov_b32 v232, 0
    v_mov_b32 v233, 0
    v_mov_b32 v234, 0
    v_mov_b32 v235, 0
    v_mov_b32 v236, 0
    v_mov_b32 v237, 0
    v_mov_b32 v238, 0
    v_mov_b32 v239, 0
    v_mov_b32 v240, 0
    v_mov_b32 v241, 0
    v_mov_b32 v242, 0
    v_mov_b32 v243, 0
    v_mov_b32 v244, 0
    v_mov_b32 v245, 0
    v_mov_b32 v246, 0
    v_mov_b32 v247, 0
    v_mov_b32 v248, 0
    v_mov_b32 v249, 0
    v_mov_b32 v250, 0
    v_mov_b32 v251, 0
    v_mov_b32 v252, 0
    v_mov_b32 v253, 0
    v_mov_b32 v254, 0
    v_mov_b32 v255, 0
    v_lshlrev_b32 v9, 2, v6
    v_lshlrev_b32 v124, 7, v2
    s_lshl_b32 s63, s32, 6
    s_add_u32 s63, s63, s80
    s_lshr_b32 s64, s63, 5
    s_sub_u32 s31, s22, 1
    s_sub_i32 s20, s31, s64
    s_max_i32 s20, s20, 1
    s_lshr_b32 s64, s63, 4
    s_cmp_lt_u32 s64, s23
    s_cselect_b32 s20, s20, 99
    s_lshl_b32 s21, s85, 4
    s_add_u32 s21, s21, s63
    s_lshl_b32 s21, s21, 13
    s_waitcnt lgkmcnt(0)
    s_mov_b32 s4, s48
    s_mov_b32 s5, s49
    s_mov_b32 s6, 7340032
    s_mov_b32 s7, 0x00020000
    s_waitcnt vmcnt(0)
    s_barrier
    s_cmp_lg_u32 s32, 0
    s_cbranch_scc1 s2_c_go
    v_lshlrev_b32 v11, 8, v2
    v_mov_b32 v10, 1
    s_mov_b32 exec_hi, 0
    buffer_store_dword v10, v11, s[72:75], s88 offen sc0 sc1
    s_mov_b32 exec_lo, 0xffff
    s_cmp_lg_u32 s25, 0
    s_cbranch_scc1 s2_c_go0
    s_mov_b32 s82, 0x40000
    buffer_load_dword v12, v9, s[72:75], s89 offen sc0 sc1
    s_sleep 6
    buffer_load_dword v13, v9, s[72:75], s89 offen sc0 sc1
    s_sleep 6
    buffer_load_dword v14, v9, s[72:75], s89 offen sc0 sc1
    s_sleep 6
s2_c_poll:
    buffer_load_dword v15, v9, s[72:75], s89 offen sc0 sc1
    s_waitcnt vmcnt(3)
    v_cmp_eq_u32 vcc, 1, v12
    s_cmpk_eq_u32 vcc_lo, 0xffff
    s_cbranch_scc1 s2_c_go0
    s_sleep 6
    buffer_load_dword v12, v9, s[72:75], s89 offen sc0 sc1
    s_waitcnt vmcnt(3)
    v_cmp_eq_u32 vcc, 1, v13
    s_cmpk_eq_u32 vcc_lo, 0xffff
    s_cbranch_scc1 s2_c_go0
    s_sleep 6
    buffer_load_dword v13, v9, s[72:75], s89 offen sc0 sc1
    s_waitcnt vmcnt(3)
    v_cmp_eq_u32 vcc, 1, v14
    s_cmpk_eq_u32 vcc_lo, 0xffff
    s_cbranch_scc1 s2_c_go0
    s_sleep 6
    buffer_load_dword v14, v9, s[72:75], s89 offen sc0 sc1
    s_waitcnt vmcnt(3)
    v_cmp_eq_u32 vcc, 1, v15
    s_cmpk_eq_u32 vcc_lo, 0xffff
    s_cbranch_scc1 s2_c_go0
    s_sleep 6
    s_sub_u32 s82, s82, 1
    s_cmp_lg_u32 s82, 0
    s_cbranch_scc1 s2_c_poll
s2_c_go0:
    s_mov_b64 exec, -1
s2_c_go:
    s_barrier
    s_barrier
    ds_read_b128 v[48:51], v114
    ds_read_b128 v[16:19], v112 offset:0
    ds_read_b128 v[20:23], v112 offset:2048
    ds_read_b128 v[24:27], v112 offset:4096
    ds_read_b128 v[28:31], v112 offset:6144
    ds_read_b128 v[32:35], v112 offset:8192
    ds_read_b128 v[36:39], v112 offset:10240
    ds_read_b128 v[40:43], v112 offset:12288
    ds_read_b128 v[44:47], v112 offset:14336
    ds_read_b128 v[52:55], v114 offset:2048
    ds_read_b128 v[56:59], v114 offset:4096
    ds_read_b128 v[60:63], v114 offset:6144
s2_cc_loop:
    s_cmp_lg_u32 s31, s20
    s_cbranch_scc1 s2_t1
    buffer_load_dword v125, v124, s[4:7], s21 offen
s2_t1:
    s_waitcnt lgkmcnt(0)
    v_mfma_f32_16x16x32_bf16 v[128:131], v[48:51], v[16:19], v[128:131]
    ds_read_b128 v[96:99], v115
    v_mfma_f32_16x16x32_bf16 v[132:135], v[48:51], v[20:23], v[132:135]
    ds_read_b128 v[64:67], v113 offset:0
    v_mfma_f32_16x16x32_bf16 v[136:139], v[48:51], v[24:27], v[136:139]
    ds_read_b128 v[68:71], v113 offset:2048
    v_mfma_f32_16x16x32_bf16 v[140:143], v[48:51], v[28:31], v[140:143]
    ds_read_b128 v[72:75], v113 offset:4096
    v_mfma_f32_16x16x32_bf16 v[144:147], v[48:51], v[32:35], v[144:147]
    ds_read_b128 v[76:79], v113 offset:6144
    v_mfma_f32_16x16x32_bf16 v[148:151], v[48:51], v[36:39], v[148:151]
    ds_read_b128 v[80:83], v113 offset:8192
    v_mfma_f32_16x16x32_bf16 v[152:155], v[48:51], v[40:43], v[152:155]
    ds_read_b128 v[84:87], v113 offset:10240
    v_mfma_f32_16x16x32_bf16 v[156:159], v[48:51], v[44:47], v[156:159]
    ds_read_b128 v[88:91], v113 offset:12288
    v_mfma_f32_16x16x32_bf16 v[160:163], v[52:55], v[16:19], v[160:163]
    ds_read_b128 v[92:95], v113 offset:14336
    v_mfma_f32_16x16x32_bf16 v[164:167], v[52:55], v[20:23], v[164:167]
    ds_read_b128 v[100:103], v115 offset:2048
    v_mfma_f32_16x16x32_bf16 v[168:171], v[52:55], v[24:27], v[168:171]
    ds_read_b128 v[104:107], v115 offset:4096
    v_mfma_f32_16x16x32_bf16 v[172:175], v[52:55], v[28:31], v[172:175]
    ds_read_b128 v[108:111], v115 offset:6144
    v_mfma_f32_16x16x32_bf16 v[176:179], v[52:55], v[32:35], v[176:179]
    v_mfma_f32_16x16x32_bf16 v[180:183], v[52:55], v[36:39], v[180:183]
    v_mfma_f32_16x16x32_bf16 v[184:187], v[52:55], v[40:43], v[184:187]
    v_mfma_f32_16x16x32_bf16 v[188:191], v[52:55], v[44:47], v[188:191]
    v_mfma_f32_16x16x32_bf16 v[192:195], v[56:59], v[16:19], v[192:195]
    v_mfma_f32_16x16x32_bf16 v[196:199], v[56:59], v[20:23], v[196:199]
    v_mfma_f32_16x16x32_bf16 v[200:203], v[56:59], v[24:27], v[200:203]
    v_mfma_f32_16x16x32_bf16 v[204:207], v[56:59], v[28:31], v[204:207]
    v_mfma_f32_16x16x32_bf16 v[208:211], v[56:59], v[32:35], v[208:211]
    v_mfma_f32_16x16x32_bf16 v[212:215], v[56:59], v[36:39], v[212:215]
    v_mfma_f32_16x16x32_bf16 v[216:219], v[56:59], v[40:43], v[216:219]
    v_mfma_f32_16x16x32_bf16 v[220:223], v[56:59], v[44:47], v[220:223]
    v_mfma_f32_16x16x32_bf16 v[224:227], v[60:63], v[16:19], v[224:227]
    v_mfma_f32_16x16x32_bf16 v[228:231], v[60:63], v[20:23], v[228:231]
    v_mfma_f32_16x16x32_bf16 v[232:235], v[60:63], v[24:27], v[232:235]
    v_mfma_f32_16x16x32_bf16 v[236:239], v[60:63], v[28:31], v[236:239]
    v_mfma_f32_16x16x32_bf16 v[240:243], v[60:63], v[32:35], v[240:243]
    v_mfma_f32_16x16x32_bf16 v[244:247], v[60:63], v[36:39], v[244:247]
    v_mfma_f32_16x16x32_bf16 v[248:251], v[60:63], v[40:43], v[248:251]
    v_mfma_f32_16x16x32_bf16 v[252:255], v[60:63], v[44:47], v[252:255]
    s_waitcnt lgkmcnt(0)
    v_mfma_f32_16x16x32_bf16 v[128:131], v[96:99], v[64:67], v[128:131]
    s_add_u32 s28, s28, 49152
    s_cmp_eq_u32 s28, 147456
    s_cselect_b32 s28, 0, s28
    v_add_u32 v112, s28, v118
    v_mfma_f32_16x16x32_bf16 v[132:135], v[96:99], v[68:71], v[132:135]
    v_add_u32 v113, s28, v119
    v_add_u32 v114, s28, v120
    v_add_u32 v115, s28, v121
    s_barrier
    v_mfma_f32_16x16x32_bf16 v[136:139], v[96:99], v[72:75], v[136:139]
    ds_read_b128 v[48:51], v114
    v_mfma_f32_16x16x32_bf16 v[140:143], v[96:99], v[76:79], v[140:143]
    ds_read_b128 v[16:19], v112 offset:0
    v_mfma_f32_16x16x32_bf16 v[144:147], v[96:99], v[80:83], v[144:147]
    ds_read_b128 v[20:23], v112 offset:2048
    v_mfma_f32_16x16x32_bf16 v[148:151], v[96:99], v[84:87], v[148:151]
    ds_read_b128 v[24:27], v112 offset:4096
    v_mfma_f32_16x16x32_bf16 v[152:155], v[96:99], v[88:91], v[152:155]
    ds_read_b128 v[28:31], v112 offset:6144
    v_mfma_f32_16x16x32_bf16 v[156:159], v[96:99], v[92:95], v[156:159]
    ds_read_b128 v[32:35], v112 offset:8192
    v_mfma_f32_16x16x32_bf16 v[160:163], v[100:103], v[64:67], v[160:163]
    ds_read_b128 v[36:39], v112 offset:10240
    v_mfma_f32_16x16x32_bf16 v[164:167], v[100:103], v[68:71], v[164:167]
    ds_read_b128 v[40:43], v112 offset:12288
    v_mfma_f32_16x16x32_bf16 v[168:171], v[100:103], v[72:75], v[168:171]
    ds_read_b128 v[44:47], v112 offset:14336
    v_mfma_f32_16x16x32_bf16 v[172:175], v[100:103], v[76:79], v[172:175]
    ds_read_b128 v[52:55], v114 offset:2048
    v_mfma_f32_16x16x32_bf16 v[176:179], v[100:103], v[80:83], v[176:179]
    ds_read_b128 v[56:59], v114 offset:4096
    v_mfma_f32_16x16x32_bf16 v[180:183], v[100:103], v[84:87], v[180:183]
    ds_read_b128 v[60:63], v114 offset:6144
    v_mfma_f32_16x16x32_bf16 v[184:187], v[100:103], v[88:91], v[184:187]
    v_mfma_f32_16x16x32_bf16 v[188:191], v[100:103], v[92:95], v[188:191]
    v_mfma_f32_16x16x32_bf16 v[192:195], v[104:107], v[64:67], v[192:195]
    v_mfma_f32_16x16x32_bf16 v[196:199], v[104:107], v[68:71], v[196:199]
    v_mfma_f32_16x16x32_bf16 v[200:203], v[104:107], v[72:75], v[200:203]
    v_mfma_f32_16x16x32_bf16 v[204:207], v[104:107], v[76:79], v[204:207]
    v_mfma_f32_16x16x32_bf16 v[208:211], v[104:107], v[80:83], v[208:211]
    v_mfma_f32_16x16x32_bf16 v[212:215], v[104:107], v[84:87], v[212:215]
    v_mfma_f32_16x16x32_bf16 v[216:219], v[104:107], v[88:91], v[216:219]
    v_mfma_f32_16x16x32_bf16 v[220:223], v[104:107], v[92:95], v[220:223]
    v_mfma_f32_16x16x32_bf16 v[224:227], v[108:111], v[64:67], v[224:227]
    v_mfma_f32_16x16x32_bf16 v[228:231], v[108:111], v[68:71], v[228:231]
    v_mfma_f32_16x16x32_bf16 v[232:235], v[108:111], v[72:75], v[232:235]
    v_mfma_f32_16x16x32_bf16 v[236:239], v[108:111], v[76:79], v[236:239]
    v_mfma_f32_16x16x32_bf16 v[240:243], v[108:111], v[80:83], v[240:243]
    v_mfma_f32_16x16x32_bf16 v[244:247], v[108:111], v[84:87], v[244:247]
    v_mfma_f32_16x16x32_bf16 v[248:251], v[108:111], v[88:91], v[248:251]
    v_mfma_f32_16x16x32_bf16 v[252:255], v[108:111], v[92:95], v[252:255]
    s_sub_u32 s31, s31, 1
    s_cmp_lg_u32 s31, 0
    s_cbranch_scc1 s2_cc_loop
    s_waitcnt lgkmcnt(0)
    v_mfma_f32_16x16x32_bf16 v[128:131], v[48:51], v[16:19], v[128:131]
    ds_read_b128 v[96:99], v115
    v_mfma_f32_16x16x32_bf16 v[132:135], v[48:51], v[20:23], v[132:135]
    ds_read_b128 v[64:67], v113 offset:0
    v_mfma_f32_16x16x32_bf16 v[136:139], v[48:51], v[24:27], v[136:139]
    ds_read_b128 v[68:71], v113 offset:2048
    v_mfma_f32_16x16x32_bf16 v[140:143], v[48:51], v[28:31], v[140:143]
    ds_read_b128 v[72:75], v113 offset:4096
    v_mfma_f32_16x16x32_bf16 v[144:147], v[48:51], v[32:35], v[144:147]
    ds_read_b128 v[76:79], v113 offset:6144
    v_mfma_f32_16x16x32_bf16 v[148:151], v[48:51], v[36:39], v[148:151]
    ds_read_b128 v[80:83], v113 offset:8192
    v_mfma_f32_16x16x32_bf16 v[152:155], v[48:51], v[40:43], v[152:155]
    ds_read_b128 v[84:87], v113 offset:10240
    v_mfma_f32_16x16x32_bf16 v[156:159], v[48:51], v[44:47], v[156:159]
    ds_read_b128 v[88:91], v113 offset:12288
    v_mfma_f32_16x16x32_bf16 v[160:163], v[52:55], v[16:19], v[160:163]
    ds_read_b128 v[92:95], v113 offset:14336
    v_mfma_f32_16x16x32_bf16 v[164:167], v[52:55], v[20:23], v[164:167]
    ds_read_b128 v[100:103], v115 offset:2048
    v_mfma_f32_16x16x32_bf16 v[168:171], v[52:55], v[24:27], v[168:171]
    ds_read_b128 v[104:107], v115 offset:4096
    v_mfma_f32_16x16x32_bf16 v[172:175], v[52:55], v[28:31], v[172:175]
    ds_read_b128 v[108:111], v115 offset:6144
    v_mfma_f32_16x16x32_bf16 v[176:179], v[52:55], v[32:35], v[176:179]
    v_mfma_f32_16x16x32_bf16 v[180:183], v[52:55], v[36:39], v[180:183]
    v_mfma_f32_16x16x32_bf16 v[184:187], v[52:55], v[40:43], v[184:187]
    v_mfma_f32_16x16x32_bf16 v[188:191], v[52:55], v[44:47], v[188:191]
    v_mfma_f32_16x16x32_bf16 v[192:195], v[56:59], v[16:19], v[192:195]
    v_mfma_f32_16x16x32_bf16 v[196:199], v[56:59], v[20:23], v[196:199]
    v_mfma_f32_16x16x32_bf16 v[200:203], v[56:59], v[24:27], v[200:203]
    v_mfma_f32_16x16x32_bf16 v[204:207], v[56:59], v[28:31], v[204:207]
    v_mfma_f32_16x16x32_bf16 v[208:211], v[56:59], v[32:35], v[208:211]
    v_mfma_f32_16x16x32_bf16 v[212:215], v[56:59], v[36:39], v[212:215]
    v_mfma_f32_16x16x32_bf16 v[216:219], v[56:59], v[40:43], v[216:219]
    v_mfma_f32_16x16x32_bf16 v[220:223], v[56:59], v[44:47], v[220:223]
    v_mfma_f32_16x16x32_bf16 v[224:227], v[60:63], v[16:19], v[224:227]
    v_mfma_f32_16x16x32_bf16 v[228:231], v[60:63], v[20:23], v[228:231]
    v_mfma_f32_16x16x32_bf16 v[232:235], v[60:63], v[24:27], v[232:235]
    v_mfma_f32_16x16x32_bf16 v[236:239], v[60:63], v[28:31], v[236:239]
    v_mfma_f32_16x16x32_bf16 v[240:243], v[60:63], v[32:35], v[240:243]
    v_mfma_f32_16x16x32_bf16 v[244:247], v[60:63], v[36:39], v[244:247]
    v_mfma_f32_16x16x32_bf16 v[248:251], v[60:63], v[40:43], v[248:251]
    v_mfma_f32_16x16x32_bf16 v[252:255], v[60:63], v[44:47], v[252:255]
    s_waitcnt lgkmcnt(0)
    v_mfma_f32_16x16x32_bf16 v[128:131], v[96:99], v[64:67], v[128:131]
    s_add_u32 s28, s28, 49152
    s_cmp_eq_u32 s28, 147456
    s_cselect_b32 s28, 0, s28
    v_add_u32 v112, s28, v118
    v_mfma_f32_16x16x32_bf16 v[132:135], v[96:99], v[68:71], v[132:135]
    v_add_u32 v113, s28, v119
    v_add_u32 v116, s28, v122
    v_add_u32 v117, s28, v123
    s_barrier
    v_mfma_f32_16x16x32_bf16 v[136:139], v[96:99], v[72:75], v[136:139]
    ds_read_b64_tr_b16 v[48:49], v116 offset:0
    v_mfma_f32_16x16x32_bf16 v[140:143], v[96:99], v[76:79], v[140:143]
    ds_read_b64_tr_b16 v[50:51], v116 offset:256
    v_mfma_f32_16x16x32_bf16 v[144:147], v[96:99], v[80:83], v[144:147]
    ds_read_b128 v[16:19], v112 offset:0
    v_mfma_f32_16x16x32_bf16 v[148:151], v[96:99], v[84:87], v[148:151]
    ds_read_b128 v[20:23], v112 offset:2048
    v_mfma_f32_16x16x32_bf16 v[152:155], v[96:99], v[88:91], v[152:155]
    ds_read_b128 v[24:27], v112 offset:4096
    v_mfma_f32_16x16x32_bf16 v[156:159], v[96:99], v[92:95], v[156:159]
    ds_read_b128 v[28:31], v112 offset:6144
    v_mfma_f32_16x16x32_bf16 v[160:163], v[100:103], v[64:67], v[160:163]
    ds_read_b128 v[32:35], v112 offset:8192
    v_mfma_f32_16x16x32_bf16 v[164:167], v[100:103], v[68:71], v[164:167]
    ds_read_b128 v[36:39], v112 offset:10240
    v_mfma_f32_16x16x32_bf16 v[168:171], v[100:103], v[72:75], v[168:171]
    ds_read_b128 v[40:43], v112 offset:12288
    v_mfma_f32_16x16x32_bf16 v[172:175], v[100:103], v[76:79], v[172:175]
    ds_read_b128 v[44:47], v112 offset:14336
    v_mfma_f32_16x16x32_bf16 v[176:179], v[100:103], v[80:83], v[176:179]
    ds_read_b64_tr_b16 v[52:53], v117 offset:0
    v_mfma_f32_16x16x32_bf16 v[180:183], v[100:103], v[84:87], v[180:183]
    ds_read_b64_tr_b16 v[54:55], v117 offset:256
    v_mfma_f32_16x16x32_bf16 v[184:187], v[100:103], v[88:91], v[184:187]
    ds_read_b64_tr_b16 v[56:57], v116 offset:1024
    v_mfma_f32_16x16x32_bf16 v[188:191], v[100:103], v[92:95], v[188:191]
    ds_read_b64_tr_b16 v[58:59], v116 offset:1280
    v_mfma_f32_16x16x32_bf16 v[192:195], v[104:107], v[64:67], v[192:195]
    ds_read_b64_tr_b16 v[60:61], v117 offset:1024
    v_mfma_f32_16x16x32_bf16 v[196:199], v[104:107], v[68:71], v[196:199]
    ds_read_b64_tr_b16 v[62:63], v117 offset:1280
    v_mfma_f32_16x16x32_bf16 v[200:203], v[104:107], v[72:75], v[200:203]
    v_mfma_f32_16x16x32_bf16 v[204:207], v[104:107], v[76:79], v[204:207]
    v_mfma_f32_16x16x32_bf16 v[208:211], v[104:107], v[80:83], v[208:211]
    v_mfma_f32_16x16x32_bf16 v[212:215], v[104:107], v[84:87], v[212:215]
    v_mfma_f32_16x16x32_bf16 v[216:219], v[104:107], v[88:91], v[216:219]
    v_mfma_f32_16x16x32_bf16 v[220:223], v[104:107], v[92:95], v[220:223]
    v_mfma_f32_16x16x32_bf16 v[224:227], v[108:111], v[64:67], v[224:227]
    v_mfma_f32_16x16x32_bf16 v[228:231], v[108:111], v[68:71], v[228:231]
    v_mfma_f32_16x16x32_bf16 v[232:235], v[108:111], v[72:75], v[232:235]
    v_mfma_f32_16x16x32_bf16 v[236:239], v[108:111], v[76:79], v[236:239]
    v_mfma_f32_16x16x32_bf16 v[240:243], v[108:111], v[80:83], v[240:243]
    v_mfma_f32_16x16x32_bf16 v[244:247], v[108:111], v[84:87], v[244:247]
    v_mfma_f32_16x16x32_bf16 v[248:251], v[108:111], v[88:91], v[248:251]
    v_mfma_f32_16x16x32_bf16 v[252:255], v[108:111], v[92:95], v[252:255]
    s_sub_u32 s31, s23, 1
s2_cw_loop:
    s_waitcnt lgkmcnt(0)
    v_mfma_f32_16x16x32_bf16 v[128:131], v[48:51], v[16:19], v[128:131]
    ds_read_b64_tr_b16 v[96:97], v116 offset:8192
    v_mfma_f32_16x16x32_bf16 v[132:135], v[48:51], v[20:23], v[132:135]
    ds_read_b64_tr_b16 v[98:99], v116 offset:8448
    v_mfma_f32_16x16x32_bf16 v[136:139], v[48:51], v[24:27], v[136:139]
    ds_read_b128 v[64:67], v113 offset:0
    v_mfma_f32_16x16x32_bf16 v[140:143], v[48:51], v[28:31], v[140:143]
    ds_read_b128 v[68:71], v113 offset:2048
    v_mfma_f32_16x16x32_bf16 v[144:147], v[48:51], v[32:35], v[144:147]
    ds_read_b128 v[72:75], v113 offset:4096
    v_mfma_f32_16x16x32_bf16 v[148:151], v[48:51], v[36:39], v[148:151]
    ds_read_b128 v[76:79], v113 offset:6144
    v_mfma_f32_16x16x32_bf16 v[152:155], v[48:51], v[40:43], v[152:155]
    ds_read_b128 v[80:83], v113 offset:8192
    v_mfma_f32_16x16x32_bf16 v[156:159], v[48:51], v[44:47], v[156:159]
    ds_read_b128 v[84:87], v113 offset:10240
    v_mfma_f32_16x16x32_bf16 v[160:163], v[52:55], v[16:19], v[160:163]
    ds_read_b128 v[88:91], v113 offset:12288
    v_mfma_f32_16x16x32_bf16 v[164:167], v[52:55], v[20:23], v[164:167]
    ds_read_b128 v[92:95], v113 offset:14336
    v_mfma_f32_16x16x32_bf16 v[168:171], v[52:55], v[24:27], v[168:171]
    ds_read_b64_tr_b16 v[100:101], v117 offset:8192
    v_mfma_f32_16x16x32_bf16 v[172:175], v[52:55], v[28:31], v[172:175]
    ds_read_b64_tr_b16 v[102:103], v117 offset:8448
    v_mfma_f32_16x16x32_bf16 v[176:179], v[52:55], v[32:35], v[176:179]
    ds_read_b64_tr_b16 v[104:105], v116 offset:9216
    v_mfma_f32_16x16x32_bf16 v[180:183], v[52:55], v[36:39], v[180:183]
    ds_read_b64_tr_b16 v[106:107], v116 offset:9472
    v_mfma_f32_16x16x32_bf16 v[184:187], v[52:55], v[40:43], v[184:187]
    ds_read_b64_tr_b16 v[108:109], v117 offset:9216
    v_mfma_f32_16x16x32_bf16 v[188:191], v[52:55], v[44:47], v[188:191]
    ds_read_b64_tr_b16 v[110:111], v117 offset:9472
    v_mfma_f32_16x16x32_bf16 v[192:195], v[56:59], v[16:19], v[192:195]
    v_mfma_f32_16x16x32_bf16 v[196:199], v[56:59], v[20:23], v[196:199]
    v_mfma_f32_16x16x32_bf16 v[200:203], v[56:59], v[24:27], v[200:203]
    v_mfma_f32_16x16x32_bf16 v[204:207], v[56:59], v[28:31], v[204:207]
    v_mfma_f32_16x16x32_bf16 v[208:211], v[56:59], v[32:35], v[208:211]
    v_mfma_f32_16x16x32_bf16 v[212:215], v[56:59], v[36:39], v[212:215]
    v_mfma_f32_16x16x32_bf16 v[216:219], v[56:59], v[40:43], v[216:219]
    v_mfma_f32_16x16x32_bf16 v[220:223], v[56:59], v[44:47], v[220:223]
    v_mfma_f32_16x16x32_bf16 v[224:227], v[60:63], v[16:19], v[224:227]
    v_mfma_f32_16x16x32_bf16 v[228:231], v[60:63], v[20:23], v[228:231]
    v_mfma_f32_16x16x32_bf16 v[232:235], v[60:63], v[24:27], v[232:235]
    v_mfma_f32_16x16x32_bf16 v[236:239], v[60:63], v[28:31], v[236:239]
    v_mfma_f32_16x16x32_bf16 v[240:243], v[60:63], v[32:35], v[240:243]
    v_mfma_f32_16x16x32_bf16 v[244:247], v[60:63], v[36:39], v[244:247]
    v_mfma_f32_16x16x32_bf16 v[248:251], v[60:63], v[40:43], v[248:251]
    v_mfma_f32_16x16x32_bf16 v[252:255], v[60:63], v[44:47], v[252:255]
    s_waitcnt lgkmcnt(0)
    v_mfma_f32_16x16x32_bf16 v[128:131], v[96:99], v[64:67], v[128:131]
    s_add_u32 s28, s28, 49152
    s_cmp_eq_u32 s28, 147456
    s_cselect_b32 s28, 0, s28
    v_add_u32 v112, s28, v118
    v_mfma_f32_16x16x32_bf16 v[132:135], v[96:99], v[68:71], v[132:135]
    v_add_u32 v113, s28, v119
    v_add_u32 v116, s28, v122
    v_add_u32 v117, s28, v123
    s_barrier
    v_mfma_f32_16x16x32_bf16 v[136:139], v[96:99], v[72:75], v[136:139]
    ds_read_b64_tr_b16 v[48:49], v116 offset:0
    v_mfma_f32_16x16x32_bf16 v[140:143], v[96:99], v[76:79], v[140:143]
    ds_read_b64_tr_b16 v[50:51], v116 offset:256
    v_mfma_f32_16x16x32_bf16 v[144:147], v[96:99], v[80:83], v[144:147]
    ds_read_b128 v[16:19], v112 offset:0
    v_mfma_f32_16x16x32_bf16 v[148:151], v[96:99], v[84:87], v[148:151]
    ds_read_b128 v[20:23], v112 offset:2048
    v_mfma_f32_16x16x32_bf16 v[152:155], v[96:99], v[88:91], v[152:155]
    ds_read_b128 v[24:27], v112 offset:4096
    v_mfma_f32_16x16x32_bf16 v[156:159], v[96:99], v[92:95], v[156:159]
    ds_read_b128 v[28:31], v112 offset:6144
    v_mfma_f32_16x16x32_bf16 v[160:163], v[100:103], v[64:67], v[160:163]
    ds_read_b128 v[32:35], v112 offset:8192
    v_mfma_f32_16x16x32_bf16 v[164:167], v[100:103], v[68:71], v[164:167]
    ds_read_b128 v[36:39], v112 offset:10240
    v_mfma_f32_16x16x32_bf16 v[168:171], v[100:103], v[72:75], v[168:171]
    ds_read_b128 v[40:43], v112 offset:12288
    v_mfma_f32_16x16x32_bf16 v[172:175], v[100:103], v[76:79], v[172:175]
    ds_read_b128 v[44:47], v112 offset:14336
    v_mfma_f32_16x16x32_bf16 v[176:179], v[100:103], v[80:83], v[176:179]
    ds_read_b64_tr_b16 v[52:53], v117 offset:0
    v_mfma_f32_16x16x32_bf16 v[180:183], v[100:103], v[84:87], v[180:183]
    ds_read_b64_tr_b16 v[54:55], v117 offset:256
    v_mfma_f32_16x16x32_bf16 v[184:187], v[100:103], v[88:91], v[184:187]
    ds_read_b64_tr_b16 v[56:57], v116 offset:1024
    v_mfma_f32_16x16x32_bf16 v[188:191], v[100:103], v[92:95], v[188:191]
    ds_read_b64_tr_b16 v[58:59], v116 offset:1280
    v_mfma_f32_16x16x32_bf16 v[192:195], v[104:107], v[64:67], v[192:195]
    ds_read_b64_tr_b16 v[60:61], v117 offset:1024
    v_mfma_f32_16x16x32_bf16 v[196:199], v[104:107], v[68:71], v[196:199]
    ds_read_b64_tr_b16 v[62:63], v117 offset:1280
    v_mfma_f32_16x16x32_bf16 v[200:203], v[104:107], v[72:75], v[200:203]
    v_mfma_f32_16x16x32_bf16 v[204:207], v[104:107], v[76:79], v[204:207]
    v_mfma_f32_16x16x32_bf16 v[208:211], v[104:107], v[80:83], v[208:211]
    v_mfma_f32_16x16x32_bf16 v[212:215], v[104:107], v[84:87], v[212:215]
    v_mfma_f32_16x16x32_bf16 v[216:219], v[104:107], v[88:91], v[216:219]
    v_mfma_f32_16x16x32_bf16 v[220:223], v[104:107], v[92:95], v[220:223]
    v_mfma_f32_16x16x32_bf16 v[224:227], v[108:111], v[64:67], v[224:227]
    v_mfma_f32_16x16x32_bf16 v[228:231], v[108:111], v[68:71], v[228:231]
    v_mfma_f32_16x16x32_bf16 v[232:235], v[108:111], v[72:75], v[232:235]
    v_mfma_f32_16x16x32_bf16 v[236:239], v[108:111], v[76:79], v[236:239]
    v_mfma_f32_16x16x32_bf16 v[240:243], v[108:111], v[80:83], v[240:243]
    v_mfma_f32_16x16x32_bf16 v[244:247], v[108:111], v[84:87], v[244:247]
    v_mfma_f32_16x16x32_bf16 v[248:251], v[108:111], v[88:91], v[248:251]
    v_mfma_f32_16x16x32_bf16 v[252:255], v[108:111], v[92:95], v[252:255]
    s_sub_u32 s31, s31, 1
    s_cmp_lg_u32 s31, 0
    s_cbranch_scc1 s2_cw_loop
    s_waitcnt lgkmcnt(0)
    v_mfma_f32_16x16x32_bf16 v[128:131], v[48:51], v[16:19], v[128:131]
    ds_read_b64_tr_b16 v[96:97], v116 offset:8192
    v_mfma_f32_16x16x32_bf16 v[132:135], v[48:51], v[20:23], v[132:135]
    ds_read_b64_tr_b16 v[98:99], v116 offset:8448
    v_mfma_f32_16x16x32_bf16 v[136:139], v[48:51], v[24:27], v[136:139]
    ds_read_b128 v[64:67], v113 offset:0
    v_mfma_f32_16x16x32_bf16 v[140:143], v[48:51], v[28:31], v[140:143]
    ds_read_b128 v[68:71], v113 offset:2048
    v_mfma_f32_16x16x32_bf16 v[144:147], v[48:51], v[32:35], v[144:147]
    ds_read_b128 v[72:75], v113 offset:4096
    v_mfma_f32_16x16x32_bf16 v[148:151], v[48:51], v[36:39], v[148:151]
    ds_read_b128 v[76:79], v113 offset:6144
    v_mfma_f32_16x16x32_bf16 v[152:155], v[48:51], v[40:43], v[152:155]
    ds_read_b128 v[80:83], v113 offset:8192
    v_mfma_f32_16x16x32_bf16 v[156:159], v[48:51], v[44:47], v[156:159]
    ds_read_b128 v[84:87], v113 offset:10240
    v_mfma_f32_16x16x32_bf16 v[160:163], v[52:55], v[16:19], v[160:163]
    ds_read_b128 v[88:91], v113 offset:12288
    v_mfma_f32_16x16x32_bf16 v[164:167], v[52:55], v[20:23], v[164:167]
    ds_read_b128 v[92:95], v113 offset:14336
    v_mfma_f32_16x16x32_bf16 v[168:171], v[52:55], v[24:27], v[168:171]
    ds_read_b64_tr_b16 v[100:101], v117 offset:8192
    v_mfma_f32_16x16x32_bf16 v[172:175], v[52:55], v[28:31], v[172:175]
    ds_read_b64_tr_b16 v[102:103], v117 offset:8448
    v_mfma_f32_16x16x32_bf16 v[176:179], v[52:55], v[32:35], v[176:179]
    ds_read_b64_tr_b16 v[104:105], v116 offset:9216
    v_mfma_f32_16x16x32_bf16 v[180:183], v[52:55], v[36:39], v[180:183]
    ds_read_b64_tr_b16 v[106:107], v116 offset:9472
    v_mfma_f32_16x16x32_bf16 v[184:187], v[52:55], v[40:43], v[184:187]
    ds_read_b64_tr_b16 v[108:109], v117 offset:9216
    v_mfma_f32_16x16x32_bf16 v[188:191], v[52:55], v[44:47], v[188:191]
    ds_read_b64_tr_b16 v[110:111], v117 offset:9472
    v_mfma_f32_16x16x32_bf16 v[192:195], v[56:59], v[16:19], v[192:195]
    v_mfma_f32_16x16x32_bf16 v[196:199], v[56:59], v[20:23], v[196:199]
    v_mfma_f32_16x16x32_bf16 v[200:203], v[56:59], v[24:27], v[200:203]
    v_mfma_f32_16x16x32_bf16 v[204:207], v[56:59], v[28:31], v[204:207]
    v_mfma_f32_16x16x32_bf16 v[208:211], v[56:59], v[32:35], v[208:211]
    v_mfma_f32_16x16x32_bf16 v[212:215], v[56:59], v[36:39], v[212:215]
    v_mfma_f32_16x16x32_bf16 v[216:219], v[56:59], v[40:43], v[216:219]
    v_mfma_f32_16x16x32_bf16 v[220:223], v[56:59], v[44:47], v[220:223]
    v_mfma_f32_16x16x32_bf16 v[224:227], v[60:63], v[16:19], v[224:227]
    v_mfma_f32_16x16x32_bf16 v[228:231], v[60:63], v[20:23], v[228:231]
    v_mfma_f32_16x16x32_bf16 v[232:235], v[60:63], v[24:27], v[232:235]
    v_mfma_f32_16x16x32_bf16 v[236:239], v[60:63], v[28:31], v[236:239]
    v_mfma_f32_16x16x32_bf16 v[240:243], v[60:63], v[32:35], v[240:243]
    v_mfma_f32_16x16x32_bf16 v[244:247], v[60:63], v[36:39], v[244:247]
    v_mfma_f32_16x16x32_bf16 v[248:251], v[60:63], v[40:43], v[248:251]
    v_mfma_f32_16x16x32_bf16 v[252:255], v[60:63], v[44:47], v[252:255]
    s_waitcnt lgkmcnt(0)
    v_mfma_f32_16x16x32_bf16 v[128:131], v[96:99], v[64:67], v[128:131]
    v_mfma_f32_16x16x32_bf16 v[132:135], v[96:99], v[68:71], v[132:135]
    v_mfma_f32_16x16x32_bf16 v[136:139], v[96:99], v[72:75], v[136:139]
    v_mfma_f32_16x16x32_bf16 v[140:143], v[96:99], v[76:79], v[140:143]
    v_mfma_f32_16x16x32_bf16 v[144:147], v[96:99], v[80:83], v[144:147]
    v_mfma_f32_16x16x32_bf16 v[148:151], v[96:99], v[84:87], v[148:151]
    v_mfma_f32_16x16x32_bf16 v[152:155], v[96:99], v[88:91], v[152:155]
    v_mfma_f32_16x16x32_bf16 v[156:159], v[96:99], v[92:95], v[156:159]
    v_mfma_f32_16x16x32_bf16 v[160:163], v[100:103], v[64:67], v[160:163]
    v_mfma_f32_16x16x32_bf16 v[164:167], v[100:103], v[68:71], v[164:167]
    v_mfma_f32_16x16x32_bf16 v[168:171], v[100:103], v[72:75], v[168:171]
    v_mfma_f32_16x16x32_bf16 v[172:175], v[100:103], v[76:79], v[172:175]
    v_mfma_f32_16x16x32_bf16 v[176:179], v[100:103], v[80:83], v[176:179]
    v_mfma_f32_16x16x32_bf16 v[180:183], v[100:103], v[84:87], v[180:183]
    v_mfma_f32_16x16x32_bf16 v[184:187], v[100:103], v[88:91], v[184:187]
    v_mfma_f32_16x16x32_bf16 v[188:191], v[100:103], v[92:95], v[188:191]
    v_mfma_f32_16x16x32_bf16 v[192:195], v[104:107], v[64:67], v[192:195]
    v_mfma_f32_16x16x32_bf16 v[196:199], v[104:107], v[68:71], v[196:199]
    v_mfma_f32_16x16x32_bf16 v[200:203], v[104:107], v[72:75], v[200:203]
    v_mfma_f32_16x16x32_bf16 v[204:207], v[104:107], v[76:79], v[204:207]
    v_mfma_f32_16x16x32_bf16 v[208:211], v[104:107], v[80:83], v[208:211]
    v_mfma_f32_16x16x32_bf16 v[212:215], v[104:107], v[84:87], v[212:215]
    v_mfma_f32_16x16x32_bf16 v[216:219], v[104:107], v[88:91], v[216:219]
    v_mfma_f32_16x16x32_bf16 v[220:223], v[104:107], v[92:95], v[220:223]
    v_mfma_f32_16x16x32_bf16 v[224:227], v[108:111], v[64:67], v[224:227]
    v_mfma_f32_16x16x32_bf16 v[228:231], v[108:111], v[68:71], v[228:231]
    v_mfma_f32_16x16x32_bf16 v[232:235], v[108:111], v[72:75], v[232:235]
    v_mfma_f32_16x16x32_bf16 v[236:239], v[108:111], v[76:79], v[236:239]
    v_mfma_f32_16x16x32_bf16 v[240:243], v[108:111], v[80:83], v[240:243]
    v_mfma_f32_16x16x32_bf16 v[244:247], v[108:111], v[84:87], v[244:247]
    v_mfma_f32_16x16x32_bf16 v[248:251], v[108:111], v[88:91], v[248:251]
    v_mfma_f32_16x16x32_bf16 v[252:255], v[108:111], v[92:95], v[252:255]
    s_add_u32 s28, s28, 49152
    s_cmp_eq_u32 s28, 147456
    s_cselect_b32 s28, 0, s28
    s_lshl_b32 s63, s61, 8
    s_add_u32 s28, s28, s63
    v_and_b32 v16, 7, v6
    v_xor_b32 v16, v16, v7
    v_lshlrev_b32 v16, 4, v16
    v_lshl_add_u32 v16, v6, 9, v16
    v_add_u32 v16, s28, v16
    v_xor_b32 v17, 64, v16
    v_lshlrev_b32 v18, 4, v7
    v_lshl_add_u32 v18, v6, 6, v18
    s_lshl_b32 s63, s61, 12
    v_add_u32 v18, s63, v18
    s_nop 7
    s_lshl_b32 s64, s60, 1
    s_cmp_eq_u32 s64, s87
    s_cbranch_scc1 s2_own0
    s_lshl_b32 s65, s80, 2
    s_add_u32 s65, s65, s64
    s_lshl_b32 s65, s65, 2
    s_add_u32 s65, s65, s87
    s_lshl_b32 s65, s65, 15
    v_cvt_pk_bf16_f32 v128, v128, v129
    v_cvt_pk_bf16_f32 v129, v130, v131
    v_cvt_pk_bf16_f32 v130, v132, v133
    v_cvt_pk_bf16_f32 v131, v134, v135
    buffer_store_dwordx4 v[128:131], v18, s[68:71], s65 offen offset:0 sc0 sc1
    v_cvt_pk_bf16_f32 v160, v160, v161
    v_cvt_pk_bf16_f32 v161, v162, v163
    v_cvt_pk_bf16_f32 v162, v164, v165
    v_cvt_pk_bf16_f32 v163, v166, v167
    buffer_store_dwordx4 v[160:163], v18, s[68:71], s65 offen offset:1024 sc0 sc1
    v_cvt_pk_bf16_f32 v192, v192, v193
    v_cvt_pk_bf16_f32 v193, v194, v195
    v_cvt_pk_bf16_f32 v194, v196, v197
    v_cvt_pk_bf16_f32 v195, v198, v199
    buffer_store_dwordx4 v[192:195], v18, s[68:71], s65 offen offset:2048 sc0 sc1
    v_cvt_pk_bf16_f32 v224, v224, v225
    v_cvt_pk_bf16_f32 v225, v226, v227
    v_cvt_pk_bf16_f32 v226, v228, v229
    v_cvt_pk_bf16_f32 v227, v230, v231
    buffer_store_dwordx4 v[224:227], v18, s[68:71], s65 offen offset:3072 sc0 sc1
    s_add_u32 s65, s65, 8192
    v_cvt_pk_bf16_f32 v136, v136, v137
    v_cvt_pk_bf16_f32 v137, v138, v139
    v_cvt_pk_bf16_f32 v138, v140, v141
    v_cvt_pk_bf16_f32 v139, v142, v143
    buffer_store_dwordx4 v[136:139], v18, s[68:71], s65 offen offset:0 sc0 sc1
    v_cvt_pk_bf16_f32 v168, v168, v169
    v_cvt_pk_bf16_f32 v169, v170, v171
    v_cvt_pk_bf16_f32 v170, v172, v173
    v_cvt_pk_bf16_f32 v171, v174, v175
    buffer_store_dwordx4 v[168:171], v18, s[68:71], s65 offen offset:1024 sc0 sc1
    v_cvt_pk_bf16_f32 v200, v200, v201
    v_cvt_pk_bf16_f32 v201, v202, v203
    v_cvt_pk_bf16_f32 v202, v204, v205
    v_cvt_pk_bf16_f32 v203, v206, v207
    buffer_store_dwordx4 v[200:203], v18, s[68:71], s65 offen offset:2048 sc0 sc1
    v_cvt_pk_bf16_f32 v232, v232, v233
    v_cvt_pk_bf16_f32 v233, v234, v235
    v_cvt_pk_bf16_f32 v234, v236, v237
    v_cvt_pk_bf16_f32 v235, v238, v239
    buffer_store_dwordx4 v[232:235], v18, s[68:71], s65 offen offset:3072 sc0 sc1
    s_branch s2_q0
s2_own0:
    ds_write_b128 v16, v[128:131] offset:0
    ds_write_b128 v17, v[160:163] offset:0
    ds_write_b128 v16, v[192:195] offset:128
    ds_write_b128 v17, v[224:227] offset:128
    ds_write_b128 v16, v[132:135] offset:8192
    ds_write_b128 v17, v[164:167] offset:8192
    ds_write_b128 v16, v[196:199] offset:8320
    ds_write_b128 v17, v[228:231] offset:8320
    ds_write_b128 v16, v[136:139] offset:16384
    ds_write_b128 v17, v[168:171] offset:16384
    ds_write_b128 v16, v[200:203] offset:16512
    ds_write_b128 v17, v[232:235] offset:16512
    ds_write_b128 v16, v[140:143] offset:24576
    ds_write_b128 v17, v[172:175] offset:24576
    ds_write_b128 v16, v[204:207] offset:24704
    ds_write_b128 v17, v[236:239] offset:24704
s2_q0:
    s_lshl_b32 s64, s60, 1
    s_add_u32 s64, s64, 1
    s_cmp_eq_u32 s64, s87
    s_cbranch_scc1 s2_own1
    s_lshl_b32 s65, s80, 2
    s_add_u32 s65, s65, s64
    s_lshl_b32 s65, s65, 2
    s_add_u32 s65, s65, s87
    s_lshl_b32 s65, s65, 15
    v_cvt_pk_bf16_f32 v144, v144, v145
    v_cvt_pk_bf16_f32 v145, v146, v147
    v_cvt_pk_bf16_f32 v146, v148, v149
    v_cvt_pk_bf16_f32 v147, v150, v151
    buffer_store_dwordx4 v[144:147], v18, s[68:71], s65 offen offset:0 sc0 sc1
    v_cvt_pk_bf16_f32 v176, v176, v177
    v_cvt_pk_bf16_f32 v177, v178, v179
    v_cvt_pk_bf16_f32 v178, v180, v181
    v_cvt_pk_bf16_f32 v179, v182, v183
    buffer_store_dwordx4 v[176:179], v18, s[68:71], s65 offen offset:1024 sc0 sc1
    v_cvt_pk_bf16_f32 v208, v208, v209
    v_cvt_pk_bf16_f32 v209, v210, v211
    v_cvt_pk_bf16_f32 v210, v212, v213
    v_cvt_pk_bf16_f32 v211, v214, v215
    buffer_store_dwordx4 v[208:211], v18, s[68:71], s65 offen offset:2048 sc0 sc1
    v_cvt_pk_bf16_f32 v240, v240, v241
    v_cvt_pk_bf16_f32 v241, v242, v243
    v_cvt_pk_bf16_f32 v242, v244, v245
    v_cvt_pk_bf16_f32 v243, v246, v247
    buffer_store_dwordx4 v[240:243], v18, s[68:71], s65 offen offset:3072 sc0 sc1
    s_add_u32 s65, s65, 8192
    v_cvt_pk_bf16_f32 v152, v152, v153
    v_cvt_pk_bf16_f32 v153, v154, v155
    v_cvt_pk_bf16_f32 v154, v156, v157
    v_cvt_pk_bf16_f32 v155, v158, v159
    buffer_store_dwordx4 v[152:155], v18, s[68:71], s65 offen offset:0 sc0 sc1
    v_cvt_pk_bf16_f32 v184, v184, v185
    v_cvt_pk_bf16_f32 v185, v186, v187
    v_cvt_pk_bf16_f32 v186, v188, v189
    v_cvt_pk_bf16_f32 v187, v190, v191
    buffer_store_dwordx4 v[184:187], v18, s[68:71], s65 offen offset:1024 sc0 sc1
    v_cvt_pk_bf16_f32 v216, v216, v217
    v_cvt_pk_bf16_f32 v217, v218, v219
    v_cvt_pk_bf16_f32 v218, v220, v221
    v_cvt_pk_bf16_f32 v219, v222, v223
    buffer_store_dwordx4 v[216:219], v18, s[68:71], s65 offen offset:2048 sc0 sc1
    v_cvt_pk_bf16_f32 v248, v248, v249
    v_cvt_pk_bf16_f32 v249, v250, v251
    v_cvt_pk_bf16_f32 v250, v252, v253
    v_cvt_pk_bf16_f32 v251, v254, v255
    buffer_store_dwordx4 v[248:251], v18, s[68:71], s65 offen offset:3072 sc0 sc1
    s_branch s2_q1
s2_own1:
    ds_write_b128 v16, v[144:147] offset:0
    ds_write_b128 v17, v[176:179] offset:0
    ds_write_b128 v16, v[208:211] offset:128
    ds_write_b128 v17, v[240:243] offset:128
    ds_write_b128 v16, v[148:151] offset:8192
    ds_write_b128 v17, v[180:183] offset:8192
    ds_write_b128 v16, v[212:215] offset:8320
    ds_write_b128 v17, v[244:247] offset:8320
    ds_write_b128 v16, v[152:155] offset:16384
    ds_write_b128 v17, v[184:187] offset:16384
    ds_write_b128 v16, v[216:219] offset:16512
    ds_write_b128 v17, v[248:251] offset:16512
    ds_write_b128 v16, v[156:159] offset:24576
    ds_write_b128 v17, v[188:191] offset:24576
    ds_write_b128 v16, v[220:223] offset:24704
    ds_write_b128 v17, v[252:255] offset:24704
s2_q1:
    s_waitcnt vmcnt(0) lgkmcnt(0)
    s_barrier
    s_cmp_lg_u32 s32, 0
    s_cbranch_scc1 s2_done
    v_lshlrev_b32 v11, 8, v2
    v_mov_b32 v10, 1
    s_lshl_b32 s63, s80, 10
    s_lshl_b32 s64, s87, 2
    s_add_u32 s63, s63, s64
    s_mov_b64 exec, 15
    buffer_store_dword v10, v11, s[72:75], s63 offen offset:128 sc0 sc1
    s_mov_b64 exec, -1
    s_endpgm
s2_loader:
    s_sub_u32 s62, s32, 4
    v_lshrrev_b32 v3, 3, v2
    v_and_b32 v4, 7, v2
    v_lshrrev_b32 v5, 1, v3
    v_xor_b32 v4, v4, v5
    v_lshlrev_b32 v4, 4, v4
    s_movk_i32 s63, 11264
    v_mul_lo_u32 v9, v3, s63
    v_add_u32 v48, v9, v4
    v_xor_b32 v49, 64, v48
    v_add_u32 v49, 90112, v49
    v_add_u32 v50, 180224, v48
    v_add_u32 v51, 180224, v49
    v_add_u32 v52, 180224, v50
    v_add_u32 v53, 180224, v51
    v_add_u32 v54, 180224, v52
    v_add_u32 v55, 180224, v53
    v_lshl_add_u32 v56, v3, 11, v4
    v_xor_b32 v57, 64, v56
    v_add_u32 v57, 16384, v57
    v_add_u32 v58, 32768, v56
    v_add_u32 v59, 32768, v57
    v_lshrrev_b32 v9, 2, v2
    v_and_b32 v10, 3, v2
    v_lshrrev_b32 v11, 5, v2
    v_lshlrev_b32 v11, 1, v11
    v_xor_b32 v10, v10, v11
    v_lshlrev_b32 v10, 4, v10
    v_lshl_add_u32 v60, v9, 11, v10
    s_lshl_b32 s20, s34, 8
    s_lshl_b32 s63, s62, 6
    s_add_u32 s20, s20, s63
    s_mul_i32 s20, s20, 11264
    s_lshl_b32 s29, s62, 13
    s_lshl_b32 s30, s62, 12
    s_add_u32 s30, s30, 32768
    s_mov_b32 s28, 0
    s_lshl_b32 s24, s62, 15
    s_lshl_b32 s63, s35, 8
    s_add_u32 s24, s24, s63
    v_lshrrev_b32 v5, 5, v2
    v_and_b32 v6, 31, v2
    v_and_b32 v62, 15, v2
    v_lshlrev_b32 v62, 2, v62
    s_lshl_b32 s63, s3, 4
    s_add_u32 s63, s63, s84
    s_lshl_b32 s63, s63, 7
    s_add_u32 s21, s20, s63
    s_add_u32 s21, s21, 7168
    s_lshl_b32 s26, s35, 7
    s_lshl_b32 s63, s62, 5
    s_add_u32 s26, s26, s63
    s_lshl_b32 s26, s26, 11
    s_lshl_b32 s63, s84, 7
    s_add_u32 s26, s26, s63
    s_movk_i32 s27, 128
    s_add_u32 s64, s22, s23
    s_mov_b32 s31, 3
    s_waitcnt lgkmcnt(0)
    s_cmp_eq_u32 s3, 0
    s_cselect_b32 s40, s40, s42
    s_cselect_b32 s41, s41, s43
    s_add_u32 s4, s58, 8388608
    s_addc_u32 s5, s59, 0
    s_mov_b32 s6, 23068672
    s_mov_b32 s7, 0x00020000
    s_mov_b32 s8, s40
    s_mov_b32 s9, s41
    s_mov_b32 s10, 2097152
    s_mov_b32 s11, 0x00020000
    v_mov_b32 v61, 0
    s_cmp_eq_u32 s3, 0
    s_mov_b32 s81, 0xff07ff07
    s_cselect_b32 s81, 0xfff0fff0, s81
    s_mov_b32 s83, 0x7ff07ff
    s_cselect_b32 s83, 0xf07ff07f, s83
    s_cmp_eq_u32 s33, 0
    s_cselect_b32 s81, s81, s83
    s_cbranch_scc1 s2_ld_slow
    s_cmp_lg_u32 s25, 0
    s_cbranch_scc1 s2_ld_fast
    s_waitcnt vmcnt(0)
    s_barrier
    s_barrier
s2_ld_fast:
    s_add_u32 s65, s29, s28
    s_add_u32 s66, s30, s28
    s_add_u32 m0, s65, 0
    s_nop 0
    buffer_load_dwordx4 v48, s[4:7], s21 offen sc1 lds
    s_add_u32 m0, s65, 1024
    s_nop 0
    buffer_load_dwordx4 v49, s[4:7], s21 offen sc1 lds
    s_add_u32 m0, s65, 2048
    s_nop 0
    buffer_load_dwordx4 v50, s[4:7], s21 offen sc1 lds
    s_add_u32 m0, s65, 3072
    s_nop 0
    buffer_load_dwordx4 v51, s[4:7], s21 offen sc1 lds
    s_add_u32 m0, s65, 4096
    s_nop 0
    buffer_load_dwordx4 v52, s[4:7], s21 offen sc1 lds
    s_add_u32 m0, s65, 5120
    s_nop 0
    buffer_load_dwordx4 v53, s[4:7], s21 offen sc1 lds
    s_add_u32 m0, s65, 6144
    s_nop 0
    buffer_load_dwordx4 v54, s[4:7], s21 offen sc1 lds
    s_add_u32 m0, s65, 7168
    s_nop 0
    buffer_load_dwordx4 v55, s[4:7], s21 offen sc1 lds
    s_add_u32 s21, s21, 128
    s_add_u32 m0, s66, 0
    s_nop 0
    buffer_load_dwordx4 v56, s[8:11], s26 offen lds
    s_add_u32 m0, s66, 1024
    s_nop 0
    buffer_load_dwordx4 v57, s[8:11], s26 offen lds
    s_add_u32 m0, s66, 2048
    s_nop 0
    buffer_load_dwordx4 v58, s[8:11], s26 offen lds
    s_add_u32 m0, s66, 3072
    s_nop 0
    buffer_load_dwordx4 v59, s[8:11], s26 offen lds
    s_add_u32 s26, s26, s27
    s_add_u32 s28, s28, 49152
    s_cmp_eq_u32 s28, 147456
    s_cselect_b32 s28, 0, s28
    s_add_u32 s65, s29, s28
    s_add_u32 s66, s30, s28
    s_add_u32 m0, s65, 0
    s_nop 0
    buffer_load_dwordx4 v48, s[4:7], s21 offen sc1 lds
    s_add_u32 m0, s65, 1024
    s_nop 0
    buffer_load_dwordx4 v49, s[4:7], s21 offen sc1 lds
    s_add_u32 m0, s65, 2048
    s_nop 0
    buffer_load_dwordx4 v50, s[4:7], s21 offen sc1 lds
    s_add_u32 m0, s65, 3072
    s_nop 0
    buffer_load_dwordx4 v51, s[4:7], s21 offen sc1 lds
    s_add_u32 m0, s65, 4096
    s_nop 0
    buffer_load_dwordx4 v52, s[4:7], s21 offen sc1 lds
    s_add_u32 m0, s65, 5120
    s_nop 0
    buffer_load_dwordx4 v53, s[4:7], s21 offen sc1 lds
    s_add_u32 m0, s65, 6144
    s_nop 0
    buffer_load_dwordx4 v54, s[4:7], s21 offen sc1 lds
    s_add_u32 m0, s65, 7168
    s_nop 0
    buffer_load_dwordx4 v55, s[4:7], s21 offen sc1 lds
    s_add_u32 s21, s21, 128
    s_add_u32 m0, s66, 0
    s_nop 0
    buffer_load_dwordx4 v56, s[8:11], s26 offen lds
    s_add_u32 m0, s66, 1024
    s_nop 0
    buffer_load_dwordx4 v57, s[8:11], s26 offen lds
    s_add_u32 m0, s66, 2048
    s_nop 0
    buffer_load_dwordx4 v58, s[8:11], s26 offen lds
    s_add_u32 m0, s66, 3072
    s_nop 0
    buffer_load_dwordx4 v59, s[8:11], s26 offen lds
    s_add_u32 s26, s26, s27
    s_add_u32 s28, s28, 49152
    s_cmp_eq_u32 s28, 147456
    s_cselect_b32 s28, 0, s28
    s_cmp_eq_u32 s25, 0
    s_cbranch_scc1 s2_ld_fast2
    s_waitcnt vmcnt(24)
    s_barrier
    s_barrier
s2_ld_fast2:
    s_waitcnt vmcnt(12)
    s_barrier
    s_mov_b32 s31, 2
    s_branch s2_ld_chk
s2_ld_slow:
    s_waitcnt vmcnt(0)
    s_barrier
    s_sleep 3
    s_add_u32 m0, s30, 0
    s_nop 0
    buffer_load_dwordx4 v56, s[8:11], s26 offen lds
    s_add_u32 m0, s30, 1024
    s_nop 0
    buffer_load_dwordx4 v57, s[8:11], s26 offen lds
    s_add_u32 m0, s30, 2048
    s_nop 0
    buffer_load_dwordx4 v58, s[8:11], s26 offen lds
    s_add_u32 m0, s30, 3072
    s_nop 0
    buffer_load_dwordx4 v59, s[8:11], s26 offen lds
    s_add_u32 s26, s26, s27
    s_add_u32 m0, s30, 49152
    s_nop 0
    buffer_load_dwordx4 v56, s[8:11], s26 offen lds
    s_add_u32 m0, s30, 50176
    s_nop 0
    buffer_load_dwordx4 v57, s[8:11], s26 offen lds
    s_add_u32 m0, s30, 51200
    s_nop 0
    buffer_load_dwordx4 v58, s[8:11], s26 offen lds
    s_add_u32 m0, s30, 52224
    s_nop 0
    buffer_load_dwordx4 v59, s[8:11], s26 offen lds
    s_add_u32 s26, s26, s27
    s_add_u32 m0, s30, 98304
    s_nop 0
    buffer_load_dwordx4 v56, s[8:11], s26 offen lds
    s_add_u32 m0, s30, 99328
    s_nop 0
    buffer_load_dwordx4 v57, s[8:11], s26 offen lds
    s_add_u32 m0, s30, 100352
    s_nop 0
    buffer_load_dwordx4 v58, s[8:11], s26 offen lds
    s_add_u32 m0, s30, 101376
    s_nop 0
    buffer_load_dwordx4 v59, s[8:11], s26 offen lds
    s_add_u32 s26, s26, s27
    s_barrier
    s_add_u32 m0, s29, 0
    s_nop 0
    buffer_load_dwordx4 v48, s[4:7], s21 offen sc1 lds
    s_add_u32 m0, s29, 1024
    s_nop 0
    buffer_load_dwordx4 v49, s[4:7], s21 offen sc1 lds
    s_add_u32 m0, s29, 2048
    s_nop 0
    buffer_load_dwordx4 v50, s[4:7], s21 offen sc1 lds
    s_add_u32 m0, s29, 3072
    s_nop 0
    buffer_load_dwordx4 v51, s[4:7], s21 offen sc1 lds
    s_add_u32 m0, s29, 4096
    s_nop 0
    buffer_load_dwordx4 v52, s[4:7], s21 offen sc1 lds
    s_add_u32 m0, s29, 5120
    s_nop 0
    buffer_load_dwordx4 v53, s[4:7], s21 offen sc1 lds
    s_add_u32 m0, s29, 6144
    s_nop 0
    buffer_load_dwordx4 v54, s[4:7], s21 offen sc1 lds
    s_add_u32 m0, s29, 7168
    s_nop 0
    buffer_load_dwordx4 v55, s[4:7], s21 offen sc1 lds
    s_add_u32 s21, s21, 128
    s_add_u32 m0, s29, 49152
    s_nop 0
    buffer_load_dwordx4 v48, s[4:7], s21 offen sc1 lds
    s_add_u32 m0, s29, 50176
    s_nop 0
    buffer_load_dwordx4 v49, s[4:7], s21 offen sc1 lds
    s_add_u32 m0, s29, 51200
    s_nop 0
    buffer_load_dwordx4 v50, s[4:7], s21 offen sc1 lds
    s_add_u32 m0, s29, 52224
    s_nop 0
    buffer_load_dwordx4 v51, s[4:7], s21 offen sc1 lds
    s_add_u32 m0, s29, 53248
    s_nop 0
    buffer_load_dwordx4 v52, s[4:7], s21 offen sc1 lds
    s_add_u32 m0, s29, 54272
    s_nop 0
    buffer_load_dwordx4 v53, s[4:7], s21 offen sc1 lds
    s_add_u32 m0, s29, 55296
    s_nop 0
    buffer_load_dwordx4 v54, s[4:7], s21 offen sc1 lds
    s_add_u32 m0, s29, 56320
    s_nop 0
    buffer_load_dwordx4 v55, s[4:7], s21 offen sc1 lds
    s_add_u32 s21, s21, 128
    s_waitcnt vmcnt(8)
    s_barrier
    s_add_u32 m0, s29, 98304
    s_nop 0
    buffer_load_dwordx4 v48, s[4:7], s21 offen sc1 lds
    s_add_u32 m0, s29, 99328
    s_nop 0
    buffer_load_dwordx4 v49, s[4:7], s21 offen sc1 lds
    s_add_u32 m0, s29, 100352
    s_nop 0
    buffer_load_dwordx4 v50, s[4:7], s21 offen sc1 lds
    s_add_u32 m0, s29, 101376
    s_nop 0
    buffer_load_dwordx4 v51, s[4:7], s21 offen sc1 lds
    s_add_u32 m0, s29, 102400
    s_nop 0
    buffer_load_dwordx4 v52, s[4:7], s21 offen sc1 lds
    s_add_u32 m0, s29, 103424
    s_nop 0
    buffer_load_dwordx4 v53, s[4:7], s21 offen sc1 lds
    s_add_u32 m0, s29, 104448
    s_nop 0
    buffer_load_dwordx4 v54, s[4:7], s21 offen sc1 lds
    s_add_u32 m0, s29, 105472
    s_nop 0
    buffer_load_dwordx4 v55, s[4:7], s21 offen sc1 lds
    s_add_u32 s21, s21, 128
    s_waitcnt vmcnt(8)
    s_branch s2_ld_loop1
s2_ld_loop:
    s_waitcnt vmcnt(12)
s2_ld_loop1:
    s_barrier
s2_ld_chk:
    s_add_u32 s63, s31, 1
    s_cmp_lg_u32 s63, s22
    s_cbranch_scc1 s2_ld_g0
    buffer_load_dword v61, v62, s[72:75], s89 offen offset:64 sc0 sc1
s2_ld_g0:
    s_cmp_lg_u32 s31, s22
    s_cbranch_scc1 s2_ld_go
    s_mov_b32 s22, 999
    s_mov_b32 s86, 0
    s_mov_b32 s82, 0x100000
s2_ld_hm:
    v_cmp_eq_u32 vcc, 1, v61
    s_or_b32 s63, vcc_lo, s81
    s_cmp_eq_u32 s63, -1
    s_cbranch_scc1 s2_ld_hmok
    buffer_load_dword v61, v62, s[72:75], s89 offen offset:64 sc0 sc1
    s_waitcnt vmcnt(0)
    s_cmp_eq_u32 s86, 1
    s_cbranch_scc1 s2_ld_hm2
    s_barrier
    s_add_u32 s86, s86, 1
    s_branch s2_ld_hm
s2_ld_hm2:
    s_sleep 4
    s_sub_u32 s82, s82, 1
    s_cmp_lg_u32 s82, 0
    s_cbranch_scc1 s2_ld_hm
s2_ld_hmok:
    s_mov_b32 s8, s48
    s_mov_b32 s9, s49
    s_mov_b32 s10, 7340032
    s_mov_b32 s11, 0x00020000
    v_add_u32 v56, 0, v60
    v_add_u32 v57, 64, v60
    v_add_u32 v58, 128, v60
    v_add_u32 v59, 192, v60
    s_lshl_b32 s26, s85, 17
    s_add_u32 s26, s26, s24
    s_mov_b32 s27, 131072
    s_lshl_b32 s21, s85, 7
    s_add_u32 s21, s21, s20
    s_cmp_eq_u32 s86, 0
    s_cbranch_scc1 s2_ld_go
    s_add_u32 s65, s29, s28
    s_add_u32 s66, s30, s28
    s_add_u32 m0, s65, 0
    s_nop 0
    buffer_load_dwordx4 v48, s[4:7], s21 offen sc1 lds
    s_add_u32 m0, s65, 1024
    s_nop 0
    buffer_load_dwordx4 v49, s[4:7], s21 offen sc1 lds
    s_add_u32 m0, s65, 2048
    s_nop 0
    buffer_load_dwordx4 v50, s[4:7], s21 offen sc1 lds
    s_add_u32 m0, s65, 3072
    s_nop 0
    buffer_load_dwordx4 v51, s[4:7], s21 offen sc1 lds
    s_add_u32 m0, s65, 4096
    s_nop 0
    buffer_load_dwordx4 v52, s[4:7], s21 offen sc1 lds
    s_add_u32 m0, s65, 5120
    s_nop 0
    buffer_load_dwordx4 v53, s[4:7], s21 offen sc1 lds
    s_add_u32 m0, s65, 6144
    s_nop 0
    buffer_load_dwordx4 v54, s[4:7], s21 offen sc1 lds
    s_add_u32 m0, s65, 7168
    s_nop 0
    buffer_load_dwordx4 v55, s[4:7], s21 offen sc1 lds
    s_add_u32 s21, s21, 128
    s_add_u32 m0, s66, 0
    s_nop 0
    buffer_load_dwordx4 v56, s[8:11], s26 offen lds
    s_add_u32 m0, s66, 1024
    s_nop 0
    buffer_load_dwordx4 v57, s[8:11], s26 offen lds
    s_add_u32 m0, s66, 2048
    s_nop 0
    buffer_load_dwordx4 v58, s[8:11], s26 offen lds
    s_add_u32 m0, s66, 3072
    s_nop 0
    buffer_load_dwordx4 v59, s[8:11], s26 offen lds
    s_add_u32 s26, s26, s27
    s_add_u32 s28, s28, 49152
    s_cmp_eq_u32 s28, 147456
    s_cselect_b32 s28, 0, s28
    s_add_u32 s31, s31, 1
s2_ld_go:
    s_add_u32 s65, s29, s28
    s_add_u32 s66, s30, s28
    s_add_u32 m0, s65, 0
    s_nop 0
    buffer_load_dwordx4 v48, s[4:7], s21 offen sc1 lds
    s_add_u32 m0, s65, 1024
    s_nop 0
    buffer_load_dwordx4 v49, s[4:7], s21 offen sc1 lds
    s_add_u32 m0, s65, 2048
    s_nop 0
    buffer_load_dwordx4 v50, s[4:7], s21 offen sc1 lds
    s_add_u32 m0, s65, 3072
    s_nop 0
    buffer_load_dwordx4 v51, s[4:7], s21 offen sc1 lds
    s_add_u32 m0, s65, 4096
    s_nop 0
    buffer_load_dwordx4 v52, s[4:7], s21 offen sc1 lds
    s_add_u32 m0, s65, 5120
    s_nop 0
    buffer_load_dwordx4 v53, s[4:7], s21 offen sc1 lds
    s_add_u32 m0, s65, 6144
    s_nop 0
    buffer_load_dwordx4 v54, s[4:7], s21 offen sc1 lds
    s_add_u32 m0, s65, 7168
    s_nop 0
    buffer_load_dwordx4 v55, s[4:7], s21 offen sc1 lds
    s_add_u32 s21, s21, 128
    s_add_u32 m0, s66, 0
    s_nop 0
    buffer_load_dwordx4 v56, s[8:11], s26 offen lds
    s_add_u32 m0, s66, 1024
    s_nop 0
    buffer_load_dwordx4 v57, s[8:11], s26 offen lds
    s_add_u32 m0, s66, 2048
    s_nop 0
    buffer_load_dwordx4 v58, s[8:11], s26 offen lds
    s_add_u32 m0, s66, 3072
    s_nop 0
    buffer_load_dwordx4 v59, s[8:11], s26 offen lds
    s_add_u32 s26, s26, s27
    s_add_u32 s28, s28, 49152
    s_cmp_eq_u32 s28, 147456
    s_cselect_b32 s28, 0, s28
    s_add_u32 s31, s31, 1
    s_cmp_lg_u32 s31, s64
    s_cbranch_scc1 s2_ld_loop
    s_mov_b32 s12, s36
    s_mov_b32 s13, s37
    s_mov_b32 s14, 4194304
    s_mov_b32 s15, 0x00020000
    s_mov_b32 s16, s44
    s_mov_b32 s17, s45
    s_mov_b32 s18, 2048
    s_mov_b32 s19, 0x00020000
    s_mov_b32 s76, s50
    s_mov_b32 s77, s51
    s_mov_b32 s78, 2048
    s_mov_b32 s79, 0x00020000
    s_add_u32 s8, s58, 4194304
    s_addc_u32 s9, s59, 0
    s_mov_b32 s10, 16384
    s_mov_b32 s11, 0x00020000
    s_lshl_b32 s65, s34, 8
    s_lshl_b32 s63, s87, 6
    s_add_u32 s65, s65, s63
    s_lshr_b32 s63, s62, 1
    s_lshl_b32 s63, s63, 5
    s_add_u32 s65, s65, s63
    s_and_b32 s61, s62, 1
    v_lshlrev_b32 v7, 4, v6
    v_lshl_add_u32 v7, v5, 14, v7
    s_lshl_b32 s66, s65, 12
    s_lshl_b32 s63, s35, 9
    s_add_u32 s66, s66, s63
    s_lshl_b32 s63, s61, 15
    s_add_u32 s66, s66, s63
    v_lshrrev_b32 v8, 1, v7
    s_lshr_b32 s67, s66, 1
    buffer_load_dwordx2 v[64:65], v8, s[12:15], s67 offen offset:0
    buffer_load_dwordx2 v[66:67], v8, s[12:15], s67 offen offset:2048
    s_add_u32 s67, s67, 4096
    buffer_load_dwordx2 v[68:69], v8, s[12:15], s67 offen offset:0
    buffer_load_dwordx2 v[70:71], v8, s[12:15], s67 offen offset:2048
    s_add_u32 s67, s67, 28672
    buffer_load_dwordx2 v[72:73], v8, s[12:15], s67 offen offset:0
    buffer_load_dwordx2 v[74:75], v8, s[12:15], s67 offen offset:2048
    s_add_u32 s67, s67, 4096
    buffer_load_dwordx2 v[76:77], v8, s[12:15], s67 offen offset:0
    buffer_load_dwordx2 v[78:79], v8, s[12:15], s67 offen offset:2048
    s_add_u32 s67, s67, 4096
    v_lshlrev_b32 v8, 3, v6
    s_lshl_b32 s67, s35, 8
    buffer_load_dwordx2 v[96:97], v8, s[16:19], s67 offen
    buffer_load_dwordx2 v[98:99], v8, s[76:79], s67 offen
    v_lshlrev_b32 v8, 4, v5
    s_lshl_b32 s67, s65, 3
    s_lshl_b32 s63, s61, 5
    s_add_u32 s67, s67, s63
    buffer_load_dwordx4 v[100:103], v8, s[8:11], s67 offen offset:0
    buffer_load_dwordx4 v[104:107], v8, s[8:11], s67 offen offset:128
    s_waitcnt vmcnt(24)
    s_barrier
    s_waitcnt vmcnt(12)
    s_barrier
    s_waitcnt vmcnt(0)
    s_mov_b32 s86, 0xffff0000
    v_lshlrev_b32 v116, 16, v96
    v_and_b32 v117, s86, v96
    v_lshlrev_b32 v118, 16, v97
    v_and_b32 v119, s86, v97
    v_lshlrev_b32 v120, 16, v98
    v_and_b32 v121, s86, v98
    v_lshlrev_b32 v122, 16, v99
    v_and_b32 v123, s86, v99
    v_lshlrev_b32 v16, 16, v64
    v_and_b32 v17, s86, v64
    v_lshlrev_b32 v18, 16, v65
    v_and_b32 v19, s86, v65
    v_mul_f32 v16, v16, v116
    v_mul_f32 v17, v17, v117
    v_mul_f32 v18, v18, v118
    v_mul_f32 v19, v19, v119
    v_cvt_pk_bf16_f32 v20, v16, v17
    v_cvt_pk_bf16_f32 v21, v18, v19
    v_sub_f32 v22, 1.0, v100
    v_lshlrev_b32 v16, 16, v20
    v_and_b32 v17, s86, v20
    v_lshlrev_b32 v18, 16, v21
    v_and_b32 v19, s86, v21
    v_cvt_pk_bf16_f32 v22, v22, v22
    v_lshlrev_b32 v22, 16, v22
    v_mul_f32 v224, v100, v16
    v_mul_f32 v225, v100, v17
    v_mul_f32 v226, v100, v18
    v_mul_f32 v227, v100, v19
    v_fmac_f32 v224, v22, v120
    v_fmac_f32 v225, v22, v121
    v_fmac_f32 v226, v22, v122
    v_fmac_f32 v227, v22, v123
    v_lshlrev_b32 v16, 16, v66
    v_and_b32 v17, s86, v66
    v_lshlrev_b32 v18, 16, v67
    v_and_b32 v19, s86, v67
    v_mul_f32 v16, v16, v116
    v_mul_f32 v17, v17, v117
    v_mul_f32 v18, v18, v118
    v_mul_f32 v19, v19, v119
    v_cvt_pk_bf16_f32 v20, v16, v17
    v_cvt_pk_bf16_f32 v21, v18, v19
    v_sub_f32 v22, 1.0, v101
    v_lshlrev_b32 v16, 16, v20
    v_and_b32 v17, s86, v20
    v_lshlrev_b32 v18, 16, v21
    v_and_b32 v19, s86, v21
    v_cvt_pk_bf16_f32 v22, v22, v22
    v_lshlrev_b32 v22, 16, v22
    v_mul_f32 v228, v101, v16
    v_mul_f32 v229, v101, v17
    v_mul_f32 v230, v101, v18
    v_mul_f32 v231, v101, v19
    v_fmac_f32 v228, v22, v120
    v_fmac_f32 v229, v22, v121
    v_fmac_f32 v230, v22, v122
    v_fmac_f32 v231, v22, v123
    v_lshlrev_b32 v16, 16, v68
    v_and_b32 v17, s86, v68
    v_lshlrev_b32 v18, 16, v69
    v_and_b32 v19, s86, v69
    v_mul_f32 v16, v16, v116
    v_mul_f32 v17, v17, v117
    v_mul_f32 v18, v18, v118
    v_mul_f32 v19, v19, v119
    v_cvt_pk_bf16_f32 v20, v16, v17
    v_cvt_pk_bf16_f32 v21, v18, v19
    v_sub_f32 v22, 1.0, v102
    v_lshlrev_b32 v16, 16, v20
    v_and_b32 v17, s86, v20
    v_lshlrev_b32 v18, 16, v21
    v_and_b32 v19, s86, v21
    v_cvt_pk_bf16_f32 v22, v22, v22
    v_lshlrev_b32 v22, 16, v22
    v_mul_f32 v232, v102, v16
    v_mul_f32 v233, v102, v17
    v_mul_f32 v234, v102, v18
    v_mul_f32 v235, v102, v19
    v_fmac_f32 v232, v22, v120
    v_fmac_f32 v233, v22, v121
    v_fmac_f32 v234, v22, v122
    v_fmac_f32 v235, v22, v123
    v_lshlrev_b32 v16, 16, v70
    v_and_b32 v17, s86, v70
    v_lshlrev_b32 v18, 16, v71
    v_and_b32 v19, s86, v71
    v_mul_f32 v16, v16, v116
    v_mul_f32 v17, v17, v117
    v_mul_f32 v18, v18, v118
    v_mul_f32 v19, v19, v119
    v_cvt_pk_bf16_f32 v20, v16, v17
    v_cvt_pk_bf16_f32 v21, v18, v19
    v_sub_f32 v22, 1.0, v103
    v_lshlrev_b32 v16, 16, v20
    v_and_b32 v17, s86, v20
    v_lshlrev_b32 v18, 16, v21
    v_and_b32 v19, s86, v21
    v_cvt_pk_bf16_f32 v22, v22, v22
    v_lshlrev_b32 v22, 16, v22
    v_mul_f32 v236, v103, v16
    v_mul_f32 v237, v103, v17
    v_mul_f32 v238, v103, v18
    v_mul_f32 v239, v103, v19
    v_fmac_f32 v236, v22, v120
    v_fmac_f32 v237, v22, v121
    v_fmac_f32 v238, v22, v122
    v_fmac_f32 v239, v22, v123
    v_lshlrev_b32 v16, 16, v72
    v_and_b32 v17, s86, v72
    v_lshlrev_b32 v18, 16, v73
    v_and_b32 v19, s86, v73
    v_mul_f32 v16, v16, v116
    v_mul_f32 v17, v17, v117
    v_mul_f32 v18, v18, v118
    v_mul_f32 v19, v19, v119
    v_cvt_pk_bf16_f32 v20, v16, v17
    v_cvt_pk_bf16_f32 v21, v18, v19
    v_sub_f32 v22, 1.0, v104
    v_lshlrev_b32 v16, 16, v20
    v_and_b32 v17, s86, v20
    v_lshlrev_b32 v18, 16, v21
    v_and_b32 v19, s86, v21
    v_cvt_pk_bf16_f32 v22, v22, v22
    v_lshlrev_b32 v22, 16, v22
    v_mul_f32 v240, v104, v16
    v_mul_f32 v241, v104, v17
    v_mul_f32 v242, v104, v18
    v_mul_f32 v243, v104, v19
    v_fmac_f32 v240, v22, v120
    v_fmac_f32 v241, v22, v121
    v_fmac_f32 v242, v22, v122
    v_fmac_f32 v243, v22, v123
    v_lshlrev_b32 v16, 16, v74
    v_and_b32 v17, s86, v74
    v_lshlrev_b32 v18, 16, v75
    v_and_b32 v19, s86, v75
    v_mul_f32 v16, v16, v116
    v_mul_f32 v17, v17, v117
    v_mul_f32 v18, v18, v118
    v_mul_f32 v19, v19, v119
    v_cvt_pk_bf16_f32 v20, v16, v17
    v_cvt_pk_bf16_f32 v21, v18, v19
    v_sub_f32 v22, 1.0, v105
    v_lshlrev_b32 v16, 16, v20
    v_and_b32 v17, s86, v20
    v_lshlrev_b32 v18, 16, v21
    v_and_b32 v19, s86, v21
    v_cvt_pk_bf16_f32 v22, v22, v22
    v_lshlrev_b32 v22, 16, v22
    v_mul_f32 v244, v105, v16
    v_mul_f32 v245, v105, v17
    v_mul_f32 v246, v105, v18
    v_mul_f32 v247, v105, v19
    v_fmac_f32 v244, v22, v120
    v_fmac_f32 v245, v22, v121
    v_fmac_f32 v246, v22, v122
    v_fmac_f32 v247, v22, v123
    v_lshlrev_b32 v16, 16, v76
    v_and_b32 v17, s86, v76
    v_lshlrev_b32 v18, 16, v77
    v_and_b32 v19, s86, v77
    v_mul_f32 v16, v16, v116
    v_mul_f32 v17, v17, v117
    v_mul_f32 v18, v18, v118
    v_mul_f32 v19, v19, v119
    v_cvt_pk_bf16_f32 v20, v16, v17
    v_cvt_pk_bf16_f32 v21, v18, v19
    v_sub_f32 v22, 1.0, v106
    v_lshlrev_b32 v16, 16, v20
    v_and_b32 v17, s86, v20
    v_lshlrev_b32 v18, 16, v21
    v_and_b32 v19, s86, v21
    v_cvt_pk_bf16_f32 v22, v22, v22
    v_lshlrev_b32 v22, 16, v22
    v_mul_f32 v248, v106, v16
    v_mul_f32 v249, v106, v17
    v_mul_f32 v250, v106, v18
    v_mul_f32 v251, v106, v19
    v_fmac_f32 v248, v22, v120
    v_fmac_f32 v249, v22, v121
    v_fmac_f32 v250, v22, v122
    v_fmac_f32 v251, v22, v123
    v_lshlrev_b32 v16, 16, v78
    v_and_b32 v17, s86, v78
    v_lshlrev_b32 v18, 16, v79
    v_and_b32 v19, s86, v79
    v_mul_f32 v16, v16, v116
    v_mul_f32 v17, v17, v117
    v_mul_f32 v18, v18, v118
    v_mul_f32 v19, v19, v119
    v_cvt_pk_bf16_f32 v20, v16, v17
    v_cvt_pk_bf16_f32 v21, v18, v19
    v_sub_f32 v22, 1.0, v107
    v_lshlrev_b32 v16, 16, v20
    v_and_b32 v17, s86, v20
    v_lshlrev_b32 v18, 16, v21
    v_and_b32 v19, s86, v21
    v_cvt_pk_bf16_f32 v22, v22, v22
    v_lshlrev_b32 v22, 16, v22
    v_mul_f32 v252, v107, v16
    v_mul_f32 v253, v107, v17
    v_mul_f32 v254, v107, v18
    v_mul_f32 v255, v107, v19
    v_fmac_f32 v252, v22, v120
    v_fmac_f32 v253, v22, v121
    v_fmac_f32 v254, v22, v122
    v_fmac_f32 v255, v22, v123
    s_mov_b32 s8, s52
    s_mov_b32 s9, s53
    s_mov_b32 s10, 8388608
    s_mov_b32 s11, 0x00020000
    s_lshr_b32 s63, s62, 1
    s_lshl_b32 s63, s63, 14
    s_add_u32 s28, s28, s63
    s_lshl_b32 s63, s61, 12
    s_add_u32 s28, s28, s63
    v_lshlrev_b32 v8, 4, v6
    v_lshl_add_u32 v8, v5, 11, v8
    s_lshr_b32 s63, s62, 1
    s_lshl_b32 s63, s63, 13
    s_lshl_b32 s64, s61, 9
    s_add_u32 s63, s63, s64
    v_lshrrev_b32 v9, 2, v6
    v_lshlrev_b32 v9, 10, v9
    v_and_b32 v10, 3, v6
    v_lshl_add_u32 v9, v10, 4, v9
    v_lshl_add_u32 v9, v5, 8, v9
    v_add_u32 v9, s63, v9
    v_lshlrev_b32 v10, 6, v5
    v_xor_b32 v8, v8, v10
    v_add_u32 v8, s28, v8
    v_xor_b32 v24, 16, v8
    v_xor_b32 v25, 32, v8
    v_xor_b32 v26, 48, v8
    v_mov_b32 v23, v8
    s_add_u32 s67, s66, 0x10000
    s_lshl_b32 s65, s89, 9
    s_lshl_b32 s81, 1, s87
    s_barrier
    ds_read_b128 v[64:67], v23 offset:0
    ds_read_b128 v[68:71], v24 offset:512
    ds_read_b128 v[72:75], v25 offset:1024
    ds_read_b128 v[76:79], v26 offset:1536
    ds_read_b128 v[80:83], v23 offset:8192
    ds_read_b128 v[84:87], v24 offset:8704
    ds_read_b128 v[88:91], v25 offset:9216
    ds_read_b128 v[92:95], v26 offset:9728
    s_mov_b32 s82, 0x100000
s2_poll:
    buffer_load_dword v61, v62, s[72:75], s89 offen offset:128 sc0 sc1
    s_waitcnt vmcnt(0)
    v_cmp_eq_u32 vcc, 1, v61
    s_or_b32 s83, vcc_lo, s81
    s_and_b32 s83, s83, 15
    s_cmp_eq_u32 s83, 15
    s_cbranch_scc1 s2_got
    s_sleep 2
    s_sub_u32 s82, s82, 1
    s_cmp_lg_u32 s82, 0
    s_cbranch_scc1 s2_poll
s2_got:
    s_xor_b32 s63, s87, 1
    s_lshl_b32 s63, s63, 15
    s_add_u32 s84, s65, s63
    s_xor_b32 s63, s87, 2
    s_lshl_b32 s63, s63, 15
    s_add_u32 s85, s65, s63
    s_xor_b32 s63, s87, 3
    s_lshl_b32 s63, s63, 15
    s_add_u32 s86, s65, s63
    buffer_load_dwordx4 v[128:131], v9, s[68:71], s84 offen offset:0 sc0 sc1
    buffer_load_dwordx4 v[132:135], v9, s[68:71], s85 offen offset:0 sc0 sc1
    buffer_load_dwordx4 v[136:139], v9, s[68:71], s86 offen offset:0 sc0 sc1
    buffer_load_dwordx4 v[140:143], v9, s[68:71], s84 offen offset:64 sc0 sc1
    buffer_load_dwordx4 v[144:147], v9, s[68:71], s85 offen offset:64 sc0 sc1
    buffer_load_dwordx4 v[148:151], v9, s[68:71], s86 offen offset:64 sc0 sc1
    buffer_load_dwordx4 v[152:155], v9, s[68:71], s84 offen offset:128 sc0 sc1
    buffer_load_dwordx4 v[156:159], v9, s[68:71], s85 offen offset:128 sc0 sc1
    buffer_load_dwordx4 v[160:163], v9, s[68:71], s86 offen offset:128 sc0 sc1
    buffer_load_dwordx4 v[164:167], v9, s[68:71], s84 offen offset:192 sc0 sc1
    buffer_load_dwordx4 v[168:171], v9, s[68:71], s85 offen offset:192 sc0 sc1
    buffer_load_dwordx4 v[172:175], v9, s[68:71], s86 offen offset:192 sc0 sc1
    s_waitcnt lgkmcnt(0)
    v_add_f32 v224, v224, v64
    v_add_f32 v225, v225, v65
    v_add_f32 v226, v226, v66
    v_add_f32 v227, v227, v67
    v_add_f32 v228, v228, v68
    v_add_f32 v229, v229, v69
    v_add_f32 v230, v230, v70
    v_add_f32 v231, v231, v71
    v_add_f32 v232, v232, v72
    v_add_f32 v233, v233, v73
    v_add_f32 v234, v234, v74
    v_add_f32 v235, v235, v75
    v_add_f32 v236, v236, v76
    v_add_f32 v237, v237, v77
    v_add_f32 v238, v238, v78
    v_add_f32 v239, v239, v79
    v_add_f32 v240, v240, v80
    v_add_f32 v241, v241, v81
    v_add_f32 v242, v242, v82
    v_add_f32 v243, v243, v83
    v_add_f32 v244, v244, v84
    v_add_f32 v245, v245, v85
    v_add_f32 v246, v246, v86
    v_add_f32 v247, v247, v87
    v_add_f32 v248, v248, v88
    v_add_f32 v249, v249, v89
    v_add_f32 v250, v250, v90
    v_add_f32 v251, v251, v91
    v_add_f32 v252, v252, v92
    v_add_f32 v253, v253, v93
    v_add_f32 v254, v254, v94
    v_add_f32 v255, v255, v95
    s_mov_b32 s86, 0xffff0000
    s_waitcnt vmcnt(9)
    v_lshlrev_b32 v16, 16, v128
    v_and_b32 v17, s86, v128
    v_lshlrev_b32 v18, 16, v129
    v_and_b32 v19, s86, v129
    v_add_f32 v224, v224, v16
    v_add_f32 v225, v225, v17
    v_add_f32 v226, v226, v18
    v_add_f32 v227, v227, v19
    v_lshlrev_b32 v20, 16, v130
    v_and_b32 v21, s86, v130
    v_lshlrev_b32 v22, 16, v131
    v_and_b32 v23, s86, v131
    v_add_f32 v240, v240, v20
    v_add_f32 v241, v241, v21
    v_add_f32 v242, v242, v22
    v_add_f32 v243, v243, v23
    v_lshlrev_b32 v16, 16, v132
    v_and_b32 v17, s86, v132
    v_lshlrev_b32 v18, 16, v133
    v_and_b32 v19, s86, v133
    v_add_f32 v224, v224, v16
    v_add_f32 v225, v225, v17
    v_add_f32 v226, v226, v18
    v_add_f32 v227, v227, v19
    v_lshlrev_b32 v20, 16, v134
    v_and_b32 v21, s86, v134
    v_lshlrev_b32 v22, 16, v135
    v_and_b32 v23, s86, v135
    v_add_f32 v240, v240, v20
    v_add_f32 v241, v241, v21
    v_add_f32 v242, v242, v22
    v_add_f32 v243, v243, v23
    v_lshlrev_b32 v16, 16, v136
    v_and_b32 v17, s86, v136
    v_lshlrev_b32 v18, 16, v137
    v_and_b32 v19, s86, v137
    v_add_f32 v224, v224, v16
    v_add_f32 v225, v225, v17
    v_add_f32 v226, v226, v18
    v_add_f32 v227, v227, v19
    v_lshlrev_b32 v20, 16, v138
    v_and_b32 v21, s86, v138
    v_lshlrev_b32 v22, 16, v139
    v_and_b32 v23, s86, v139
    v_add_f32 v240, v240, v20
    v_add_f32 v241, v241, v21
    v_add_f32 v242, v242, v22
    v_add_f32 v243, v243, v23
    s_waitcnt vmcnt(6)
    v_lshlrev_b32 v16, 16, v140
    v_and_b32 v17, s86, v140
    v_lshlrev_b32 v18, 16, v141
    v_and_b32 v19, s86, v141
    v_add_f32 v228, v228, v16
    v_add_f32 v229, v229, v17
    v_add_f32 v230, v230, v18
    v_add_f32 v231, v231, v19
    v_lshlrev_b32 v20, 16, v142
    v_and_b32 v21, s86, v142
    v_lshlrev_b32 v22, 16, v143
    v_and_b32 v23, s86, v143
    v_add_f32 v244, v244, v20
    v_add_f32 v245, v245, v21
    v_add_f32 v246, v246, v22
    v_add_f32 v247, v247, v23
    v_lshlrev_b32 v16, 16, v144
    v_and_b32 v17, s86, v144
    v_lshlrev_b32 v18, 16, v145
    v_and_b32 v19, s86, v145
    v_add_f32 v228, v228, v16
    v_add_f32 v229, v229, v17
    v_add_f32 v230, v230, v18
    v_add_f32 v231, v231, v19
    v_lshlrev_b32 v20, 16, v146
    v_and_b32 v21, s86, v146
    v_lshlrev_b32 v22, 16, v147
    v_and_b32 v23, s86, v147
    v_add_f32 v244, v244, v20
    v_add_f32 v245, v245, v21
    v_add_f32 v246, v246, v22
    v_add_f32 v247, v247, v23
    v_lshlrev_b32 v16, 16, v148
    v_and_b32 v17, s86, v148
    v_lshlrev_b32 v18, 16, v149
    v_and_b32 v19, s86, v149
    v_add_f32 v228, v228, v16
    v_add_f32 v229, v229, v17
    v_add_f32 v230, v230, v18
    v_add_f32 v231, v231, v19
    v_lshlrev_b32 v20, 16, v150
    v_and_b32 v21, s86, v150
    v_lshlrev_b32 v22, 16, v151
    v_and_b32 v23, s86, v151
    v_add_f32 v244, v244, v20
    v_add_f32 v245, v245, v21
    v_add_f32 v246, v246, v22
    v_add_f32 v247, v247, v23
    s_waitcnt vmcnt(3)
    v_lshlrev_b32 v16, 16, v152
    v_and_b32 v17, s86, v152
    v_lshlrev_b32 v18, 16, v153
    v_and_b32 v19, s86, v153
    v_add_f32 v232, v232, v16
    v_add_f32 v233, v233, v17
    v_add_f32 v234, v234, v18
    v_add_f32 v235, v235, v19
    v_lshlrev_b32 v20, 16, v154
    v_and_b32 v21, s86, v154
    v_lshlrev_b32 v22, 16, v155
    v_and_b32 v23, s86, v155
    v_add_f32 v248, v248, v20
    v_add_f32 v249, v249, v21
    v_add_f32 v250, v250, v22
    v_add_f32 v251, v251, v23
    v_lshlrev_b32 v16, 16, v156
    v_and_b32 v17, s86, v156
    v_lshlrev_b32 v18, 16, v157
    v_and_b32 v19, s86, v157
    v_add_f32 v232, v232, v16
    v_add_f32 v233, v233, v17
    v_add_f32 v234, v234, v18
    v_add_f32 v235, v235, v19
    v_lshlrev_b32 v20, 16, v158
    v_and_b32 v21, s86, v158
    v_lshlrev_b32 v22, 16, v159
    v_and_b32 v23, s86, v159
    v_add_f32 v248, v248, v20
    v_add_f32 v249, v249, v21
    v_add_f32 v250, v250, v22
    v_add_f32 v251, v251, v23
    v_lshlrev_b32 v16, 16, v160
    v_and_b32 v17, s86, v160
    v_lshlrev_b32 v18, 16, v161
    v_and_b32 v19, s86, v161
    v_add_f32 v232, v232, v16
    v_add_f32 v233, v233, v17
    v_add_f32 v234, v234, v18
    v_add_f32 v235, v235, v19
    v_lshlrev_b32 v20, 16, v162
    v_and_b32 v21, s86, v162
    v_lshlrev_b32 v22, 16, v163
    v_and_b32 v23, s86, v163
    v_add_f32 v248, v248, v20
    v_add_f32 v249, v249, v21
    v_add_f32 v250, v250, v22
    v_add_f32 v251, v251, v23
    s_waitcnt vmcnt(0)
    v_lshlrev_b32 v16, 16, v164
    v_and_b32 v17, s86, v164
    v_lshlrev_b32 v18, 16, v165
    v_and_b32 v19, s86, v165
    v_add_f32 v236, v236, v16
    v_add_f32 v237, v237, v17
    v_add_f32 v238, v238, v18
    v_add_f32 v239, v239, v19
    v_lshlrev_b32 v20, 16, v166
    v_and_b32 v21, s86, v166
    v_lshlrev_b32 v22, 16, v167
    v_and_b32 v23, s86, v167
    v_add_f32 v252, v252, v20
    v_add_f32 v253, v253, v21
    v_add_f32 v254, v254, v22
    v_add_f32 v255, v255, v23
    v_lshlrev_b32 v16, 16, v168
    v_and_b32 v17, s86, v168
    v_lshlrev_b32 v18, 16, v169
    v_and_b32 v19, s86, v169
    v_add_f32 v236, v236, v16
    v_add_f32 v237, v237, v17
    v_add_f32 v238, v238, v18
    v_add_f32 v239, v239, v19
    v_lshlrev_b32 v20, 16, v170
    v_and_b32 v21, s86, v170
    v_lshlrev_b32 v22, 16, v171
    v_and_b32 v23, s86, v171
    v_add_f32 v252, v252, v20
    v_add_f32 v253, v253, v21
    v_add_f32 v254, v254, v22
    v_add_f32 v255, v255, v23
    v_lshlrev_b32 v16, 16, v172
    v_and_b32 v17, s86, v172
    v_lshlrev_b32 v18, 16, v173
    v_and_b32 v19, s86, v173
    v_add_f32 v236, v236, v16
    v_add_f32 v237, v237, v17
    v_add_f32 v238, v238, v18
    v_add_f32 v239, v239, v19
    v_lshlrev_b32 v20, 16, v174
    v_and_b32 v21, s86, v174
    v_lshlrev_b32 v22, 16, v175
    v_and_b32 v23, s86, v175
    v_add_f32 v252, v252, v20
    v_add_f32 v253, v253, v21
    v_add_f32 v254, v254, v22
    v_add_f32 v255, v255, v23
    buffer_store_dwordx4 v[224:227], v7, s[8:11], s66 offen nt
    s_add_u32 s66, s66, 4096
    buffer_store_dwordx4 v[228:231], v7, s[8:11], s66 offen nt
    s_add_u32 s66, s66, 4096
    buffer_store_dwordx4 v[232:235], v7, s[8:11], s66 offen nt
    s_add_u32 s66, s66, 4096
    buffer_store_dwordx4 v[236:239], v7, s[8:11], s66 offen nt
    s_add_u32 s66, s66, 4096
    buffer_store_dwordx4 v[240:243], v7, s[8:11], s67 offen nt
    s_add_u32 s67, s67, 4096
    buffer_store_dwordx4 v[244:247], v7, s[8:11], s67 offen nt
    s_add_u32 s67, s67, 4096
    buffer_store_dwordx4 v[248:251], v7, s[8:11], s67 offen nt
    s_add_u32 s67, s67, 4096
    buffer_store_dwordx4 v[252:255], v7, s[8:11], s67 offen nt
    s_add_u32 s67, s67, 4096
s2_done:
    s_endpgm
.section .rodata,"a"
.p2align 6
.amdhsa_kernel s1_kernel
  .amdhsa_next_free_vgpr 256
  .amdhsa_next_free_sgpr 100
  .amdhsa_accum_offset 256
  .amdhsa_group_segment_fixed_size 0
  .amdhsa_kernarg_size 144
  .amdhsa_user_sgpr_count 2
  .amdhsa_user_sgpr_kernarg_segment_ptr 1
  .amdhsa_system_sgpr_workgroup_id_x 1
.end_amdhsa_kernel
```
